```python
import torch

def _softmax(x, axis=-1):
    return torch.softmax(x, dim=axis)
def _gelu(x):
    return torch.nn.functional.gelu(x, approximate="tanh")
def _silu(x):
    return torch.nn.functional.silu(x)
def _sigmoid(x):
    return torch.sigmoid(x)
def _layernorm(x, axis=-1, eps=1e-5):
    m = x.mean(dim=axis, keepdim=True)
    v = x.var(dim=axis, keepdim=True, unbiased=False)
    return (x - m) / torch.sqrt(v + eps)
def _scatter_add(tgt, idx, src, axis=0):
    return tgt.clone().index_add_(axis, idx, src)
def _segment_sum(src, seg, n):
    out = torch.zeros((n,) + src.shape[1:], dtype=src.dtype)
    return out.index_add_(0, seg, src)
def _pad(x, pw):
    flat = tuple(v for pair in reversed(pw) for v in pair)
    return torch.nn.functional.pad(x, flat)

kernel_name = 'standalone__mixer_channel_mlp__prompt'

def setup_inputs():

    _w = (lambda a: (lambda t: t.to(torch.bfloat16) if t.is_floating_point() else t)(torch.as_tensor(a)))
    B, S, D, F = 1, 2048, 576, 4608
    return {
        "x": _w((lambda *s: torch.randn(*s, dtype=torch.bfloat16) * 0.05)(B, S, D)),
        "w1": _w((lambda *s: torch.randn(*s, dtype=torch.bfloat16) * 0.8)(D, F) * (D ** -0.5)),
        "b1": _w((lambda *s: torch.randn(*s, dtype=torch.bfloat16) * 0.4)(F)),
        "w2": _w((lambda *s: torch.randn(*s, dtype=torch.bfloat16) * 0.05)(F, D) * (F ** -0.5)),
        "b2": _w((lambda *s: torch.randn(*s, dtype=torch.bfloat16) * 0.05)(D)),
    }

def reference(x, w1, b1, w2, b2):
    y = _layernorm(x, axis=-1)
    h = _gelu(torch.einsum("bsd,df->bsf", y, w1) + b1)
    return torch.einsum("bsf,fd->bsd", h, w2) + b2
```

```asm
; @launch grid=(256,1,1) block=(512,1,1) lds=163840
.amdgcn_target "amdgcn-amd-amdhsa--gfx950"
.text
.globl standalone__mixer_channel_mlp__prompt_kernel
.p2align 8
.type standalone__mixer_channel_mlp__prompt_kernel,@function
standalone__mixer_channel_mlp__prompt_kernel:
    s_cmp_ge_u32 s2, 256
    s_cbranch_scc1 L_end
    s_load_dwordx16 s[64:79], s[0:1], 0
    s_memrealtime s[96:97]
    v_lshrrev_b32 v1, 6, v0
    v_and_b32 v0, 63, v0
    v_readfirstlane_b32 s36, v1
    s_and_b32 s40, s2, 3
    s_lshr_b32 s62, s2, 3
    s_and_b32 s41, s62, 3
    s_lshr_b32 s62, s62, 2
    s_lshl_b32 s39, s2, 1
    s_and_b32 s39, s39, 8
    s_add_u32 s39, s39, s62
    s_lshl_b32 s42, s36, 10
    s_lshl1_add_u32 s81, s41, s62
    s_sub_u32 s62, s81, 9
    s_cmp_ge_u32 s81, 9
    s_cselect_b32 s81, s62, s81
    s_mul_i32 s82, s39, 147456
    s_mul_i32 s44, s81, 589824
    s_lshl_b32 s53, s81, 7
    s_add_u32 s53, s53, s82
    v_lshrrev_b32 v64, 3, v0
    v_and_b32 v65, 7, v0
    v_lshrrev_b32 v66, 1, v64
    s_and_b32 s62, s36, 1
    s_lshl_b32 s63, s62, 2
    v_or_b32 v67, s63, v66
    v_xor_b32 v67, v67, v65
    s_lshl_b32 s63, s36, 3
    v_add_u32 v68, s63, v64
    v_mul_u32_u24 v6, 1152, v68
    v_lshl_add_u32 v6, v67, 4, v6
    v_bfe_u32 v64, v0, 2, 3
    v_add_u32 v64, s63, v64
    v_mul_u32_u24 v5, 9216, v64
    v_lshrrev_b32 v65, 5, v0
    v_lshl_add_u32 v5, v65, 6, v5
    s_lshl_b32 s62, s62, 1
    v_and_b32 v66, 3, v0
    v_xor_b32 v66, s62, v66
    v_lshl_add_u32 v5, v66, 4, v5
    s_cmp_eq_u32 s41, 3
    s_cselect_b32 s62, 1, 0
    s_lshl2_add_u32 s3, s41, s62
    s_mul_i32 s43, s41, 5
    s_sub_u32 s43, s43, s62
    s_lshl_b32 s43, s43, 6
    s_mul_i32 s62, s40, 2304
    s_lshl_b32 s63, s3, 7
    s_add_u32 s83, s62, s63
    v_add_u32 v5, s83, v5
    s_mov_b32 s6, 0x240000
    s_mov_b32 s7, 0x20000
    s_mov_b32 s10, 0x510000
    s_mov_b32 s11, 0x20000
    s_cmp_eq_u32 s36, 7
    s_cbranch_scc0 L_dw1
    s_getpc_b64 s[62:63]
    s_and_b32 s60, s39, 7
    s_lshl2_add_u32 s60, s60, s41
    s_mul_i32 s60, s60, 1536
    v_lshlrev_b32 v66, 7, v0
    v_add_u32 v66, s60, v66
    v_min_u32 v66, L_end-L_cpf, v66
    s_mov_b32 m0, 512
    s_mov_b32 exec_lo, 0xfff
    s_mov_b32 exec_hi, 0x0
    global_load_lds_dword v66, s[62:63]
    s_mov_b64 exec, -1
L_dw1:
L_cpf:
    s_waitcnt lgkmcnt(0)
    s_mov_b64 s[4:5], s[64:65]
    s_mov_b64 s[8:9], s[66:67]
    s_add_u32 m0, s42, 8192
    s_nop 0
    buffer_load_dwordx4 v6, s[4:7], s53 offen lds
    s_add_u32 s62, s53, 73728
    s_add_u32 m0, s42, 16384
    s_nop 0
    buffer_load_dwordx4 v6, s[4:7], s62 offen lds
    s_add_u32 m0, s42, 24576
    s_nop 0
    buffer_load_dwordx4 v5, s[8:11], s44 offen lds
    s_add_u32 s81, s81, 1
    s_cmp_eq_u32 s81, 9
    s_cselect_b32 s81, 0, s81
    s_mul_i32 s45, s81, 589824
    s_lshl_b32 s54, s81, 7
    s_add_u32 s54, s54, s82
    s_add_u32 m0, s42, 32768
    s_nop 0
    buffer_load_dwordx4 v6, s[4:7], s54 offen lds
    s_add_u32 s62, s54, 73728
    s_add_u32 m0, s42, 40960
    s_nop 0
    buffer_load_dwordx4 v6, s[4:7], s62 offen lds
    s_add_u32 m0, s42, 49152
    s_nop 0
    buffer_load_dwordx4 v5, s[8:11], s45 offen lds
    s_and_b32 s37, s36, 3
    s_lshr_b32 s38, s36, 2
    v_lshlrev_b32 v100, 4, v0
    s_and_b32 s98, s37, 1
    s_xor_b32 s98, s98, s38
    v_lshrrev_b32 v64, 4, v0
    v_bfe_u32 v65, v0, 2, 2
    v_and_b32 v66, 3, v0
    v_and_b32 v67, 1, v64
    v_lshlrev_b32 v68, 10, v64
    v_lshl_add_u32 v68, v65, 6, v68
    v_lshl_add_u32 v68, v66, 3, v68
    s_lshr_b32 s62, s37, 1
    v_xor_b32 v67, s62, v67
    v_lshl_add_u32 v69, v67, 5, v68
    v_xor_b32 v70, 32, v69
    s_xor_b32 s62, s98, 0
    s_lshl_b32 s62, s62, 12
    s_lshl_b32 s63, s38, 9
    s_add_u32 s62, s62, s63
    v_add_u32 v1, s62, v69
    v_add_u32 v3, s62, v70
    s_xor_b32 s62, s98, 1
    s_lshl_b32 s62, s62, 12
    s_lshl_b32 s63, s38, 9
    s_add_u32 s62, s62, s63
    v_add_u32 v2, s62, v69
    v_add_u32 v4, s62, v70
    v_and_b32 v65, 15, v0
    v_lshrrev_b32 v66, 1, v65
    v_xor_b32 v66, v66, v64
    s_lshl_b32 s62, s37, 12
    v_lshlrev_b32 v65, 7, v65
    v_add_u32 v65, s62, v65
    s_xor_b32 s62, s98, 0
    s_lshl_b32 s62, s62, 2
    v_xor_b32 v67, s62, v66
    v_lshl_add_u32 v101, v67, 4, v65
    s_xor_b32 s62, s98, 1
    s_lshl_b32 s62, s62, 2
    v_xor_b32 v67, s62, v66
    v_lshl_add_u32 v102, v67, 4, v65
    v_mov_b32 v88, 0x3f803f80
    v_mov_b32 v89, 0x3f803f80
    v_mov_b32 v90, 0x3f803f80
    v_mov_b32 v91, 0x3f803f80
    s_lshl_b64 s[98:99], 1, s36
    s_mov_b32 s16, s78
    s_mov_b32 s17, s79
    s_mov_b32 s18, 0x4000000
    s_mov_b32 s19, 0x20000
    s_mov_b32 s24, s76
    s_mov_b32 s25, s77
    s_mov_b32 s26, 0x100
    s_mov_b32 s27, 0x20000
    s_or_b32 s80, s2, s36
    s_cmp_eq_u32 s80, 0
    s_cbranch_scc0 L_dw2
    s_and_b32 s96, s96, 0xfffffff0
    s_or_b32 s97, s97, 0x80000000
    v_mov_b32 v64, s96
    v_mov_b32 v65, s97
    s_mov_b64 exec, 1
    buffer_store_dwordx2 v[64:65], off, s[24:27], 0 sc1
    s_mov_b64 exec, -1
L_dw2:
    s_waitcnt vmcnt(3)
    s_add_u32 s81, s81, 1
    s_cmp_eq_u32 s81, 9
    s_cselect_b32 s81, 0, s81
    s_mul_i32 s46, s81, 589824
    s_lshl_b32 s55, s81, 7
    s_add_u32 s55, s55, s82
    s_add_u32 m0, s42, 57344
    s_nop 0
    buffer_load_dwordx4 v6, s[4:7], s55 offen lds
    s_add_u32 s62, s55, 73728
    s_add_u32 m0, s42, 65536
    s_nop 0
    buffer_load_dwordx4 v6, s[4:7], s62 offen lds
    s_add_u32 m0, s42, 73728
    s_nop 0
    buffer_load_dwordx4 v5, s[8:11], s46 offen lds
    s_add_u32 s81, s81, 1
    s_cmp_eq_u32 s81, 9
    s_cselect_b32 s81, 0, s81
    s_mul_i32 s47, s81, 589824
    s_lshl_b32 s56, s81, 7
    s_add_u32 s56, s56, s82
    s_add_u32 m0, s42, 81920
    s_nop 0
    buffer_load_dwordx4 v6, s[4:7], s56 offen lds
    s_add_u32 s62, s56, 73728
    s_add_u32 m0, s42, 90112
    s_nop 0
    buffer_load_dwordx4 v6, s[4:7], s62 offen lds
    s_add_u32 m0, s42, 98304
    s_nop 0
    buffer_load_dwordx4 v5, s[8:11], s47 offen lds
    s_barrier
    ds_read_b128 v[112:115], v101 offset:8192
    ds_read_b128 v[116:119], v102 offset:8192
    ds_read_b128 v[120:123], v101 offset:10240
    ds_read_b128 v[124:127], v102 offset:10240
    ds_read_b64_tr_b16 v[24:25], v1 offset:24576
    ds_read_b64_tr_b16 v[26:27], v1 offset:24832
    ds_read_b64_tr_b16 v[28:29], v2 offset:24576
    ds_read_b64_tr_b16 v[30:31], v2 offset:24832
    ds_read_b64_tr_b16 v[32:33], v3 offset:24576
    ds_read_b64_tr_b16 v[34:35], v3 offset:24832
    ds_read_b64_tr_b16 v[36:37], v4 offset:24576
    ds_read_b64_tr_b16 v[38:39], v4 offset:24832
    s_waitcnt vmcnt(6)
    s_barrier
    s_setprio 3
    s_waitcnt lgkmcnt(4)
    v_mfma_f32_16x16x32_bf16 v[48:51], v[24:27], v[112:115], 0
    s_add_u32 s81, s81, 1
    s_cmp_eq_u32 s81, 9
    s_cselect_b32 s81, 0, s81
    s_mul_i32 s48, s81, 589824
    s_lshl_b32 s57, s81, 7
    s_add_u32 s57, s57, s82
    ds_read_b128 v[128:131], v101 offset:32768
    ds_read_b128 v[132:135], v102 offset:32768
    v_mfma_f32_16x16x32_bf16 v[48:51], v[28:31], v[116:119], v[48:51]
    ds_read_b128 v[136:139], v101 offset:34816
    ds_read_b128 v[140:143], v102 offset:34816
    v_mfma_f32_16x16x32_bf16 v[52:55], v[24:27], v[120:123], 0
    s_add_u32 m0, s42, 106496
    ds_read_b64_tr_b16 v[40:41], v1 offset:49152
    buffer_load_dwordx4 v6, s[4:7], s57 offen lds
    ds_read_b64_tr_b16 v[42:43], v1 offset:49408
    v_mfma_f32_16x16x32_bf16 v[52:55], v[28:31], v[124:127], v[52:55]
    ds_read_b64_tr_b16 v[44:45], v2 offset:49152
    ds_read_b64_tr_b16 v[46:47], v2 offset:49408
    v_mfma_f32_16x16x32_bf16 v[92:95], v[88:91], v[24:27], 0
    v_mfma_f32_16x16x32_bf16 v[80:83], v[112:115], v[112:115], 0
    s_add_u32 s62, s57, 73728
    s_add_u32 m0, s42, 114688
    s_nop 0
    buffer_load_dwordx4 v6, s[4:7], s62 offen lds
    v_mfma_f32_16x16x32_bf16 v[84:87], v[120:123], v[120:123], 0
    s_setprio 1
    s_waitcnt lgkmcnt(8)
    v_mfma_f32_16x16x32_bf16 v[56:59], v[32:35], v[112:115], 0
    ds_read_b64_tr_b16 v[24:25], v3 offset:49152
    ds_read_b64_tr_b16 v[26:27], v3 offset:49408
    v_mfma_f32_16x16x32_bf16 v[56:59], v[36:39], v[116:119], v[56:59]
    s_add_u32 m0, s42, 122880
    ds_read_b64_tr_b16 v[28:29], v4 offset:49152
    buffer_load_dwordx4 v5, s[8:11], s48 offen lds
    ds_read_b64_tr_b16 v[30:31], v4 offset:49408
    v_mfma_f32_16x16x32_bf16 v[60:63], v[32:35], v[120:123], 0
    s_add_u32 s81, s81, 1
    s_cmp_eq_u32 s81, 9
    s_cselect_b32 s81, 0, s81
    s_mul_i32 s49, s81, 589824
    s_lshl_b32 s58, s81, 7
    s_add_u32 s58, s58, s82
    v_mfma_f32_16x16x32_bf16 v[60:63], v[36:39], v[124:127], v[60:63]
    v_mfma_f32_16x16x32_bf16 v[104:107], v[88:91], v[116:119], 0
    s_add_u32 m0, s42, 131072
    s_nop 0
    buffer_load_dwordx4 v6, s[4:7], s58 offen lds
    v_mfma_f32_16x16x32_bf16 v[108:111], v[88:91], v[124:127], 0
    s_waitcnt vmcnt(7)
    s_barrier
    s_setprio 3
    s_waitcnt lgkmcnt(4)
    v_mfma_f32_16x16x32_bf16 v[48:51], v[40:43], v[128:131], v[48:51]
    s_mov_b32 s28, s68
    s_mov_b32 s29, s69
    s_mov_b32 s30, 0x2400
    s_mov_b32 s31, 0x20000
    s_mov_b32 s32, s72
    s_mov_b32 s33, s73
    s_mov_b32 s34, 0x480
    s_mov_b32 s35, 0x20000
    s_mov_b32 m0, 4096
    s_nop 0
    buffer_load_dwordx4 v100, s[28:31], s83 offen lds
    s_mov_b32 m0, 5120
    s_nop 0
    buffer_load_dwordx4 v100, s[32:35], s43 offen lds
    s_mov_b32 s12, s70
    s_mov_b32 s13, s71
    s_mov_b32 s14, 0x510000
    s_mov_b32 s15, 0x20000
    s_mov_b32 s20, s74
    s_mov_b32 s21, s75
    s_mov_b32 s22, 0x240000
    s_mov_b32 s23, 0x20000
    s_mov_b32 s64, s3
    s_cmp_ge_u32 s37, 2
    s_cselect_b64 vcc, -1, 0
    ds_read_b128 v[144:147], v101 offset:57344
    ds_read_b128 v[148:151], v102 offset:57344
    v_mfma_f32_16x16x32_bf16 v[48:51], v[44:47], v[132:135], v[48:51]
    s_lshl2_add_u32 s62, s39, s40
    s_lshl2_add_u32 s62, s62, s41
    s_lshl_b32 s62, s62, 7
    s_add_u32 s2, s62, 0x2800000
    s_lshl2_add_u32 s62, s39, s41
    s_lshl2_add_u32 s62, s62, s40
    s_lshl_b32 s62, s62, 7
    s_add_u32 s3, s62, 0x2840000
    s_add_u32 s62, s58, 73728
    s_add_u32 m0, s42, 139264
    ds_read_b128 v[152:155], v101 offset:59392
    buffer_load_dwordx4 v6, s[4:7], s62 offen lds
    ds_read_b128 v[156:159], v102 offset:59392
    v_mfma_f32_16x16x32_bf16 v[52:55], v[40:43], v[136:139], v[52:55]
    v_add_u32 v1, 0x12000, v1
    ds_read_b64_tr_b16 v[32:33], v1 offset:0
    ds_read_b64_tr_b16 v[34:35], v1 offset:256
    v_mfma_f32_16x16x32_bf16 v[52:55], v[44:47], v[140:143], v[52:55]
    v_add_u32 v2, 0x12000, v2
    ds_read_b64_tr_b16 v[36:37], v2 offset:0
    ds_read_b64_tr_b16 v[38:39], v2 offset:256
    v_mfma_f32_16x16x32_bf16 v[92:95], v[88:91], v[40:43], v[92:95]
    s_add_u32 m0, s42, 147456
    s_nop 0
    buffer_load_dwordx4 v5, s[8:11], s49 offen lds
    v_mfma_f32_16x16x32_bf16 v[80:83], v[128:131], v[128:131], v[80:83]
    s_add_u32 s81, s81, 1
    s_cmp_eq_u32 s81, 9
    s_cselect_b32 s81, 0, s81
    s_mul_i32 s50, s81, 589824
    s_lshl_b32 s59, s81, 7
    s_add_u32 s59, s59, s82
    v_mfma_f32_16x16x32_bf16 v[84:87], v[136:139], v[136:139], v[84:87]
    s_setprio 1
    s_waitcnt lgkmcnt(8)
    v_mfma_f32_16x16x32_bf16 v[56:59], v[24:27], v[128:131], v[56:59]
    s_add_u32 m0, s42, 8192
    v_add_u32 v3, 0x12000, v3
    ds_read_b64_tr_b16 v[40:41], v3 offset:0
    buffer_load_dwordx4 v6, s[4:7], s59 offen lds
    ds_read_b64_tr_b16 v[42:43], v3 offset:256
    v_mfma_f32_16x16x32_bf16 v[56:59], v[28:31], v[132:135], v[56:59]
    v_add_u32 v4, 0x12000, v4
    ds_read_b64_tr_b16 v[44:45], v4 offset:0
    ds_read_b64_tr_b16 v[46:47], v4 offset:256
    v_mfma_f32_16x16x32_bf16 v[60:63], v[24:27], v[136:139], v[60:63]
    v_mfma_f32_16x16x32_bf16 v[60:63], v[28:31], v[140:143], v[60:63]
    s_add_u32 s62, s59, 73728
    s_add_u32 m0, s42, 16384
    s_nop 0
    buffer_load_dwordx4 v6, s[4:7], s62 offen lds
    v_mfma_f32_16x16x32_bf16 v[104:107], v[88:91], v[132:135], v[104:107]
    v_mfma_f32_16x16x32_bf16 v[108:111], v[88:91], v[140:143], v[108:111]
    s_waitcnt vmcnt(10)
    s_barrier
    s_setprio 3
    s_waitcnt lgkmcnt(4)
    v_mfma_f32_16x16x32_bf16 v[48:51], v[32:35], v[144:147], v[48:51]
    s_lshl_b32 s67, s38, 8
    s_add_u32 s67, s67, 1024
    s_lshl2_add_u32 s66, s37, s67
    s_lshr_b32 s62, s37, 1
    s_lshl3_add_u32 s67, s62, s67
    s_lshl1_add_u32 s79, s38, s62
    s_lshl_b32 s79, s79, 5
    s_add_u32 s79, s79, 4096
    s_add_u32 m0, s42, 24576
    v_add_u32 v101, 0x14000, v101
    ds_read_b128 v[160:163], v101 offset:0
    buffer_load_dwordx4 v5, s[8:11], s50 offen lds
    v_add_u32 v102, 0x14000, v102
    ds_read_b128 v[164:167], v102 offset:0
    v_mfma_f32_16x16x32_bf16 v[48:51], v[36:39], v[148:151], v[48:51]
    s_mul_i32 s62, s40, 36
    s_add_u32 s62, s62, s38
    s_mul_i32 s63, s39, 144
    s_add_u32 s62, s62, s63
    s_lshl2_add_u32 s62, s62, s37
    s_lshl_b32 s65, s62, 11
    s_mul_i32 s76, s40, 1327104
    s_add_u32 s81, s81, 1
    s_cmp_eq_u32 s81, 9
    s_cselect_b32 s81, 0, s81
    s_mul_i32 s51, s81, 589824
    s_lshl_b32 s60, s81, 7
    s_add_u32 s60, s60, s82
    ds_read_b128 v[168:171], v101 offset:2048
    ds_read_b128 v[172:175], v102 offset:2048
    v_mfma_f32_16x16x32_bf16 v[52:55], v[32:35], v[152:155], v[52:55]
    ds_read_b64_tr_b16 v[24:25], v1 offset:24576
    ds_read_b64_tr_b16 v[26:27], v1 offset:24832
    v_mfma_f32_16x16x32_bf16 v[52:55], v[36:39], v[156:159], v[52:55]
    s_add_u32 m0, s42, 32768
    ds_read_b64_tr_b16 v[28:29], v2 offset:24576
    buffer_load_dwordx4 v6, s[4:7], s60 offen lds
    ds_read_b64_tr_b16 v[30:31], v2 offset:24832
    v_mfma_f32_16x16x32_bf16 v[92:95], v[88:91], v[32:35], v[92:95]
    v_mfma_f32_16x16x32_bf16 v[80:83], v[144:147], v[144:147], v[80:83]
    v_mfma_f32_16x16x32_bf16 v[84:87], v[152:155], v[152:155], v[84:87]
    s_add_u32 s62, s60, 73728
    s_add_u32 m0, s42, 40960
    s_nop 0
    buffer_load_dwordx4 v6, s[4:7], s62 offen lds
    s_setprio 1
    s_waitcnt lgkmcnt(8)
    v_mfma_f32_16x16x32_bf16 v[56:59], v[40:43], v[144:147], v[56:59]
    ds_read_b64_tr_b16 v[32:33], v3 offset:24576
    ds_read_b64_tr_b16 v[34:35], v3 offset:24832
    v_mfma_f32_16x16x32_bf16 v[56:59], v[44:47], v[148:151], v[56:59]
    ds_read_b64_tr_b16 v[36:37], v4 offset:24576
    ds_read_b64_tr_b16 v[38:39], v4 offset:24832
    v_mfma_f32_16x16x32_bf16 v[60:63], v[40:43], v[152:155], v[60:63]
    s_add_u32 m0, s42, 49152
    s_nop 0
    buffer_load_dwordx4 v5, s[8:11], s51 offen lds
    v_mfma_f32_16x16x32_bf16 v[60:63], v[44:47], v[156:159], v[60:63]
    v_mfma_f32_16x16x32_bf16 v[104:107], v[88:91], v[148:151], v[104:107]
    v_mfma_f32_16x16x32_bf16 v[108:111], v[88:91], v[156:159], v[108:111]
    s_waitcnt vmcnt(11)
    s_barrier
    s_setprio 3
    s_waitcnt lgkmcnt(4)
    v_mfma_f32_16x16x32_bf16 v[48:51], v[24:27], v[160:163], v[48:51]
    s_mov_b32 s62, s41
    s_cmp_eq_u32 s62, 3
    s_cselect_b32 s63, 1, 0
    s_lshl2_add_u32 s62, s62, s63
    s_lshl_b32 s72, s62, 14
    s_add_u32 s72, s72, s65
    s_mul_i32 s68, s62, 73728
    s_add_u32 s68, s68, s76
    s_xor_b32 s62, s41, 1
    s_cmp_eq_u32 s62, 3
    s_cselect_b32 s63, 1, 0
    s_lshl2_add_u32 s62, s62, s63
    s_lshl_b32 s73, s62, 14
    s_add_u32 s73, s73, s65
    s_mul_i32 s69, s62, 73728
    s_add_u32 s69, s69, s76
    s_add_u32 s81, s81, 1
    s_cmp_eq_u32 s81, 9
    s_cselect_b32 s81, 0, s81
    s_mul_i32 s52, s81, 589824
    s_lshl_b32 s61, s81, 7
    s_add_u32 s61, s61, s82
    ds_read_b128 v[176:179], v101 offset:24576
    ds_read_b128 v[180:183], v102 offset:24576
    v_mfma_f32_16x16x32_bf16 v[48:51], v[28:31], v[164:167], v[48:51]
    s_xor_b32 s62, s41, 2
    s_and_b32 s62, s62, 2
    s_cmp_eq_u32 s62, 3
    s_cselect_b32 s63, 1, 0
    s_lshl2_add_u32 s62, s62, s63
    s_lshl_b32 s74, s62, 14
    s_add_u32 s74, s74, s65
    s_mul_i32 s70, s62, 73728
    s_add_u32 s70, s70, s76
    s_add_u32 m0, s42, 57344
    ds_read_b128 v[184:187], v101 offset:26624
    buffer_load_dwordx4 v6, s[4:7], s61 offen lds
    ds_read_b128 v[188:191], v102 offset:26624
    v_mfma_f32_16x16x32_bf16 v[52:55], v[24:27], v[168:171], v[52:55]
    ds_read_b64_tr_b16 v[40:41], v1 offset:49152
    ds_read_b64_tr_b16 v[42:43], v1 offset:49408
    v_mfma_f32_16x16x32_bf16 v[52:55], v[28:31], v[172:175], v[52:55]
    ds_read_b64_tr_b16 v[44:45], v2 offset:49152
    ds_read_b64_tr_b16 v[46:47], v2 offset:49408
    v_mfma_f32_16x16x32_bf16 v[92:95], v[88:91], v[24:27], v[92:95]
    s_add_u32 s62, s61, 73728
    s_add_u32 m0, s42, 65536
    s_nop 0
    buffer_load_dwordx4 v6, s[4:7], s62 offen lds
    v_mfma_f32_16x16x32_bf16 v[80:83], v[160:163], v[160:163], v[80:83]
    v_mfma_f32_16x16x32_bf16 v[84:87], v[168:171], v[168:171], v[84:87]
    s_setprio 1
    s_waitcnt lgkmcnt(8)
    v_mfma_f32_16x16x32_bf16 v[56:59], v[32:35], v[160:163], v[56:59]
    s_add_u32 m0, s42, 73728
    ds_read_b64_tr_b16 v[24:25], v3 offset:49152
    buffer_load_dwordx4 v5, s[8:11], s52 offen lds
    ds_read_b64_tr_b16 v[26:27], v3 offset:49408
    v_mfma_f32_16x16x32_bf16 v[56:59], v[36:39], v[164:167], v[56:59]
    ds_read_b64_tr_b16 v[28:29], v4 offset:49152
    ds_read_b64_tr_b16 v[30:31], v4 offset:49408
    v_mfma_f32_16x16x32_bf16 v[60:63], v[32:35], v[168:171], v[60:63]
    v_mfma_f32_16x16x32_bf16 v[60:63], v[36:39], v[172:175], v[60:63]
    v_mfma_f32_16x16x32_bf16 v[104:107], v[88:91], v[164:167], v[104:107]
    v_mfma_f32_16x16x32_bf16 v[108:111], v[88:91], v[172:175], v[108:111]
    s_waitcnt vmcnt(9)
    s_barrier
    s_setprio 3
    s_waitcnt lgkmcnt(4)
    v_mfma_f32_16x16x32_bf16 v[48:51], v[40:43], v[176:179], v[48:51]
    s_xor_b32 s62, s41, 2
    s_and_b32 s62, s62, 2
    s_add_u32 s62, s62, 1
    s_cmp_eq_u32 s62, 3
    s_cselect_b32 s63, 1, 0
    s_lshl2_add_u32 s62, s62, s63
    s_lshl_b32 s75, s62, 14
    s_add_u32 s75, s75, s65
    s_mul_i32 s71, s62, 73728
    s_add_u32 s71, s71, s76
    s_mov_b32 s65, s72
    s_lshl2_add_u32 s62, s39, s41
    s_mul_i32 s62, s62, 160
    s_lshl3_add_u32 s62, s37, s62
    s_add_u32 s62, s62, s38
    s_lshl_b32 s62, s62, 11
    s_add_u32 s76, s62, 0x1200000
    v_add_u32 v5, 128, v5
    s_add_u32 m0, s42, 155648
    ds_read_b128 v[192:195], v101 offset:49152
    buffer_load_dwordx4 v5, s[8:11], s44 offen lds
    ds_read_b128 v[196:199], v102 offset:49152
    v_mfma_f32_16x16x32_bf16 v[48:51], v[44:47], v[180:183], v[48:51]
    v_bfe_u32 v64, v0, 4, 1
    v_lshlrev_b32 v64, 1, v64
    v_and_b32 v65, 3, v0
    v_xor_b32 v64, v64, v65
    s_and_b32 s62, s37, 1
    s_lshl1_add_u32 s62, s38, s62
    s_lshl_b32 s62, s62, 4
    v_lshrrev_b32 v65, 2, v0
    v_add_u32 v65, s62, v65
    v_mul_u32_u24 v7, 1152, v65
    v_lshl_add_u32 v7, v64, 4, v7
    ds_read_b128 v[200:203], v101 offset:51200
    ds_read_b128 v[204:207], v102 offset:51200
    v_mfma_f32_16x16x32_bf16 v[52:55], v[40:43], v[184:187], v[52:55]
    v_add_u32 v1, 0x12000, v1
    ds_read_b64_tr_b16 v[32:33], v1 offset:0
    ds_read_b64_tr_b16 v[34:35], v1 offset:256
    v_mfma_f32_16x16x32_bf16 v[52:55], v[44:47], v[188:191], v[52:55]
    s_add_u32 m0, s42, 81920
    v_add_u32 v2, 0x12000, v2
    ds_read_b64_tr_b16 v[36:37], v2 offset:0
    buffer_load_dwordx4 v5, s[8:11], s45 offen lds
    ds_read_b64_tr_b16 v[38:39], v2 offset:256
    v_mfma_f32_16x16x32_bf16 v[92:95], v[88:91], v[40:43], v[92:95]
    v_mfma_f32_16x16x32_bf16 v[80:83], v[176:179], v[176:179], v[80:83]
    v_mfma_f32_16x16x32_bf16 v[84:87], v[184:187], v[184:187], v[84:87]
    s_add_u32 m0, s42, 90112
    s_nop 0
    buffer_load_dwordx4 v5, s[8:11], s46 offen lds
    s_setprio 1
    s_waitcnt lgkmcnt(8)
    v_mfma_f32_16x16x32_bf16 v[56:59], v[24:27], v[176:179], v[56:59]
    v_add_u32 v3, 0x12000, v3
    ds_read_b64_tr_b16 v[40:41], v3 offset:0
    ds_read_b64_tr_b16 v[42:43], v3 offset:256
    v_mfma_f32_16x16x32_bf16 v[56:59], v[28:31], v[180:183], v[56:59]
    v_add_u32 v4, 0x12000, v4
    ds_read_b64_tr_b16 v[44:45], v4 offset:0
    ds_read_b64_tr_b16 v[46:47], v4 offset:256
    v_mfma_f32_16x16x32_bf16 v[60:63], v[24:27], v[184:187], v[60:63]
    v_mfma_f32_16x16x32_bf16 v[60:63], v[28:31], v[188:191], v[60:63]
    v_mfma_f32_16x16x32_bf16 v[104:107], v[88:91], v[180:183], v[104:107]
    v_mfma_f32_16x16x32_bf16 v[108:111], v[88:91], v[188:191], v[108:111]
    s_waitcnt vmcnt(9)
    s_barrier
    s_setprio 3
    s_waitcnt lgkmcnt(4)
    v_mfma_f32_16x16x32_bf16 v[48:51], v[32:35], v[192:195], v[48:51]
    s_add_u32 m0, s42, 98304
    v_add_u32 v101, 0xfffee000, v101
    ds_read_b128 v[208:211], v101 offset:0
    buffer_load_dwordx4 v5, s[8:11], s47 offen lds
    v_add_u32 v102, 0xfffee000, v102
    ds_read_b128 v[212:215], v102 offset:0
    v_mfma_f32_16x16x32_bf16 v[48:51], v[36:39], v[196:199], v[48:51]
    ds_read_b128 v[216:219], v101 offset:2048
    ds_read_b128 v[220:223], v102 offset:2048
    v_mfma_f32_16x16x32_bf16 v[52:55], v[32:35], v[200:203], v[52:55]
    v_add_u32 v1, 0xfffe2000, v1
    ds_read_b64_tr_b16 v[24:25], v1 offset:0
    ds_read_b64_tr_b16 v[26:27], v1 offset:256
    v_mfma_f32_16x16x32_bf16 v[52:55], v[36:39], v[204:207], v[52:55]
    s_add_u32 m0, s42, 106496
    v_add_u32 v2, 0xfffe2000, v2
    ds_read_b64_tr_b16 v[28:29], v2 offset:0
    buffer_load_dwordx4 v5, s[8:11], s48 offen lds
    ds_read_b64_tr_b16 v[30:31], v2 offset:256
    v_mfma_f32_16x16x32_bf16 v[92:95], v[88:91], v[32:35], v[92:95]
    v_mfma_f32_16x16x32_bf16 v[80:83], v[192:195], v[192:195], v[80:83]
    v_mfma_f32_16x16x32_bf16 v[84:87], v[200:203], v[200:203], v[84:87]
    s_add_u32 m0, s42, 114688
    s_nop 0
    buffer_load_dwordx4 v5, s[8:11], s49 offen lds
    s_setprio 1
    s_waitcnt lgkmcnt(8)
    v_mfma_f32_16x16x32_bf16 v[56:59], v[40:43], v[192:195], v[56:59]
    v_add_u32 v3, 0xfffe2000, v3
    ds_read_b64_tr_b16 v[32:33], v3 offset:0
    ds_read_b64_tr_b16 v[34:35], v3 offset:256
    v_mfma_f32_16x16x32_bf16 v[56:59], v[44:47], v[196:199], v[56:59]
    v_add_u32 v4, 0xfffe2000, v4
    ds_read_b64_tr_b16 v[36:37], v4 offset:0
    ds_read_b64_tr_b16 v[38:39], v4 offset:256
    v_mfma_f32_16x16x32_bf16 v[60:63], v[40:43], v[200:203], v[60:63]
    v_mfma_f32_16x16x32_bf16 v[60:63], v[44:47], v[204:207], v[60:63]
    v_mfma_f32_16x16x32_bf16 v[104:107], v[88:91], v[196:199], v[104:107]
    v_mfma_f32_16x16x32_bf16 v[108:111], v[88:91], v[204:207], v[108:111]
    s_waitcnt vmcnt(9)
    s_barrier
    s_setprio 3
    s_waitcnt lgkmcnt(4)
    v_mfma_f32_16x16x32_bf16 v[48:51], v[24:27], v[208:211], v[48:51]
    buffer_load_dwordx2 v[78:79], off, s[24:27], 0 sc1
    s_add_u32 m0, s42, 122880
    ds_read_b128 v[224:227], v101 offset:24576
    buffer_load_dwordx4 v5, s[8:11], s50 offen lds
    ds_read_b128 v[228:231], v102 offset:24576
    v_mfma_f32_16x16x32_bf16 v[48:51], v[28:31], v[212:215], v[48:51]
    ds_read_b128 v[232:235], v101 offset:26624
    ds_read_b128 v[236:239], v102 offset:26624
    v_mfma_f32_16x16x32_bf16 v[52:55], v[24:27], v[216:219], v[52:55]
    ds_read_b64_tr_b16 v[40:41], v1 offset:24576
    ds_read_b64_tr_b16 v[42:43], v1 offset:24832
    v_mfma_f32_16x16x32_bf16 v[52:55], v[28:31], v[220:223], v[52:55]
    s_add_u32 m0, s42, 131072
    ds_read_b64_tr_b16 v[44:45], v2 offset:24576
    buffer_load_dwordx4 v5, s[8:11], s51 offen lds
    ds_read_b64_tr_b16 v[46:47], v2 offset:24832
    v_mfma_f32_16x16x32_bf16 v[92:95], v[88:91], v[24:27], v[92:95]
    v_mfma_f32_16x16x32_bf16 v[80:83], v[208:211], v[208:211], v[80:83]
    v_mfma_f32_16x16x32_bf16 v[84:87], v[216:219], v[216:219], v[84:87]
    s_add_u32 m0, s42, 139264
    s_nop 0
    buffer_load_dwordx4 v5, s[8:11], s52 offen lds
    s_setprio 1
    s_waitcnt lgkmcnt(8)
    v_mfma_f32_16x16x32_bf16 v[56:59], v[32:35], v[208:211], v[56:59]
    ds_read_b64_tr_b16 v[24:25], v3 offset:24576
    ds_read_b64_tr_b16 v[26:27], v3 offset:24832
    v_mfma_f32_16x16x32_bf16 v[56:59], v[36:39], v[212:215], v[56:59]
    ds_read_b64_tr_b16 v[28:29], v4 offset:24576
    ds_read_b64_tr_b16 v[30:31], v4 offset:24832
    v_mfma_f32_16x16x32_bf16 v[60:63], v[32:35], v[216:219], v[60:63]
    v_mfma_f32_16x16x32_bf16 v[60:63], v[36:39], v[220:223], v[60:63]
    v_mfma_f32_16x16x32_bf16 v[104:107], v[88:91], v[212:215], v[104:107]
    v_mfma_f32_16x16x32_bf16 v[108:111], v[88:91], v[220:223], v[108:111]
    s_waitcnt vmcnt(9)
    s_barrier
    s_setprio 3
    s_waitcnt lgkmcnt(4)
    v_mfma_f32_16x16x32_bf16 v[48:51], v[40:43], v[224:227], v[48:51]
    s_cmp_eq_u32 s41, 1
    s_cselect_b32 s77, 64, 0
    s_add_u32 s82, s77, 256
    s_add_u32 s77, s77, s43
    s_xor_b32 s62, s40, 2
    s_and_b32 s62, s62, 2
    s_lshl_b32 s62, s62, 6
    s_add_u32 s80, s62, s77
    s_xor_b32 s62, s40, 1
    s_lshl_b32 s62, s62, 6
    s_add_u32 s81, s62, s77
    s_lshl_b32 s62, s40, 6
    s_add_u32 s83, s62, s77
    s_cmp_eq_u32 s36, 2
    s_cbranch_scc0 L_dw3
    v_lshlrev_b32 v99, 7, v0
    s_and_b32 s62, s39, 7
    s_lshl2_add_u32 s62, s62, s41
    s_mul_i32 s62, s62, 41472
    s_mul_i32 s63, s40, 1327104
    s_add_u32 s62, s62, s63
    s_add_u32 s62, s62, 0
    s_mov_b32 m0, 512
    s_mov_b32 exec_lo, 0xffffffff
    s_mov_b32 exec_hi, 0x3fffff
    buffer_load_dword v99, s[12:15], s62 offen lds
    s_mov_b64 exec, -1
L_dw3:
    v_add_u32 v5, 128, v5
    s_add_u32 m0, s42, 147456
    ds_read_b128 v[240:243], v101 offset:49152
    buffer_load_dwordx4 v5, s[8:11], s44 offen lds
    ds_read_b128 v[244:247], v102 offset:49152
    v_mfma_f32_16x16x32_bf16 v[48:51], v[44:47], v[228:231], v[48:51]
    ds_read_b128 v[248:251], v101 offset:51200
    ds_read_b128 v[252:255], v102 offset:51200
    v_mfma_f32_16x16x32_bf16 v[52:55], v[40:43], v[232:235], v[52:55]
    ds_read_b64_tr_b16 v[32:33], v1 offset:49152
    ds_read_b64_tr_b16 v[34:35], v1 offset:49408
    v_mfma_f32_16x16x32_bf16 v[52:55], v[44:47], v[236:239], v[52:55]
    s_add_u32 m0, s42, 8192
    ds_read_b64_tr_b16 v[36:37], v2 offset:49152
    buffer_load_dwordx4 v5, s[8:11], s45 offen lds
    ds_read_b64_tr_b16 v[38:39], v2 offset:49408
    v_mfma_f32_16x16x32_bf16 v[92:95], v[88:91], v[40:43], v[92:95]
    v_mfma_f32_16x16x32_bf16 v[80:83], v[224:227], v[224:227], v[80:83]
    v_mfma_f32_16x16x32_bf16 v[84:87], v[232:235], v[232:235], v[84:87]
    s_add_u32 m0, s42, 16384
    s_nop 0
    buffer_load_dwordx4 v5, s[8:11], s46 offen lds
    s_setprio 1
    s_waitcnt lgkmcnt(8)
    v_mfma_f32_16x16x32_bf16 v[56:59], v[24:27], v[224:227], v[56:59]
    ds_read_b64_tr_b16 v[40:41], v3 offset:49152
    ds_read_b64_tr_b16 v[42:43], v3 offset:49408
    v_mfma_f32_16x16x32_bf16 v[56:59], v[28:31], v[228:231], v[56:59]
    ds_read_b64_tr_b16 v[44:45], v4 offset:49152
    ds_read_b64_tr_b16 v[46:47], v4 offset:49408
    v_mfma_f32_16x16x32_bf16 v[60:63], v[24:27], v[232:235], v[60:63]
    v_mfma_f32_16x16x32_bf16 v[60:63], v[28:31], v[236:239], v[60:63]
    v_mfma_f32_16x16x32_bf16 v[104:107], v[88:91], v[228:231], v[104:107]
    v_mfma_f32_16x16x32_bf16 v[108:111], v[88:91], v[236:239], v[108:111]
    s_waitcnt vmcnt(6)
    v_readfirstlane_b32 s96, v78
    v_readfirstlane_b32 s97, v79
    s_nop 2
    s_cmp_eq_u32 s97, 0
    s_cbranch_scc0 L_ok4
    s_mov_b32 s78, 200000
L_sp5:
    s_sleep 1
    buffer_load_dwordx2 v[78:79], off, s[24:27], 0 sc1
    s_waitcnt vmcnt(0)
    v_readfirstlane_b32 s96, v78
    v_readfirstlane_b32 s97, v79
    s_nop 2
    s_cmp_eq_u32 s97, 0
    s_cbranch_scc0 L_ok4
    s_sub_u32 s78, s78, 1
    s_cmp_lg_u32 s78, 0
    s_cbranch_scc1 L_sp5
L_ok4:
    s_nop 1
    s_waitcnt vmcnt(9)
    s_barrier
    s_setprio 3
    s_waitcnt lgkmcnt(4)
    v_mfma_f32_16x16x32_bf16 v[48:51], v[32:35], v[240:243], v[48:51]
    s_cmp_eq_u32 s36, 3
    s_cbranch_scc0 L_dw6
    v_lshlrev_b32 v99, 7, v0
    s_and_b32 s62, s39, 7
    s_lshl2_add_u32 s62, s62, s41
    s_mul_i32 s62, s62, 41472
    s_mul_i32 s63, s40, 1327104
    s_add_u32 s62, s62, s63
    s_add_u32 s62, s62, 6912
    s_mov_b32 m0, 512
    s_mov_b32 exec_lo, 0xffffffff
    s_mov_b32 exec_hi, 0x3fffff
    buffer_load_dword v99, s[12:15], s62 offen lds
    s_mov_b64 exec, -1
L_dw6:
    s_add_u32 m0, s42, 24576
    v_add_u32 v1, 0x20000, v1
    ds_read_b64_tr_b16 v[24:25], v1 offset:0
    buffer_load_dwordx4 v5, s[8:11], s47 offen lds
    ds_read_b64_tr_b16 v[26:27], v1 offset:256
    v_mfma_f32_16x16x32_bf16 v[48:51], v[36:39], v[244:247], v[48:51]
    v_add_u32 v2, 0x20000, v2
    ds_read_b64_tr_b16 v[28:29], v2 offset:0
    ds_read_b64_tr_b16 v[30:31], v2 offset:256
    v_mfma_f32_16x16x32_bf16 v[52:55], v[32:35], v[248:251], v[52:55]
    v_mfma_f32_16x16x32_bf16 v[52:55], v[36:39], v[252:255], v[52:55]
    s_add_u32 m0, s42, 32768
    s_nop 0
    buffer_load_dwordx4 v5, s[8:11], s48 offen lds
    v_mfma_f32_16x16x32_bf16 v[92:95], v[88:91], v[32:35], v[92:95]
    v_mfma_f32_16x16x32_bf16 v[80:83], v[240:243], v[240:243], v[80:83]
    v_mfma_f32_16x16x32_bf16 v[84:87], v[248:251], v[248:251], v[84:87]
    s_add_u32 m0, s42, 40960
    s_nop 0
    buffer_load_dwordx4 v5, s[8:11], s49 offen lds
    s_setprio 1
    s_waitcnt lgkmcnt(4)
    v_mfma_f32_16x16x32_bf16 v[56:59], v[40:43], v[240:243], v[56:59]
    v_add_u32 v3, 0x20000, v3
    ds_read_b64_tr_b16 v[32:33], v3 offset:0
    ds_read_b64_tr_b16 v[34:35], v3 offset:256
    v_mfma_f32_16x16x32_bf16 v[56:59], v[44:47], v[244:247], v[56:59]
    v_add_u32 v4, 0x20000, v4
    ds_read_b64_tr_b16 v[36:37], v4 offset:0
    ds_read_b64_tr_b16 v[38:39], v4 offset:256
    v_mfma_f32_16x16x32_bf16 v[60:63], v[40:43], v[248:251], v[60:63]
    v_mfma_f32_16x16x32_bf16 v[60:63], v[44:47], v[252:255], v[60:63]
    v_mfma_f32_16x16x32_bf16 v[104:107], v[88:91], v[244:247], v[104:107]
    v_mfma_f32_16x16x32_bf16 v[108:111], v[88:91], v[252:255], v[108:111]
    s_mov_b32 s54, 0xaaaaaaaa
    s_mov_b32 s55, 0xaaaaaaaa
    s_mov_b32 s56, 0xcccccccc
    s_mov_b32 s57, 0xcccccccc
    s_mov_b32 s58, 0xf0000f
    s_mov_b32 s59, 0xf0000f00
    v_and_b32 v98, 15, v0
    s_lshl_b32 s62, s36, 8
    s_add_u32 s62, s62, 2048
    v_lshl_add_u32 v98, v98, 3, s62
    v_cndmask_b32 v80, v80, v81, s[54:55]
    v_cndmask_b32 v82, v82, v83, s[54:55]
    v_cndmask_b32 v105, v80, v82, s[56:57]
    v_cndmask_b32 v84, v84, v85, s[54:55]
    v_cndmask_b32 v86, v86, v87, s[54:55]
    v_cndmask_b32 v109, v84, v86, s[56:57]
    s_mov_b64 exec, s[58:59]
    ds_write_b64 v98, v[104:105] offset:0
    ds_write_b64 v98, v[108:109] offset:128
    s_mov_b64 exec, -1
    v_and_b32 v99, 15, v0
    v_lshl_add_u32 v99, v99, 4, s66
    ds_write_b32 v99, v92 offset:0
    s_waitcnt lgkmcnt(0)
    s_waitcnt vmcnt(9)
    s_barrier
    s_setprio 3
    v_mfma_f32_16x16x32_bf16 v[64:67], v[24:27], v[112:115], 0
    s_cmp_eq_u32 s36, 4
    s_cbranch_scc0 L_dw7
    v_lshlrev_b32 v99, 7, v0
    s_and_b32 s62, s39, 7
    s_lshl2_add_u32 s62, s62, s41
    s_mul_i32 s62, s62, 41472
    s_mul_i32 s63, s40, 1327104
    s_add_u32 s62, s62, s63
    s_add_u32 s62, s62, 13824
    s_mov_b32 m0, 512
    s_mov_b32 exec_lo, 0xffffffff
    s_mov_b32 exec_hi, 0x3fffff
    buffer_load_dword v99, s[12:15], s62 offen lds
    s_mov_b64 exec, -1
L_dw7:
    v_bfe_u32 v106, v0, 2, 3
    v_lshl_add_u32 v106, s36, 3, v106
    v_mul_u32_u24 v6, 1152, v106
    v_lshrrev_b32 v106, 5, v0
    s_add_u32 m0, s42, 49152
    v_add_u32 v1, 0xfffee000, v1
    ds_read_b64_tr_b16 v[40:41], v1 offset:0
    buffer_load_dwordx4 v5, s[8:11], s50 offen lds
    v_mfma_f32_16x16x32_bf16 v[64:67], v[28:31], v[116:119], v[64:67]
    v_lshl_add_u32 v6, v106, 6, v6
    v_bfe_u32 v106, v0, 4, 1
    ds_read_b64_tr_b16 v[42:43], v1 offset:256
    v_mfma_f32_16x16x32_bf16 v[68:71], v[24:27], v[120:123], 0
    v_lshlrev_b32 v106, 1, v106
    v_and_b32 v107, 3, v0
    v_xor_b32 v106, v106, v107
    v_lshl_add_u32 v6, v106, 4, v6
    v_add_u32 v2, 0xfffee000, v2
    ds_read_b64_tr_b16 v[44:45], v2 offset:0
    v_mfma_f32_16x16x32_bf16 v[68:71], v[28:31], v[124:127], v[68:71]
    v_and_b32 v98, 15, v0
    s_lshl_b32 s63, s37, 8
    s_add_u32 s63, s63, 2048
    v_lshl_add_u32 v98, v98, 3, s63
    ds_read2_b64 v[80:83], v98 offset0:0 offset1:128
    ds_read2_b64 v[84:87], v98 offset0:16 offset1:144
    ds_read_b64_tr_b16 v[46:47], v2 offset:256
    v_mfma_f32_16x16x32_bf16 v[92:95], v[88:91], v[24:27], 0
    s_mov_b32 s54, 0xffff
    s_mov_b32 s55, 0x0
    s_mov_b32 s56, 0xffff0000
    s_mov_b32 s57, 0x0
    v_mfma_f32_16x16x32_bf16 v[72:75], v[32:35], v[112:115], 0
    v_add_u32 v3, 0xfffee000, v3
    ds_read_b64_tr_b16 v[24:25], v3 offset:0
    v_mfma_f32_16x16x32_bf16 v[72:75], v[36:39], v[116:119], v[72:75]
    ds_read_b64_tr_b16 v[26:27], v3 offset:256
    v_mfma_f32_16x16x32_bf16 v[76:79], v[32:35], v[120:123], 0
    s_waitcnt lgkmcnt(4)
    v_add_f32 v80, v80, v82
    v_add_f32 v81, v81, v83
    v_mul_f32 v80, 0xbae38e39, v80
    v_mul_f32 v81, 0x3ae38e39, v81
    s_add_u32 m0, s42, 57344
    v_add_u32 v4, 0xfffee000, v4
    ds_read_b64_tr_b16 v[28:29], v4 offset:0
    buffer_load_dwordx4 v5, s[8:11], s51 offen lds
    v_mfma_f32_16x16x32_bf16 v[76:79], v[36:39], v[124:127], v[76:79]
    v_fma_f32 v81, -v80, v80, v81
    v_max_f32 v81, 0, v81
    v_add_f32 v81, 0x3727c5ac, v81
    ds_read_b64_tr_b16 v[30:31], v4 offset:256
    s_setprio 2
    s_waitcnt lgkmcnt(4)
    v_mfma_f32_16x16x32_bf16 v[64:67], v[40:43], v[128:131], v[64:67]
    v_sqrt_f32 v18, v81
    ds_read_b64_tr_b16 v[32:33], v1 offset:8192
    v_mfma_f32_16x16x32_bf16 v[64:67], v[44:47], v[132:135], v[64:67]
    v_rsq_f32 v82, v81
    v_cvt_pk_bf16_f32 v104, v80, v80
    v_mul_f32 v16, 0xc0135761, v82
    ds_read_b64_tr_b16 v[34:35], v1 offset:8448
    v_mfma_f32_16x16x32_bf16 v[68:71], v[40:43], v[136:139], v[68:71]
    v_mul_f32 v83, v82, v82
    v_lshlrev_b32 v105, 16, v104
    v_mul_f32 v83, v83, v82
    v_sub_f32 v105, v80, v105
    ds_read_b64_tr_b16 v[36:37], v2 offset:8192
    v_mfma_f32_16x16x32_bf16 v[68:71], v[44:47], v[140:143], v[68:71]
    v_mul_f32 v17, 0xbdd2d3e8, v83
    v_cvt_pk_bf16_f32 v106, v105, v18
    v_and_b32 v107, 0xffff0000, v106
    ds_read_b64_tr_b16 v[38:39], v2 offset:8448
    v_mfma_f32_16x16x32_bf16 v[92:95], v[88:91], v[40:43], v[92:95]
    v_sub_f32 v107, v18, v107
    v_cvt_pk_bf16_f32 v107, 0, v107
    v_cndmask_b32 v8, 0, v104, s[54:55]
    v_cndmask_b32 v9, 0, v107, s[56:57]
    s_setprio 1
    s_waitcnt lgkmcnt(4)
    v_mfma_f32_16x16x32_bf16 v[72:75], v[24:27], v[128:131], v[72:75]
    v_cndmask_b32 v9, v9, v106, s[54:55]
    v_add_f32 v84, v84, v86
    v_add_f32 v85, v85, v87
    s_add_u32 m0, s42, 65536
    ds_read_b64_tr_b16 v[40:41], v3 offset:8192
    buffer_load_dwordx4 v5, s[8:11], s52 offen lds
    v_mfma_f32_16x16x32_bf16 v[72:75], v[28:31], v[132:135], v[72:75]
    v_mul_f32 v84, 0xbae38e39, v84
    v_mul_f32 v85, 0x3ae38e39, v85
    v_fma_f32 v85, -v84, v84, v85
    v_max_f32 v85, 0, v85
    ds_read_b64_tr_b16 v[42:43], v3 offset:8448
    v_mfma_f32_16x16x32_bf16 v[76:79], v[24:27], v[136:139], v[76:79]
    v_add_f32 v85, 0x3727c5ac, v85
    v_sqrt_f32 v21, v85
    ds_read_b64_tr_b16 v[44:45], v4 offset:8192
    v_mfma_f32_16x16x32_bf16 v[76:79], v[28:31], v[140:143], v[76:79]
    v_rsq_f32 v86, v85
    v_cvt_pk_bf16_f32 v108, v84, v84
    v_mul_f32 v19, 0xc0135761, v86
    ds_read_b64_tr_b16 v[46:47], v4 offset:8448
    s_waitcnt lgkmcnt(4)
    v_mfma_f32_16x16x32_bf16 v[64:67], v[32:35], v[144:147], v[64:67]
    v_mul_f32 v87, v86, v86
    v_lshlrev_b32 v109, 16, v108
    v_mul_f32 v87, v87, v86
    ds_read_b64_tr_b16 v[24:25], v1 offset:16384
    v_mfma_f32_16x16x32_bf16 v[64:67], v[36:39], v[148:151], v[64:67]
    v_sub_f32 v109, v84, v109
    v_mul_f32 v20, 0xbdd2d3e8, v87
    v_cvt_pk_bf16_f32 v110, v109, v21
    v_and_b32 v111, 0xffff0000, v110
    ds_read_b64_tr_b16 v[26:27], v1 offset:16640
    v_mfma_f32_16x16x32_bf16 v[68:71], v[32:35], v[152:155], v[68:71]
    v_sub_f32 v111, v21, v111
    v_cvt_pk_bf16_f32 v111, 0, v111
    v_cndmask_b32 v10, 0, v108, s[54:55]
    ds_read_b64_tr_b16 v[28:29], v2 offset:16384
    v_mfma_f32_16x16x32_bf16 v[68:71], v[36:39], v[156:159], v[68:71]
    v_cndmask_b32 v11, 0, v111, s[56:57]
    v_cndmask_b32 v11, v11, v110, s[54:55]
    v_and_b32 v96, 15, v0
    v_lshl_add_u32 v22, v96, 4, s67
    ds_read_b64 v[12:13], v22 offset:0
    v_add_u32 v5, 128, v5
    s_add_u32 m0, s42, 73728
    ds_read_b64_tr_b16 v[30:31], v2 offset:16640
    buffer_load_dwordx4 v5, s[8:11], s44 offen lds
    v_mfma_f32_16x16x32_bf16 v[92:95], v[88:91], v[32:35], v[92:95]
    v_xor_b32 v22, 8, v22
    ds_read_b64 v[14:15], v22 offset:0
    v_lshl_add_u32 v96, v96, 1, s79
    ds_read_u16 v22, v96 offset:0
    v_xor_b32 v96, 32, v96
    s_setprio 0
    s_waitcnt lgkmcnt(7)
    v_mfma_f32_16x16x32_bf16 v[72:75], v[40:43], v[144:147], v[72:75]
    ds_read_u16 v96, v96 offset:0
    ds_read_b64_tr_b16 v[32:33], v3 offset:16384
    v_mfma_f32_16x16x32_bf16 v[72:75], v[44:47], v[148:151], v[72:75]
    ds_read_b64_tr_b16 v[34:35], v3 offset:16640
    v_mfma_f32_16x16x32_bf16 v[76:79], v[40:43], v[152:155], v[76:79]
    ds_read_b64_tr_b16 v[36:37], v4 offset:16384
    v_mfma_f32_16x16x32_bf16 v[76:79], v[44:47], v[156:159], v[76:79]
    ds_read_b64_tr_b16 v[38:39], v4 offset:16640
    s_waitcnt vmcnt(10)
    s_barrier
    s_setprio 3
    s_waitcnt lgkmcnt(7)
    v_mfma_f32_16x16x32_bf16 v[64:67], v[24:27], v[160:163], v[64:67]
    v_add_f32 v12, v12, v13
    s_waitcnt lgkmcnt(6)
    v_add_f32 v14, v14, v15
    s_waitcnt lgkmcnt(5)
    v_lshlrev_b32 v22, 16, v22
    s_waitcnt lgkmcnt(4)
    v_lshlrev_b32 v96, 16, v96
    ds_read_b64_tr_b16 v[40:41], v1 offset:24576
    v_mfma_f32_16x16x32_bf16 v[64:67], v[28:31], v[164:167], v[64:67]
    v_cvt_pk_bf16_f32 v23, v12, v22
    v_cvt_pk_bf16_f32 v97, v14, v96
    v_lshlrev_b32 v13, 16, v23
    v_lshlrev_b32 v15, 16, v97
    s_add_u32 m0, s42, 155648
    ds_read_b64_tr_b16 v[42:43], v1 offset:24832
    buffer_load_dwordx4 v5, s[8:11], s45 offen lds
    v_mfma_f32_16x16x32_bf16 v[68:71], v[24:27], v[168:171], v[68:71]
    v_sub_f32 v12, v12, v13
    v_sub_f32 v14, v14, v15
    v_cvt_pk_bf16_f32 v22, v13, v12
    ds_read_b64_tr_b16 v[44:45], v2 offset:24576
    v_mfma_f32_16x16x32_bf16 v[68:71], v[28:31], v[172:175], v[68:71]
    v_cvt_pk_bf16_f32 v96, v15, v14
    ds_read_b64_tr_b16 v[46:47], v2 offset:24832
    v_mfma_f32_16x16x32_bf16 v[92:95], v[88:91], v[24:27], v[92:95]
    v_mfma_f32_16x16x16_bf16 v[48:51], v[22:23], v[8:9], v[48:51]
    v_mfma_f32_16x16x16_bf16 v[52:55], v[22:23], v[10:11], v[52:55]
    v_mfma_f32_16x16x16_bf16 v[56:59], v[96:97], v[8:9], v[56:59]
    v_mfma_f32_16x16x16_bf16 v[60:63], v[96:97], v[10:11], v[60:63]
    s_waitcnt lgkmcnt(4)
    v_mfma_f32_16x16x32_bf16 v[72:75], v[32:35], v[160:163], v[72:75]
    ds_read_b64_tr_b16 v[24:25], v3 offset:24576
    v_mfma_f32_16x16x32_bf16 v[72:75], v[36:39], v[164:167], v[72:75]
    s_nop 0
    v_mul_f32 v12, v48, v48
    v_mul_f32 v13, v49, v49
    v_mul_f32 v14, v50, v50
    v_mul_f32 v15, v51, v51
    ds_read_b64_tr_b16 v[26:27], v3 offset:24832
    v_mfma_f32_16x16x32_bf16 v[76:79], v[32:35], v[168:171], v[76:79]
    v_fma_f32 v12, v12, v17, v16
    v_fma_f32 v13, v13, v17, v16
    v_fma_f32 v14, v14, v17, v16
    ds_read_b64_tr_b16 v[28:29], v4 offset:24576
    v_mfma_f32_16x16x32_bf16 v[76:79], v[36:39], v[172:175], v[76:79]
    v_fma_f32 v15, v15, v17, v16
    v_mul_f32 v12, v48, v12
    v_mul_f32 v13, v49, v13
    v_mul_f32 v14, v50, v14
    s_add_u32 m0, s42, 81920
    ds_read_b64_tr_b16 v[30:31], v4 offset:24832
    buffer_load_dwordx4 v5, s[8:11], s46 offen lds
    s_setprio 2
    s_waitcnt lgkmcnt(4)
    v_mfma_f32_16x16x32_bf16 v[64:67], v[40:43], v[176:179], v[64:67]
    v_mul_f32 v15, v51, v15
    v_exp_f32 v12, v12
    ds_read_b64_tr_b16 v[32:33], v1 offset:32768
    v_mfma_f32_16x16x32_bf16 v[64:67], v[44:47], v[180:183], v[64:67]
    v_exp_f32 v13, v13
    v_exp_f32 v14, v14
    ds_read_b64_tr_b16 v[34:35], v1 offset:33024
    v_mfma_f32_16x16x32_bf16 v[68:71], v[40:43], v[184:187], v[68:71]
    v_exp_f32 v15, v15
    v_fma_f32 v12, v12, v18, v18
    ds_read_b64_tr_b16 v[36:37], v2 offset:32768
    v_mfma_f32_16x16x32_bf16 v[68:71], v[44:47], v[188:191], v[68:71]
    v_fma_f32 v13, v13, v18, v18
    v_fma_f32 v14, v14, v18, v18
    v_fma_f32 v15, v15, v18, v18
    ds_read_b64_tr_b16 v[38:39], v2 offset:33024
    v_mfma_f32_16x16x32_bf16 v[92:95], v[88:91], v[40:43], v[92:95]
    v_rcp_f32 v12, v12
    v_rcp_f32 v13, v13
    s_setprio 1
    s_waitcnt lgkmcnt(4)
    v_mfma_f32_16x16x32_bf16 v[72:75], v[24:27], v[176:179], v[72:75]
    v_rcp_f32 v14, v14
    ds_read_b64_tr_b16 v[40:41], v3 offset:32768
    v_mfma_f32_16x16x32_bf16 v[72:75], v[28:31], v[180:183], v[72:75]
    v_rcp_f32 v15, v15
    v_mul_f32 v48, v48, v12
    v_mul_f32 v49, v49, v13
    s_add_u32 m0, s42, 90112
    ds_read_b64_tr_b16 v[42:43], v3 offset:33024
    buffer_load_dwordx4 v5, s[8:11], s47 offen lds
    v_mfma_f32_16x16x32_bf16 v[76:79], v[24:27], v[184:187], v[76:79]
    v_mul_f32 v50, v50, v14
    v_mul_f32 v51, v51, v15
    v_cvt_pk_bf16_f32 v80, v48, v49
    ds_read_b64_tr_b16 v[44:45], v4 offset:32768
    v_mfma_f32_16x16x32_bf16 v[76:79], v[28:31], v[188:191], v[76:79]
    v_cvt_pk_bf16_f32 v81, v50, v51
    v_mul_f32 v12, v56, v56
    v_mul_f32 v13, v57, v57
    v_mul_f32 v14, v58, v58
    ds_read_b64_tr_b16 v[46:47], v4 offset:33024
    s_waitcnt lgkmcnt(4)
    v_mfma_f32_16x16x32_bf16 v[64:67], v[32:35], v[192:195], v[64:67]
    v_mul_f32 v15, v59, v59
    v_fma_f32 v12, v12, v17, v16
    v_fma_f32 v13, v13, v17, v16
    ds_read_b64_tr_b16 v[24:25], v1 offset:40960
    v_mfma_f32_16x16x32_bf16 v[64:67], v[36:39], v[196:199], v[64:67]
    v_fma_f32 v14, v14, v17, v16
    v_fma_f32 v15, v15, v17, v16
    v_mul_f32 v12, v56, v12
    v_mul_f32 v13, v57, v13
    ds_read_b64_tr_b16 v[26:27], v1 offset:41216
    v_mfma_f32_16x16x32_bf16 v[68:71], v[32:35], v[200:203], v[68:71]
    v_mul_f32 v14, v58, v14
    v_mul_f32 v15, v59, v15
    ds_read_b64_tr_b16 v[28:29], v2 offset:40960
    v_mfma_f32_16x16x32_bf16 v[68:71], v[36:39], v[204:207], v[68:71]
    v_exp_f32 v12, v12
    v_exp_f32 v13, v13
    ds_read_b64_tr_b16 v[30:31], v2 offset:41216
    v_mfma_f32_16x16x32_bf16 v[92:95], v[88:91], v[32:35], v[92:95]
    v_exp_f32 v14, v14
    s_setprio 0
    s_waitcnt lgkmcnt(4)
    v_mfma_f32_16x16x32_bf16 v[72:75], v[40:43], v[192:195], v[72:75]
    v_exp_f32 v15, v15
    v_fma_f32 v12, v12, v18, v18
    v_fma_f32 v13, v13, v18, v18
    ds_read_b64_tr_b16 v[32:33], v3 offset:40960
    v_mfma_f32_16x16x32_bf16 v[72:75], v[44:47], v[196:199], v[72:75]
    v_fma_f32 v14, v14, v18, v18
    v_fma_f32 v15, v15, v18, v18
    v_rcp_f32 v12, v12
    ds_read_b64_tr_b16 v[34:35], v3 offset:41216
    v_mfma_f32_16x16x32_bf16 v[76:79], v[40:43], v[200:203], v[76:79]
    v_rcp_f32 v13, v13
    ds_read_b64_tr_b16 v[36:37], v4 offset:40960
    v_mfma_f32_16x16x32_bf16 v[76:79], v[44:47], v[204:207], v[76:79]
    v_rcp_f32 v14, v14
    v_rcp_f32 v15, v15
    ds_read_b64_tr_b16 v[38:39], v4 offset:41216
    s_cmp_ge_u32 s41, 2
    s_cbranch_scc1 L_typeB
    s_waitcnt vmcnt(10)
    s_barrier
    s_setprio 3
    s_waitcnt lgkmcnt(4)
    v_mfma_f32_16x16x32_bf16 v[64:67], v[24:27], v[208:211], v[64:67]
    v_mul_f32 v56, v56, v12
    v_mul_f32 v57, v57, v13
    v_mul_f32 v58, v58, v14
    v_mul_f32 v59, v59, v15
    s_add_u32 m0, s42, 98304
    ds_read_b64_tr_b16 v[40:41], v1 offset:49152
    buffer_load_dwordx4 v5, s[8:11], s48 offen lds
    v_mfma_f32_16x16x32_bf16 v[64:67], v[28:31], v[212:215], v[64:67]
    v_cvt_pk_bf16_f32 v82, v56, v57
    v_cvt_pk_bf16_f32 v83, v58, v59
    s_cbranch_vccz LA_sw8
    v_swap_b32 v80, v82
    v_swap_b32 v81, v83
LA_sw8:
    s_add_u32 s63, s65, 0
    buffer_store_dwordx4 v[80:83], v100, s[16:19], s63 offen sc1
    ds_read_b64_tr_b16 v[42:43], v1 offset:49408
    v_mfma_f32_16x16x32_bf16 v[68:71], v[24:27], v[216:219], v[68:71]
    v_mul_f32 v12, v52, v52
    v_mul_f32 v13, v53, v53
    v_mul_f32 v14, v54, v54
    v_mul_f32 v15, v55, v55
    ds_read_b64_tr_b16 v[44:45], v2 offset:49152
    v_mfma_f32_16x16x32_bf16 v[68:71], v[28:31], v[220:223], v[68:71]
    v_fma_f32 v12, v12, v20, v19
    v_fma_f32 v13, v13, v20, v19
    v_fma_f32 v14, v14, v20, v19
    ds_read_b64_tr_b16 v[46:47], v2 offset:49408
    v_mfma_f32_16x16x32_bf16 v[92:95], v[88:91], v[24:27], v[92:95]
    v_fma_f32 v15, v15, v20, v19
    v_mul_f32 v12, v52, v12
    v_mul_f32 v13, v53, v13
    v_mul_f32 v14, v54, v14
    s_waitcnt lgkmcnt(4)
    v_mfma_f32_16x16x32_bf16 v[72:75], v[32:35], v[208:211], v[72:75]
    v_mul_f32 v15, v55, v15
    v_exp_f32 v12, v12
    ds_read_b64_tr_b16 v[24:25], v3 offset:49152
    v_mfma_f32_16x16x32_bf16 v[72:75], v[36:39], v[212:215], v[72:75]
    v_exp_f32 v13, v13
    v_exp_f32 v14, v14
    ds_read_b64_tr_b16 v[26:27], v3 offset:49408
    v_mfma_f32_16x16x32_bf16 v[76:79], v[32:35], v[216:219], v[76:79]
    v_exp_f32 v15, v15
    v_fma_f32 v12, v12, v21, v21
    s_add_u32 m0, s42, 106496
    ds_read_b64_tr_b16 v[28:29], v4 offset:49152
    buffer_load_dwordx4 v5, s[8:11], s49 offen lds
    v_mfma_f32_16x16x32_bf16 v[76:79], v[36:39], v[220:223], v[76:79]
    v_fma_f32 v13, v13, v21, v21
    v_fma_f32 v14, v14, v21, v21
    v_fma_f32 v15, v15, v21, v21
    ds_read_b64_tr_b16 v[30:31], v4 offset:49408
    s_setprio 2
    s_waitcnt lgkmcnt(4)
    v_mfma_f32_16x16x32_bf16 v[64:67], v[40:43], v[224:227], v[64:67]
    v_rcp_f32 v12, v12
    v_rcp_f32 v13, v13
    ds_read_b64_tr_b16 v[32:33], v1 offset:57344
    v_mfma_f32_16x16x32_bf16 v[64:67], v[44:47], v[228:231], v[64:67]
    v_rcp_f32 v14, v14
    v_rcp_f32 v15, v15
    ds_read_b64_tr_b16 v[34:35], v1 offset:57600
    v_mfma_f32_16x16x32_bf16 v[68:71], v[40:43], v[232:235], v[68:71]
    v_mul_f32 v52, v52, v12
    v_mul_f32 v53, v53, v13
    v_mul_f32 v54, v54, v14
    ds_read_b64_tr_b16 v[36:37], v2 offset:57344
    v_mfma_f32_16x16x32_bf16 v[68:71], v[44:47], v[236:239], v[68:71]
    v_mul_f32 v55, v55, v15
    v_cvt_pk_bf16_f32 v84, v52, v53
    v_cvt_pk_bf16_f32 v85, v54, v55
    v_mul_f32 v12, v60, v60
    ds_read_b64_tr_b16 v[38:39], v2 offset:57600
    v_mfma_f32_16x16x32_bf16 v[92:95], v[88:91], v[40:43], v[92:95]
    v_mul_f32 v13, v61, v61
    v_mul_f32 v14, v62, v62
    v_mul_f32 v15, v63, v63
    s_setprio 1
    s_waitcnt lgkmcnt(4)
    v_mfma_f32_16x16x32_bf16 v[72:75], v[24:27], v[224:227], v[72:75]
    v_fma_f32 v12, v12, v20, v19
    v_fma_f32 v13, v13, v20, v19
    v_fma_f32 v14, v14, v20, v19
    v_fma_f32 v15, v15, v20, v19
    s_add_u32 m0, s42, 114688
    ds_read_b64_tr_b16 v[40:41], v3 offset:57344
    buffer_load_dwordx4 v5, s[8:11], s50 offen lds
    v_mfma_f32_16x16x32_bf16 v[72:75], v[28:31], v[228:231], v[72:75]
    v_mul_f32 v12, v60, v12
    v_mul_f32 v13, v61, v13
    v_mul_f32 v14, v62, v14
    ds_read_b64_tr_b16 v[42:43], v3 offset:57600
    v_mfma_f32_16x16x32_bf16 v[76:79], v[24:27], v[232:235], v[76:79]
    v_mul_f32 v15, v63, v15
    v_exp_f32 v12, v12
    ds_read_b64_tr_b16 v[44:45], v4 offset:57344
    v_mfma_f32_16x16x32_bf16 v[76:79], v[28:31], v[236:239], v[76:79]
    v_exp_f32 v13, v13
    v_exp_f32 v14, v14
    ds_read_b64_tr_b16 v[46:47], v4 offset:57600
    s_waitcnt lgkmcnt(4)
    v_mfma_f32_16x16x32_bf16 v[64:67], v[32:35], v[240:243], v[64:67]
    v_exp_f32 v15, v15
    v_fma_f32 v12, v12, v21, v21
    v_fma_f32 v13, v13, v21, v21
    v_add_u32 v1, 0x10000, v1
    ds_read_b64_tr_b16 v[24:25], v1 offset:0
    v_mfma_f32_16x16x32_bf16 v[64:67], v[36:39], v[244:247], v[64:67]
    v_fma_f32 v14, v14, v21, v21
    v_fma_f32 v15, v15, v21, v21
    ds_read_b64_tr_b16 v[26:27], v1 offset:256
    v_mfma_f32_16x16x32_bf16 v[68:71], v[32:35], v[248:251], v[68:71]
    v_rcp_f32 v12, v12
    v_rcp_f32 v13, v13
    v_add_u32 v2, 0x10000, v2
    ds_read_b64_tr_b16 v[28:29], v2 offset:0
    v_mfma_f32_16x16x32_bf16 v[68:71], v[36:39], v[252:255], v[68:71]
    v_rcp_f32 v14, v14
    ds_read_b64_tr_b16 v[30:31], v2 offset:256
    v_mfma_f32_16x16x32_bf16 v[92:95], v[88:91], v[32:35], v[92:95]
    v_rcp_f32 v15, v15
    v_mul_f32 v60, v60, v12
    v_mul_f32 v61, v61, v13
    v_mul_f32 v62, v62, v14
    s_setprio 0
    s_waitcnt lgkmcnt(4)
    v_mfma_f32_16x16x32_bf16 v[72:75], v[40:43], v[240:243], v[72:75]
    v_mul_f32 v63, v63, v15
    v_cvt_pk_bf16_f32 v86, v60, v61
    v_cvt_pk_bf16_f32 v87, v62, v63
    s_cbranch_vccz LA_sw9
    v_swap_b32 v84, v86
    v_swap_b32 v85, v87
LA_sw9:
    s_add_u32 s63, s65, 1024
    buffer_store_dwordx4 v[84:87], v100, s[16:19], s63 offen sc1
    s_cmp_eq_u32 s36, 5
    s_cbranch_scc0 LA_dw10
    v_lshlrev_b32 v99, 7, v0
    s_and_b32 s62, s39, 7
    s_lshl2_add_u32 s62, s62, s41
    s_mul_i32 s62, s62, 41472
    s_mul_i32 s63, s40, 1327104
    s_add_u32 s62, s62, s63
    s_add_u32 s62, s62, 20736
    s_mov_b32 m0, 512
    s_mov_b32 exec_lo, 0xffffffff
    s_mov_b32 exec_hi, 0x3fffff
    buffer_load_dword v99, s[12:15], s62 offen lds
    s_mov_b64 exec, -1
LA_dw10:
    v_add_u32 v3, 0x10000, v3
    ds_read_b64_tr_b16 v[32:33], v3 offset:0
    v_mfma_f32_16x16x32_bf16 v[72:75], v[44:47], v[244:247], v[72:75]
    s_cmp_eq_u32 s36, 6
    s_cbranch_scc0 LA_dw11
    v_lshlrev_b32 v99, 7, v0
    s_and_b32 s62, s39, 7
    s_lshl2_add_u32 s62, s62, s41
    s_mul_i32 s62, s62, 41472
    s_mul_i32 s63, s40, 1327104
    s_add_u32 s62, s62, s63
    s_add_u32 s62, s62, 27648
    s_mov_b32 m0, 512
    s_mov_b32 exec_lo, 0xffffffff
    s_mov_b32 exec_hi, 0x3fffff
    buffer_load_dword v99, s[12:15], s62 offen lds
    s_mov_b64 exec, -1
LA_dw11:
    ds_read_b64_tr_b16 v[34:35], v3 offset:256
    v_mfma_f32_16x16x32_bf16 v[76:79], v[40:43], v[248:251], v[76:79]
    v_add_u32 v4, 0x10000, v4
    ds_read_b64_tr_b16 v[36:37], v4 offset:0
    v_mfma_f32_16x16x32_bf16 v[76:79], v[44:47], v[252:255], v[76:79]
    ds_read_b64_tr_b16 v[38:39], v4 offset:256
    v_and_b32 v99, 15, v0
    v_lshl_add_u32 v99, v99, 4, s66
    ds_write_b32 v99, v92 offset:512
    s_waitcnt lgkmcnt(0)
    s_waitcnt vmcnt(12)
    s_barrier
    s_setprio 3
    v_mfma_f32_16x16x32_bf16 v[48:51], v[24:27], v[112:115], 0
    s_cmp_eq_u32 s36, 7
    s_cbranch_scc0 LA_dw12
    v_lshlrev_b32 v99, 7, v0
    s_and_b32 s62, s39, 7
    s_lshl2_add_u32 s62, s62, s41
    s_mul_i32 s62, s62, 41472
    s_mul_i32 s63, s40, 1327104
    s_add_u32 s62, s62, s63
    s_add_u32 s62, s62, 34560
    s_mov_b32 m0, 512
    s_mov_b32 exec_lo, 0xffffffff
    s_mov_b32 exec_hi, 0x3fffff
    buffer_load_dword v99, s[12:15], s62 offen lds
    s_mov_b64 exec, -1
LA_dw12:
    v_and_b32 v96, 15, v0
    v_lshl_add_u32 v22, v96, 4, s67
    ds_read_b64 v[12:13], v22 offset:512
    v_xor_b32 v22, 8, v22
    s_add_u32 m0, s42, 122880
    v_add_u32 v1, 0xfffde000, v1
    ds_read_b64_tr_b16 v[40:41], v1 offset:0
    buffer_load_dwordx4 v5, s[8:11], s51 offen lds
    v_mfma_f32_16x16x32_bf16 v[48:51], v[28:31], v[116:119], v[48:51]
    ds_read_b64 v[14:15], v22 offset:512
    v_lshl_add_u32 v96, v96, 1, s79
    ds_read_u16 v22, v96 offset:128
    ds_read_b64_tr_b16 v[42:43], v1 offset:256
    v_mfma_f32_16x16x32_bf16 v[52:55], v[24:27], v[120:123], 0
    v_xor_b32 v96, 32, v96
    ds_read_u16 v96, v96 offset:128
    v_add_u32 v2, 0xfffde000, v2
    ds_read_b64_tr_b16 v[44:45], v2 offset:0
    v_mfma_f32_16x16x32_bf16 v[52:55], v[28:31], v[124:127], v[52:55]
    ds_read_b64_tr_b16 v[46:47], v2 offset:256
    v_mfma_f32_16x16x32_bf16 v[92:95], v[88:91], v[24:27], 0
    v_mfma_f32_16x16x32_bf16 v[56:59], v[32:35], v[112:115], 0
    v_add_u32 v3, 0xfffde000, v3
    ds_read_b64_tr_b16 v[24:25], v3 offset:0
    v_mfma_f32_16x16x32_bf16 v[56:59], v[36:39], v[116:119], v[56:59]
    s_waitcnt lgkmcnt(8)
    v_add_f32 v12, v12, v13
    s_waitcnt lgkmcnt(6)
    v_add_f32 v14, v14, v15
    s_waitcnt lgkmcnt(5)
    v_lshlrev_b32 v22, 16, v22
    ds_read_b64_tr_b16 v[26:27], v3 offset:256
    v_mfma_f32_16x16x32_bf16 v[60:63], v[32:35], v[120:123], 0
    s_waitcnt lgkmcnt(4)
    v_lshlrev_b32 v96, 16, v96
    v_cvt_pk_bf16_f32 v23, v12, v22
    s_add_u32 m0, s42, 131072
    v_add_u32 v4, 0xfffde000, v4
    ds_read_b64_tr_b16 v[28:29], v4 offset:0
    buffer_load_dwordx4 v5, s[8:11], s52 offen lds
    v_mfma_f32_16x16x32_bf16 v[60:63], v[36:39], v[124:127], v[60:63]
    v_cvt_pk_bf16_f32 v97, v14, v96
    v_lshlrev_b32 v13, 16, v23
    s_add_u32 s56, s68, s80
    ds_read_b64_tr_b16 v[30:31], v4 offset:256
    s_setprio 2
    s_waitcnt lgkmcnt(4)
    v_mfma_f32_16x16x32_bf16 v[48:51], v[40:43], v[128:131], v[48:51]
    v_lshlrev_b32 v15, 16, v97
    v_sub_f32 v12, v12, v13
    s_add_u32 s56, s56, 147456
    ds_read_b64_tr_b16 v[32:33], v1 offset:8192
    v_mfma_f32_16x16x32_bf16 v[48:51], v[44:47], v[132:135], v[48:51]
    v_sub_f32 v14, v14, v15
    v_cvt_pk_bf16_f32 v22, v13, v12
    v_cvt_pk_bf16_f32 v96, v15, v14
    ds_read_b64_tr_b16 v[34:35], v1 offset:8448
    v_mfma_f32_16x16x32_bf16 v[52:55], v[40:43], v[136:139], v[52:55]
    v_mfma_f32_16x16x16_bf16 v[64:67], v[22:23], v[8:9], v[64:67]
    v_mfma_f32_16x16x16_bf16 v[68:71], v[22:23], v[10:11], v[68:71]
    ds_read_b64_tr_b16 v[36:37], v2 offset:8192
    v_mfma_f32_16x16x32_bf16 v[52:55], v[44:47], v[140:143], v[52:55]
    v_mfma_f32_16x16x16_bf16 v[72:75], v[96:97], v[8:9], v[72:75]
    v_mfma_f32_16x16x16_bf16 v[76:79], v[96:97], v[10:11], v[76:79]
    ds_read_b64_tr_b16 v[38:39], v2 offset:8448
    v_mfma_f32_16x16x32_bf16 v[92:95], v[88:91], v[40:43], v[92:95]
    s_setprio 1
    s_waitcnt lgkmcnt(4)
    v_mfma_f32_16x16x32_bf16 v[56:59], v[24:27], v[128:131], v[56:59]
    v_mul_f32 v12, v64, v64
    v_mul_f32 v13, v65, v65
    v_mul_f32 v14, v66, v66
    s_add_u32 m0, s42, 139264
    ds_read_b64_tr_b16 v[40:41], v3 offset:8192
    buffer_load_dwordx4 v6, s[12:15], s56 offen lds
    v_mfma_f32_16x16x32_bf16 v[56:59], v[28:31], v[132:135], v[56:59]
    v_mul_f32 v15, v67, v67
    v_fma_f32 v12, v12, v17, v16
    ds_read_b64_tr_b16 v[42:43], v3 offset:8448
    v_mfma_f32_16x16x32_bf16 v[60:63], v[24:27], v[136:139], v[60:63]
    v_fma_f32 v13, v13, v17, v16
    v_fma_f32 v14, v14, v17, v16
    v_fma_f32 v15, v15, v17, v16
    ds_read_b64_tr_b16 v[44:45], v4 offset:8192
    v_mfma_f32_16x16x32_bf16 v[60:63], v[28:31], v[140:143], v[60:63]
    v_mul_f32 v12, v64, v12
    v_mul_f32 v13, v65, v13
    ds_read_b64_tr_b16 v[46:47], v4 offset:8448
    s_waitcnt lgkmcnt(4)
    v_mfma_f32_16x16x32_bf16 v[48:51], v[32:35], v[144:147], v[48:51]
    v_mul_f32 v14, v66, v14
    v_mul_f32 v15, v67, v15
    ds_read_b64_tr_b16 v[24:25], v1 offset:16384
    v_mfma_f32_16x16x32_bf16 v[48:51], v[36:39], v[148:151], v[48:51]
    v_exp_f32 v12, v12
    ds_read_b64_tr_b16 v[26:27], v1 offset:16640
    v_mfma_f32_16x16x32_bf16 v[52:55], v[32:35], v[152:155], v[52:55]
    v_exp_f32 v13, v13
    ds_read_b64_tr_b16 v[28:29], v2 offset:16384
    v_mfma_f32_16x16x32_bf16 v[52:55], v[36:39], v[156:159], v[52:55]
    v_exp_f32 v14, v14
    ds_read_b64_tr_b16 v[30:31], v2 offset:16640
    v_mfma_f32_16x16x32_bf16 v[92:95], v[88:91], v[32:35], v[92:95]
    v_exp_f32 v15, v15
    v_fma_f32 v12, v12, v18, v18
    s_setprio 0
    s_waitcnt lgkmcnt(4)
    v_mfma_f32_16x16x32_bf16 v[56:59], v[40:43], v[144:147], v[56:59]
    v_fma_f32 v13, v13, v18, v18
    v_fma_f32 v14, v14, v18, v18
    ds_read_b64_tr_b16 v[32:33], v3 offset:16384
    v_mfma_f32_16x16x32_bf16 v[56:59], v[44:47], v[148:151], v[56:59]
    v_fma_f32 v15, v15, v18, v18
    v_rcp_f32 v12, v12
    ds_read_b64_tr_b16 v[34:35], v3 offset:16640
    v_mfma_f32_16x16x32_bf16 v[60:63], v[40:43], v[152:155], v[60:63]
    v_rcp_f32 v13, v13
    ds_read_b64_tr_b16 v[36:37], v4 offset:16384
    v_mfma_f32_16x16x32_bf16 v[60:63], v[44:47], v[156:159], v[60:63]
    v_rcp_f32 v14, v14
    ds_read_b64_tr_b16 v[38:39], v4 offset:16640
    s_waitcnt vmcnt(12)
    s_waitcnt vmcnt(3)
    s_barrier
    s_cmp_eq_u32 s36, 0
    s_cbranch_scc0 LA_dw13
    s_add_u32 s63, s96, 1
    v_mov_b32 v98, s63
    v_mov_b32 v99, s97
    s_mul_i32 s62, s41, 120
    s_sub_u32 s62, s2, s62
    s_lshl_b32 s63, s41, 3
    s_lshl_b32 s63, 1, s63
    s_andn2_b32 exec_lo, 0x01010101, s63
    s_mov_b32 exec_hi, 0
    buffer_store_dwordx2 v[98:99], v100, s[16:19], s62 offen sc1
    s_mov_b64 exec, -1
LA_dw13:
    s_setprio 3
    s_waitcnt lgkmcnt(4)
    v_mfma_f32_16x16x32_bf16 v[48:51], v[24:27], v[160:163], v[48:51]
    v_rcp_f32 v15, v15
    v_mul_f32 v64, v64, v12
    s_add_u32 s56, s68, s80
    ds_read_b64_tr_b16 v[40:41], v1 offset:24576
    v_mfma_f32_16x16x32_bf16 v[48:51], v[28:31], v[164:167], v[48:51]
    v_mul_f32 v65, v65, v13
    v_mul_f32 v66, v66, v14
    s_add_u32 m0, s42, 147456
    ds_read_b64_tr_b16 v[42:43], v1 offset:24832
    buffer_load_dwordx4 v6, s[12:15], s56 offen lds
    v_mfma_f32_16x16x32_bf16 v[52:55], v[24:27], v[168:171], v[52:55]
    v_mul_f32 v67, v67, v15
    v_cvt_pk_bf16_f32 v80, v64, v65
    v_cvt_pk_bf16_f32 v81, v66, v67
    s_add_u32 s56, s68, 147456
    ds_read_b64_tr_b16 v[44:45], v2 offset:24576
    v_mfma_f32_16x16x32_bf16 v[52:55], v[28:31], v[172:175], v[52:55]
    v_mul_f32 v12, v72, v72
    v_mul_f32 v13, v73, v73
    s_add_u32 s57, s68, 0
    ds_read_b64_tr_b16 v[46:47], v2 offset:24832
    v_mfma_f32_16x16x32_bf16 v[92:95], v[88:91], v[24:27], v[92:95]
    v_mul_f32 v14, v74, v74
    v_mul_f32 v15, v75, v75
    v_fma_f32 v12, v12, v17, v16
    s_cmp_ge_u32 s37, 2
    s_cselect_b32 s56, s57, s56
    s_waitcnt lgkmcnt(4)
    v_mfma_f32_16x16x32_bf16 v[56:59], v[32:35], v[160:163], v[56:59]
    v_fma_f32 v13, v13, v17, v16
    v_fma_f32 v14, v14, v17, v16
    s_add_u32 s56, s56, s81
    ds_read_b64_tr_b16 v[24:25], v3 offset:24576
    v_mfma_f32_16x16x32_bf16 v[56:59], v[36:39], v[164:167], v[56:59]
    v_fma_f32 v15, v15, v17, v16
    v_mul_f32 v12, v72, v12
    v_mul_f32 v13, v73, v13
    ds_read_b64_tr_b16 v[26:27], v3 offset:24832
    v_mfma_f32_16x16x32_bf16 v[60:63], v[32:35], v[168:171], v[60:63]
    v_mul_f32 v14, v74, v14
    v_mul_f32 v15, v75, v15
    ds_read_b64_tr_b16 v[28:29], v4 offset:24576
    v_mfma_f32_16x16x32_bf16 v[60:63], v[36:39], v[172:175], v[60:63]
    v_exp_f32 v12, v12
    s_add_u32 m0, s42, 8192
    ds_read_b64_tr_b16 v[30:31], v4 offset:24832
    buffer_load_dwordx4 v7, s[12:15], s56 offen lds
    s_setprio 2
    s_waitcnt lgkmcnt(4)
    v_mfma_f32_16x16x32_bf16 v[48:51], v[40:43], v[176:179], v[48:51]
    v_exp_f32 v13, v13
    s_add_u32 s56, s68, 147456
    ds_read_b64_tr_b16 v[32:33], v1 offset:32768
    v_mfma_f32_16x16x32_bf16 v[48:51], v[44:47], v[180:183], v[48:51]
    v_exp_f32 v14, v14
    s_add_u32 s57, s68, 0
    ds_read_b64_tr_b16 v[34:35], v1 offset:33024
    v_mfma_f32_16x16x32_bf16 v[52:55], v[40:43], v[184:187], v[52:55]
    v_exp_f32 v15, v15
    v_fma_f32 v12, v12, v18, v18
    s_cmp_ge_u32 s37, 2
    s_cselect_b32 s56, s57, s56
    ds_read_b64_tr_b16 v[36:37], v2 offset:32768
    v_mfma_f32_16x16x32_bf16 v[52:55], v[44:47], v[188:191], v[52:55]
    v_fma_f32 v13, v13, v18, v18
    v_fma_f32 v14, v14, v18, v18
    s_add_u32 s56, s56, s82
    ds_read_b64_tr_b16 v[38:39], v2 offset:33024
    v_mfma_f32_16x16x32_bf16 v[92:95], v[88:91], v[40:43], v[92:95]
    v_fma_f32 v15, v15, v18, v18
    v_rcp_f32 v12, v12
    s_setprio 1
    s_waitcnt lgkmcnt(4)
    v_mfma_f32_16x16x32_bf16 v[56:59], v[24:27], v[176:179], v[56:59]
    v_rcp_f32 v13, v13
    ds_read_b64_tr_b16 v[40:41], v3 offset:32768
    v_mfma_f32_16x16x32_bf16 v[56:59], v[28:31], v[180:183], v[56:59]
    v_rcp_f32 v14, v14
    s_add_u32 m0, s42, 16384
    ds_read_b64_tr_b16 v[42:43], v3 offset:33024
    buffer_load_dwordx4 v7, s[12:15], s56 offen lds
    v_mfma_f32_16x16x32_bf16 v[60:63], v[24:27], v[184:187], v[60:63]
    v_rcp_f32 v15, v15
    v_mul_f32 v72, v72, v12
    ds_read_b64_tr_b16 v[44:45], v4 offset:32768
    v_mfma_f32_16x16x32_bf16 v[60:63], v[28:31], v[188:191], v[60:63]
    v_mul_f32 v73, v73, v13
    v_mul_f32 v74, v74, v14
    ds_read_b64_tr_b16 v[46:47], v4 offset:33024
    s_waitcnt lgkmcnt(4)
    v_mfma_f32_16x16x32_bf16 v[48:51], v[32:35], v[192:195], v[48:51]
    v_mul_f32 v75, v75, v15
    v_cvt_pk_bf16_f32 v82, v72, v73
    v_cvt_pk_bf16_f32 v83, v74, v75
    ds_read_b64_tr_b16 v[24:25], v1 offset:40960
    v_mfma_f32_16x16x32_bf16 v[48:51], v[36:39], v[196:199], v[48:51]
    s_cbranch_vccz LA_sw14
    v_swap_b32 v80, v82
    v_swap_b32 v81, v83
LA_sw14:
    s_add_u32 s63, s65, 16384
    buffer_store_dwordx4 v[80:83], v100, s[16:19], s63 offen sc1
    v_mul_f32 v12, v68, v68
    ds_read_b64_tr_b16 v[26:27], v1 offset:41216
    v_mfma_f32_16x16x32_bf16 v[52:55], v[32:35], v[200:203], v[52:55]
    v_mul_f32 v13, v69, v69
    v_mul_f32 v14, v70, v70
    v_mul_f32 v15, v71, v71
    ds_read_b64_tr_b16 v[28:29], v2 offset:40960
    v_mfma_f32_16x16x32_bf16 v[52:55], v[36:39], v[204:207], v[52:55]
    v_fma_f32 v12, v12, v20, v19
    v_fma_f32 v13, v13, v20, v19
    ds_read_b64_tr_b16 v[30:31], v2 offset:41216
    v_mfma_f32_16x16x32_bf16 v[92:95], v[88:91], v[32:35], v[92:95]
    v_fma_f32 v14, v14, v20, v19
    v_fma_f32 v15, v15, v20, v19
    v_mul_f32 v12, v68, v12
    s_setprio 0
    s_waitcnt lgkmcnt(4)
    v_mfma_f32_16x16x32_bf16 v[56:59], v[40:43], v[192:195], v[56:59]
    v_mul_f32 v13, v69, v13
    v_mul_f32 v14, v70, v14
    ds_read_b64_tr_b16 v[32:33], v3 offset:40960
    v_mfma_f32_16x16x32_bf16 v[56:59], v[44:47], v[196:199], v[56:59]
    v_mul_f32 v15, v71, v15
    v_exp_f32 v12, v12
    ds_read_b64_tr_b16 v[34:35], v3 offset:41216
    v_mfma_f32_16x16x32_bf16 v[60:63], v[40:43], v[200:203], v[60:63]
    v_exp_f32 v13, v13
    ds_read_b64_tr_b16 v[36:37], v4 offset:40960
    v_mfma_f32_16x16x32_bf16 v[60:63], v[44:47], v[204:207], v[60:63]
    v_exp_f32 v14, v14
    ds_read_b64_tr_b16 v[38:39], v4 offset:41216
    s_barrier
    s_setprio 3
    s_waitcnt lgkmcnt(4)
    v_mfma_f32_16x16x32_bf16 v[48:51], v[24:27], v[208:211], v[48:51]
    v_exp_f32 v15, v15
    v_fma_f32 v12, v12, v21, v21
    s_add_u32 s56, s69, s80
    ds_read_b64_tr_b16 v[40:41], v1 offset:49152
    v_mfma_f32_16x16x32_bf16 v[48:51], v[28:31], v[212:215], v[48:51]
    v_fma_f32 v13, v13, v21, v21
    v_fma_f32 v14, v14, v21, v21
    s_add_u32 m0, s42, 24576
    ds_read_b64_tr_b16 v[42:43], v1 offset:49408
    buffer_load_dwordx4 v6, s[12:15], s56 offen lds
    v_mfma_f32_16x16x32_bf16 v[52:55], v[24:27], v[216:219], v[52:55]
    v_fma_f32 v15, v15, v21, v21
    v_rcp_f32 v12, v12
    s_add_u32 s56, s70, s80
    ds_read_b64_tr_b16 v[44:45], v2 offset:49152
    v_mfma_f32_16x16x32_bf16 v[52:55], v[28:31], v[220:223], v[52:55]
    v_rcp_f32 v13, v13
    ds_read_b64_tr_b16 v[46:47], v2 offset:49408
    v_mfma_f32_16x16x32_bf16 v[92:95], v[88:91], v[24:27], v[92:95]
    v_rcp_f32 v14, v14
    s_waitcnt lgkmcnt(4)
    v_mfma_f32_16x16x32_bf16 v[56:59], v[32:35], v[208:211], v[56:59]
    v_rcp_f32 v15, v15
    v_mul_f32 v68, v68, v12
    ds_read_b64_tr_b16 v[24:25], v3 offset:49152
    v_mfma_f32_16x16x32_bf16 v[56:59], v[36:39], v[212:215], v[56:59]
    v_mul_f32 v69, v69, v13
    v_mul_f32 v70, v70, v14
    ds_read_b64_tr_b16 v[26:27], v3 offset:49408
    v_mfma_f32_16x16x32_bf16 v[60:63], v[32:35], v[216:219], v[60:63]
    v_mul_f32 v71, v71, v15
    v_cvt_pk_bf16_f32 v84, v68, v69
    v_cvt_pk_bf16_f32 v85, v70, v71
    ds_read_b64_tr_b16 v[28:29], v4 offset:49152
    v_mfma_f32_16x16x32_bf16 v[60:63], v[36:39], v[220:223], v[60:63]
    v_mul_f32 v12, v76, v76
    v_mul_f32 v13, v77, v77
    s_add_u32 m0, s42, 32768
    ds_read_b64_tr_b16 v[30:31], v4 offset:49408
    buffer_load_dwordx4 v6, s[12:15], s56 offen lds
    s_setprio 2
    s_waitcnt lgkmcnt(4)
    v_mfma_f32_16x16x32_bf16 v[48:51], v[40:43], v[224:227], v[48:51]
    v_mul_f32 v14, v78, v78
    v_mul_f32 v15, v79, v79
    v_fma_f32 v12, v12, v20, v19
    s_add_u32 s56, s69, 0
    ds_read_b64_tr_b16 v[32:33], v1 offset:57344
    v_mfma_f32_16x16x32_bf16 v[48:51], v[44:47], v[228:231], v[48:51]
    v_fma_f32 v13, v13, v20, v19
    v_fma_f32 v14, v14, v20, v19
    s_add_u32 s57, s70, 0
    ds_read_b64_tr_b16 v[34:35], v1 offset:57600
    v_mfma_f32_16x16x32_bf16 v[52:55], v[40:43], v[232:235], v[52:55]
    v_fma_f32 v15, v15, v20, v19
    v_mul_f32 v12, v76, v12
    v_mul_f32 v13, v77, v13
    s_cmp_ge_u32 s37, 2
    s_cselect_b32 s56, s57, s56
    ds_read_b64_tr_b16 v[36:37], v2 offset:57344
    v_mfma_f32_16x16x32_bf16 v[52:55], v[44:47], v[236:239], v[52:55]
    v_mul_f32 v14, v78, v14
    v_mul_f32 v15, v79, v15
    s_add_u32 s56, s56, s81
    ds_read_b64_tr_b16 v[38:39], v2 offset:57600
    v_mfma_f32_16x16x32_bf16 v[92:95], v[88:91], v[40:43], v[92:95]
    v_exp_f32 v12, v12
    s_setprio 1
    s_waitcnt lgkmcnt(4)
    v_mfma_f32_16x16x32_bf16 v[56:59], v[24:27], v[224:227], v[56:59]
    v_exp_f32 v13, v13
    ds_read_b64_tr_b16 v[40:41], v3 offset:57344
    v_mfma_f32_16x16x32_bf16 v[56:59], v[28:31], v[228:231], v[56:59]
    v_exp_f32 v14, v14
    s_add_u32 m0, s42, 40960
    ds_read_b64_tr_b16 v[42:43], v3 offset:57600
    buffer_load_dwordx4 v7, s[12:15], s56 offen lds
    v_mfma_f32_16x16x32_bf16 v[60:63], v[24:27], v[232:235], v[60:63]
    v_exp_f32 v15, v15
    v_fma_f32 v12, v12, v21, v21
    ds_read_b64_tr_b16 v[44:45], v4 offset:57344
    v_mfma_f32_16x16x32_bf16 v[60:63], v[28:31], v[236:239], v[60:63]
    v_fma_f32 v13, v13, v21, v21
    v_fma_f32 v14, v14, v21, v21
    v_fma_f32 v15, v15, v21, v21
    ds_read_b64_tr_b16 v[46:47], v4 offset:57600
    s_waitcnt lgkmcnt(4)
    v_mfma_f32_16x16x32_bf16 v[48:51], v[32:35], v[240:243], v[48:51]
    v_rcp_f32 v12, v12
    v_add_u32 v1, 0x10000, v1
    ds_read_b64_tr_b16 v[24:25], v1 offset:0
    v_mfma_f32_16x16x32_bf16 v[48:51], v[36:39], v[244:247], v[48:51]
    v_rcp_f32 v13, v13
    ds_read_b64_tr_b16 v[26:27], v1 offset:256
    v_mfma_f32_16x16x32_bf16 v[52:55], v[32:35], v[248:251], v[52:55]
    v_rcp_f32 v14, v14
    v_add_u32 v2, 0x10000, v2
    ds_read_b64_tr_b16 v[28:29], v2 offset:0
    v_mfma_f32_16x16x32_bf16 v[52:55], v[36:39], v[252:255], v[52:55]
    v_rcp_f32 v15, v15
    v_mul_f32 v76, v76, v12
    ds_read_b64_tr_b16 v[30:31], v2 offset:256
    v_mfma_f32_16x16x32_bf16 v[92:95], v[88:91], v[32:35], v[92:95]
    v_mul_f32 v77, v77, v13
    v_mul_f32 v78, v78, v14
    v_mul_f32 v79, v79, v15
    s_setprio 0
    s_waitcnt lgkmcnt(4)
    v_mfma_f32_16x16x32_bf16 v[56:59], v[40:43], v[240:243], v[56:59]
    v_cvt_pk_bf16_f32 v86, v76, v77
    v_cvt_pk_bf16_f32 v87, v78, v79
    s_cbranch_vccz LA_sw15
    v_swap_b32 v84, v86
    v_swap_b32 v85, v87
LA_sw15:
    s_add_u32 s63, s65, 17408
    buffer_store_dwordx4 v[84:87], v100, s[16:19], s63 offen sc1
    v_add_u32 v3, 0x10000, v3
    ds_read_b64_tr_b16 v[32:33], v3 offset:0
    v_mfma_f32_16x16x32_bf16 v[56:59], v[44:47], v[244:247], v[56:59]
    ds_read_b64_tr_b16 v[34:35], v3 offset:256
    v_mfma_f32_16x16x32_bf16 v[60:63], v[40:43], v[248:251], v[60:63]
    v_add_u32 v4, 0x10000, v4
    ds_read_b64_tr_b16 v[36:37], v4 offset:0
    v_mfma_f32_16x16x32_bf16 v[60:63], v[44:47], v[252:255], v[60:63]
    ds_read_b64_tr_b16 v[38:39], v4 offset:256
    v_and_b32 v99, 15, v0
    v_lshl_add_u32 v99, v99, 4, s66
    ds_write_b32 v99, v92 offset:0
    s_waitcnt lgkmcnt(0)
    s_barrier
    s_setprio 3
    v_mfma_f32_16x16x32_bf16 v[64:67], v[24:27], v[112:115], 0
    s_cmp_eq_u32 s36, 0
    s_cbranch_scc0 LA_dw16
    v_and_b32 v104, 3, v0
    v_lshlrev_b32 v104, 3, v104
    buffer_load_dwordx2 v[104:105], v104, s[16:19], s2 offen sc1
LA_dw16:
    v_bfe_u32 v106, v0, 2, 3
    s_add_u32 s56, s69, 0
    v_add_u32 v1, 0x14000, v1
    ds_read_b64_tr_b16 v[40:41], v1 offset:0
    v_mfma_f32_16x16x32_bf16 v[64:67], v[28:31], v[116:119], v[64:67]
    v_lshlrev_b32 v106, 6, v106
    v_and_b32 v107, 3, v0
    s_add_u32 s57, s70, 0
    ds_read_b64_tr_b16 v[42:43], v1 offset:256
    v_mfma_f32_16x16x32_bf16 v[68:71], v[24:27], v[120:123], 0
    v_lshl_add_u32 v106, v107, 3, v106
    v_bfe_u32 v107, v0, 4, 1
    v_xor_b32 v107, s38, v107
    s_cmp_ge_u32 s37, 2
    s_cselect_b32 s56, s57, s56
    v_add_u32 v2, 0x14000, v2
    ds_read_b64_tr_b16 v[44:45], v2 offset:0
    v_mfma_f32_16x16x32_bf16 v[68:71], v[28:31], v[124:127], v[68:71]
    v_lshl_add_u32 v106, v107, 5, v106
    s_add_u32 s56, s56, s82
    ds_read_b64_tr_b16 v[46:47], v2 offset:256
    v_mfma_f32_16x16x32_bf16 v[92:95], v[88:91], v[24:27], 0
    v_lshl_add_u32 v106, s38, 12, v106
    v_lshrrev_b32 v107, 5, v0
    v_lshl_add_u32 v5, v107, 10, v106
    v_mfma_f32_16x16x32_bf16 v[72:75], v[32:35], v[112:115], 0
    v_lshl_add_u32 v102, v107, 9, v106
    v_xor_b32 v101, 32, v5
    v_xor_b32 v103, 32, v102
    s_add_u32 m0, s42, 49152
    v_add_u32 v3, 0x14000, v3
    ds_read_b64_tr_b16 v[24:25], v3 offset:0
    buffer_load_dwordx4 v7, s[12:15], s56 offen lds
    v_mfma_f32_16x16x32_bf16 v[72:75], v[36:39], v[116:119], v[72:75]
    v_and_b32 v96, 15, v0
    s_add_u32 s56, s71, s80
    ds_read_b64_tr_b16 v[26:27], v3 offset:256
    v_mfma_f32_16x16x32_bf16 v[76:79], v[32:35], v[120:123], 0
    v_lshl_add_u32 v22, v96, 4, s67
    ds_read_b64 v[12:13], v22 offset:0
    v_xor_b32 v22, 8, v22
    ds_read_b64 v[14:15], v22 offset:0
    v_lshl_add_u32 v96, v96, 1, s79
    v_add_u32 v4, 0x14000, v4
    ds_read_b64_tr_b16 v[28:29], v4 offset:0
    v_mfma_f32_16x16x32_bf16 v[76:79], v[36:39], v[124:127], v[76:79]
    ds_read_u16 v22, v96 offset:256
    v_xor_b32 v96, 32, v96
    ds_read_u16 v96, v96 offset:256
    ds_read_b64_tr_b16 v[30:31], v4 offset:256
    s_setprio 2
    s_waitcnt lgkmcnt(8)
    v_mfma_f32_16x16x32_bf16 v[64:67], v[40:43], v[128:131], v[64:67]
    v_add_u32 v1, 0xfffee000, v1
    ds_read_b64_tr_b16 v[32:33], v1 offset:0
    v_mfma_f32_16x16x32_bf16 v[64:67], v[44:47], v[132:135], v[64:67]
    ds_read_b64_tr_b16 v[34:35], v1 offset:256
    v_mfma_f32_16x16x32_bf16 v[68:71], v[40:43], v[136:139], v[68:71]
    v_add_u32 v2, 0xfffee000, v2
    ds_read_b64_tr_b16 v[36:37], v2 offset:0
    v_mfma_f32_16x16x32_bf16 v[68:71], v[44:47], v[140:143], v[68:71]
    s_waitcnt lgkmcnt(8)
    v_add_f32 v12, v12, v13
    s_waitcnt lgkmcnt(7)
    v_add_f32 v14, v14, v15
    s_waitcnt lgkmcnt(5)
    v_lshlrev_b32 v22, 16, v22
    s_add_u32 m0, s42, 57344
    ds_read_b64_tr_b16 v[38:39], v2 offset:256
    buffer_load_dwordx4 v6, s[12:15], s56 offen lds
    v_mfma_f32_16x16x32_bf16 v[92:95], v[88:91], v[40:43], v[92:95]
    s_waitcnt lgkmcnt(5)
    v_lshlrev_b32 v96, 16, v96
    v_cvt_pk_bf16_f32 v23, v12, v22
    v_cvt_pk_bf16_f32 v97, v14, v96
    s_add_u32 s56, s68, s80
    s_setprio 1
    s_waitcnt lgkmcnt(4)
    v_mfma_f32_16x16x32_bf16 v[72:75], v[24:27], v[128:131], v[72:75]
    v_lshlrev_b32 v13, 16, v23
    v_lshlrev_b32 v15, 16, v97
    v_sub_f32 v12, v12, v13
    s_add_u32 s56, s56, 73728
    v_add_u32 v3, 0xfffee000, v3
    ds_read_b64_tr_b16 v[40:41], v3 offset:0
    v_mfma_f32_16x16x32_bf16 v[72:75], v[28:31], v[132:135], v[72:75]
    v_sub_f32 v14, v14, v15
    ds_read_b64_tr_b16 v[42:43], v3 offset:256
    v_mfma_f32_16x16x32_bf16 v[76:79], v[24:27], v[136:139], v[76:79]
    v_cvt_pk_bf16_f32 v22, v13, v12
    v_cvt_pk_bf16_f32 v96, v15, v14
    v_add_u32 v4, 0xfffee000, v4
    ds_read_b64_tr_b16 v[44:45], v4 offset:0
    v_mfma_f32_16x16x32_bf16 v[76:79], v[28:31], v[140:143], v[76:79]
    v_mfma_f32_16x16x16_bf16 v[48:51], v[22:23], v[8:9], v[48:51]
    v_mfma_f32_16x16x16_bf16 v[52:55], v[22:23], v[10:11], v[52:55]
    v_mfma_f32_16x16x16_bf16 v[56:59], v[96:97], v[8:9], v[56:59]
    ds_read_b64_tr_b16 v[46:47], v4 offset:256
    s_waitcnt lgkmcnt(4)
    v_mfma_f32_16x16x32_bf16 v[64:67], v[32:35], v[144:147], v[64:67]
    v_mfma_f32_16x16x16_bf16 v[60:63], v[96:97], v[10:11], v[60:63]
    ds_read_b64_tr_b16 v[24:25], v1 offset:8192
    v_mfma_f32_16x16x32_bf16 v[64:67], v[36:39], v[148:151], v[64:67]
    s_add_u32 m0, s42, 65536
    ds_read_b64_tr_b16 v[26:27], v1 offset:8448
    buffer_load_dwordx4 v6, s[12:15], s56 offen lds
    v_mfma_f32_16x16x32_bf16 v[68:71], v[32:35], v[152:155], v[68:71]
    v_mul_f32 v12, v48, v48
    v_mul_f32 v13, v49, v49
    v_mul_f32 v14, v50, v50
    ds_read_b64_tr_b16 v[28:29], v2 offset:8192
    v_mfma_f32_16x16x32_bf16 v[68:71], v[36:39], v[156:159], v[68:71]
    v_mul_f32 v15, v51, v51
    v_fma_f32 v12, v12, v17, v16
    v_fma_f32 v13, v13, v17, v16
    ds_read_b64_tr_b16 v[30:31], v2 offset:8448
    v_mfma_f32_16x16x32_bf16 v[92:95], v[88:91], v[32:35], v[92:95]
    v_fma_f32 v14, v14, v17, v16
    v_fma_f32 v15, v15, v17, v16
    s_setprio 0
    s_waitcnt lgkmcnt(4)
    v_mfma_f32_16x16x32_bf16 v[72:75], v[40:43], v[144:147], v[72:75]
    v_mul_f32 v12, v48, v12
    v_mul_f32 v13, v49, v13
    v_mul_f32 v14, v50, v14
    ds_read_b64_tr_b16 v[32:33], v3 offset:8192
    v_mfma_f32_16x16x32_bf16 v[72:75], v[44:47], v[148:151], v[72:75]
    v_mul_f32 v15, v51, v15
    v_exp_f32 v12, v12
    ds_read_b64_tr_b16 v[34:35], v3 offset:8448
    v_mfma_f32_16x16x32_bf16 v[76:79], v[40:43], v[152:155], v[76:79]
    v_exp_f32 v13, v13
    ds_read_b64_tr_b16 v[36:37], v4 offset:8192
    v_mfma_f32_16x16x32_bf16 v[76:79], v[44:47], v[156:159], v[76:79]
    v_exp_f32 v14, v14
    ds_read_b64_tr_b16 v[38:39], v4 offset:8448
    s_cmp_eq_u32 s36, 0
    s_cbranch_scc0 LA_dw19
    s_waitcnt vmcnt(3)
    s_add_u32 s62, s96, 1
    v_subrev_u32 v104, s62, v104
    v_cmp_ne_u32 s[58:59], s97, v105
    v_cmp_lt_u32 s[60:61], 14, v104
    s_lshl_b32 s62, 1, s41
    s_andn2_b32 s62, 15, s62
    s_nop 0
    s_or_b32 s60, s60, s58
    s_and_b32 s60, s60, s62
    s_cbranch_scc0 LA_ok17
    s_mov_b32 s78, 200000
LA_sp18:
    s_sleep 1
    v_and_b32 v104, 3, v0
    v_lshlrev_b32 v104, 3, v104
    buffer_load_dwordx2 v[104:105], v104, s[16:19], s2 offen sc1
    s_waitcnt vmcnt(0)
    s_add_u32 s62, s96, 1
    v_subrev_u32 v104, s62, v104
    v_cmp_ne_u32 s[58:59], s97, v105
    v_cmp_lt_u32 s[60:61], 14, v104
    s_lshl_b32 s62, 1, s41
    s_andn2_b32 s62, 15, s62
    s_nop 0
    s_or_b32 s60, s60, s58
    s_and_b32 s60, s60, s62
    s_cbranch_scc0 LA_ok17
    s_sub_u32 s78, s78, 1
    s_cmp_lg_u32 s78, 0
    s_cbranch_scc1 LA_sp18
LA_ok17:
    s_nop 1
LA_dw19:
    s_waitcnt vmcnt(12)
    s_waitcnt vmcnt(3)
    s_barrier
    s_cmp_eq_u32 s36, 0
    s_cbranch_scc0 LA_dw20
    s_add_u32 s63, s96, 2
    v_mov_b32 v98, s63
    v_mov_b32 v99, s97
    s_mul_i32 s62, s41, 120
    s_sub_u32 s62, s2, s62
    s_lshl_b32 s63, s41, 3
    s_lshl_b32 s63, 1, s63
    s_andn2_b32 exec_lo, 0x01010101, s63
    s_mov_b32 exec_hi, 0
    buffer_store_dwordx2 v[98:99], v100, s[16:19], s62 offen sc1
    s_mov_b64 exec, -1
LA_dw20:
    s_setprio 3
    s_waitcnt lgkmcnt(4)
    v_mfma_f32_16x16x32_bf16 v[64:67], v[24:27], v[160:163], v[64:67]
    v_exp_f32 v15, v15
    v_fma_f32 v12, v12, v18, v18
    s_add_u32 s56, s71, 0
    ds_read_b64_tr_b16 v[40:41], v1 offset:16384
    s_add_u32 s63, s72, 0
    buffer_load_dwordx4 v[112:115], v100, s[16:19], s63 offen offset:0 sc1
    v_mfma_f32_16x16x32_bf16 v[64:67], v[28:31], v[164:167], v[64:67]
    v_fma_f32 v13, v13, v18, v18
    v_fma_f32 v14, v14, v18, v18
    v_fma_f32 v15, v15, v18, v18
    s_add_u32 s57, s68, 73728
    ds_read_b64_tr_b16 v[42:43], v1 offset:16640
    v_mfma_f32_16x16x32_bf16 v[68:71], v[24:27], v[168:171], v[68:71]
    v_rcp_f32 v12, v12
    s_cmp_ge_u32 s37, 2
    s_cselect_b32 s56, s57, s56
    ds_read_b64_tr_b16 v[44:45], v2 offset:16384
    v_mfma_f32_16x16x32_bf16 v[68:71], v[28:31], v[172:175], v[68:71]
    v_rcp_f32 v13, v13
    s_add_u32 s56, s56, s81
    ds_read_b64_tr_b16 v[46:47], v2 offset:16640
    v_mfma_f32_16x16x32_bf16 v[92:95], v[88:91], v[24:27], v[92:95]
    v_rcp_f32 v14, v14
    s_waitcnt lgkmcnt(4)
    v_mfma_f32_16x16x32_bf16 v[72:75], v[32:35], v[160:163], v[72:75]
    v_rcp_f32 v15, v15
    v_mul_f32 v48, v48, v12
    s_add_u32 m0, s42, 73728
    ds_read_b64_tr_b16 v[24:25], v3 offset:16384
    buffer_load_dwordx4 v7, s[12:15], s56 offen lds
    v_mfma_f32_16x16x32_bf16 v[72:75], v[36:39], v[164:167], v[72:75]
    v_mul_f32 v49, v49, v13
    v_mul_f32 v50, v50, v14
    v_mul_f32 v51, v51, v15
    s_add_u32 s56, s71, 0
    ds_read_b64_tr_b16 v[26:27], v3 offset:16640
    s_add_u32 s63, s72, 0
    buffer_load_dwordx4 v[116:119], v100, s[16:19], s63 offen offset:1024 sc1
    v_mfma_f32_16x16x32_bf16 v[76:79], v[32:35], v[168:171], v[76:79]
    v_cvt_pk_bf16_f32 v80, v48, v49
    v_cvt_pk_bf16_f32 v81, v50, v51
    v_mul_f32 v12, v56, v56
    s_add_u32 s57, s68, 73728
    ds_read_b64_tr_b16 v[28:29], v4 offset:16384
    v_mfma_f32_16x16x32_bf16 v[76:79], v[36:39], v[172:175], v[76:79]
    v_mul_f32 v13, v57, v57
    v_mul_f32 v14, v58, v58
    s_cmp_ge_u32 s37, 2
    s_cselect_b32 s56, s57, s56
    ds_read_b64_tr_b16 v[30:31], v4 offset:16640
    s_setprio 2
    s_waitcnt lgkmcnt(4)
    v_mfma_f32_16x16x32_bf16 v[64:67], v[40:43], v[176:179], v[64:67]
    v_mul_f32 v15, v59, v59
    v_fma_f32 v12, v12, v17, v16
    v_fma_f32 v13, v13, v17, v16
    s_add_u32 s56, s56, s82
    ds_read_b64_tr_b16 v[32:33], v1 offset:24576
    v_mfma_f32_16x16x32_bf16 v[64:67], v[44:47], v[180:183], v[64:67]
    v_fma_f32 v14, v14, v17, v16
    v_fma_f32 v15, v15, v17, v16
    v_mul_f32 v12, v56, v12
    ds_read_b64_tr_b16 v[34:35], v1 offset:24832
    v_mfma_f32_16x16x32_bf16 v[68:71], v[40:43], v[184:187], v[68:71]
    v_mul_f32 v13, v57, v13
    v_mul_f32 v14, v58, v14
    ds_read_b64_tr_b16 v[36:37], v2 offset:24576
    s_add_u32 s63, s73, 0
    buffer_load_dwordx4 v[120:123], v100, s[16:19], s63 offen offset:0 sc1
    v_mfma_f32_16x16x32_bf16 v[68:71], v[44:47], v[188:191], v[68:71]
    v_mul_f32 v15, v59, v15
    v_exp_f32 v12, v12
    ds_read_b64_tr_b16 v[38:39], v2 offset:24832
    v_mfma_f32_16x16x32_bf16 v[92:95], v[88:91], v[40:43], v[92:95]
    v_exp_f32 v13, v13
    s_setprio 1
    s_waitcnt lgkmcnt(4)
    v_mfma_f32_16x16x32_bf16 v[72:75], v[24:27], v[176:179], v[72:75]
    v_exp_f32 v14, v14
    s_add_u32 m0, s42, 155648
    ds_read_b64_tr_b16 v[40:41], v3 offset:24576
    buffer_load_dwordx4 v7, s[12:15], s56 offen lds
    v_mfma_f32_16x16x32_bf16 v[72:75], v[28:31], v[180:183], v[72:75]
    v_exp_f32 v15, v15
    v_fma_f32 v12, v12, v18, v18
    s_add_u32 s56, s69, s80
    ds_read_b64_tr_b16 v[42:43], v3 offset:24832
    v_mfma_f32_16x16x32_bf16 v[76:79], v[24:27], v[184:187], v[76:79]
    v_fma_f32 v13, v13, v18, v18
    v_fma_f32 v14, v14, v18, v18
    v_fma_f32 v15, v15, v18, v18
    s_add_u32 s56, s56, 73728
    ds_read_b64_tr_b16 v[44:45], v4 offset:24576
    s_add_u32 s63, s73, 0
    buffer_load_dwordx4 v[124:127], v100, s[16:19], s63 offen offset:1024 sc1
    v_mfma_f32_16x16x32_bf16 v[76:79], v[28:31], v[188:191], v[76:79]
    v_rcp_f32 v12, v12
    ds_read_b64_tr_b16 v[46:47], v4 offset:24832
    s_waitcnt lgkmcnt(4)
    v_mfma_f32_16x16x32_bf16 v[64:67], v[32:35], v[192:195], v[64:67]
    v_rcp_f32 v13, v13
    ds_read_b64_tr_b16 v[24:25], v1 offset:32768
    v_mfma_f32_16x16x32_bf16 v[64:67], v[36:39], v[196:199], v[64:67]
    v_rcp_f32 v14, v14
    ds_read_b64_tr_b16 v[26:27], v1 offset:33024
    v_mfma_f32_16x16x32_bf16 v[68:71], v[32:35], v[200:203], v[68:71]
    v_rcp_f32 v15, v15
    v_mul_f32 v56, v56, v12
    ds_read_b64_tr_b16 v[28:29], v2 offset:32768
    v_mfma_f32_16x16x32_bf16 v[68:71], v[36:39], v[204:207], v[68:71]
    v_mul_f32 v57, v57, v13
    v_mul_f32 v58, v58, v14
    v_mul_f32 v59, v59, v15
    ds_read_b64_tr_b16 v[30:31], v2 offset:33024
    s_add_u32 s63, s74, 0
    buffer_load_dwordx4 v[128:131], v100, s[16:19], s63 offen offset:0 sc1
    v_mfma_f32_16x16x32_bf16 v[92:95], v[88:91], v[32:35], v[92:95]
    v_cvt_pk_bf16_f32 v82, v56, v57
    v_cvt_pk_bf16_f32 v83, v58, v59
    s_cbranch_vccz LA_sw21
    v_swap_b32 v80, v82
    v_swap_b32 v81, v83
LA_sw21:
    s_add_u32 s63, s65, 32768
    buffer_store_dwordx4 v[80:83], v100, s[16:19], s63 offen sc1
    s_setprio 0
    s_waitcnt lgkmcnt(4)
    v_mfma_f32_16x16x32_bf16 v[72:75], v[40:43], v[192:195], v[72:75]
    v_mul_f32 v12, v52, v52
    v_mul_f32 v13, v53, v53
    v_mul_f32 v14, v54, v54
    s_add_u32 m0, s42, 81920
    ds_read_b64_tr_b16 v[32:33], v3 offset:32768
    buffer_load_dwordx4 v6, s[12:15], s56 offen lds
    v_mfma_f32_16x16x32_bf16 v[72:75], v[44:47], v[196:199], v[72:75]
    v_mul_f32 v15, v55, v55
    v_fma_f32 v12, v12, v20, v19
    ds_read_b64_tr_b16 v[34:35], v3 offset:33024
    v_mfma_f32_16x16x32_bf16 v[76:79], v[40:43], v[200:203], v[76:79]
    v_fma_f32 v13, v13, v20, v19
    v_fma_f32 v14, v14, v20, v19
    v_fma_f32 v15, v15, v20, v19
    ds_read_b64_tr_b16 v[36:37], v4 offset:32768
    v_mfma_f32_16x16x32_bf16 v[76:79], v[44:47], v[204:207], v[76:79]
    v_mul_f32 v12, v52, v12
    v_mul_f32 v13, v53, v13
    v_mul_f32 v14, v54, v14
    ds_read_b64_tr_b16 v[38:39], v4 offset:33024
    s_add_u32 s63, s74, 0
    buffer_load_dwordx4 v[132:135], v100, s[16:19], s63 offen offset:1024 sc1
    s_barrier
    s_setprio 3
    s_waitcnt lgkmcnt(4)
    v_mfma_f32_16x16x32_bf16 v[64:67], v[24:27], v[208:211], v[64:67]
    s_cmp_eq_u32 s36, 0
    s_cbranch_scc0 LA_dw22
    v_and_b32 v108, 3, v0
    v_lshlrev_b32 v108, 3, v108
    buffer_load_dwordx2 v[108:109], v108, s[16:19], s2 offen sc1
LA_dw22:
    v_mul_f32 v15, v55, v15
    s_add_u32 s56, s70, s80
    ds_read_b64_tr_b16 v[40:41], v1 offset:40960
    v_mfma_f32_16x16x32_bf16 v[64:67], v[28:31], v[212:215], v[64:67]
    v_exp_f32 v12, v12
    s_add_u32 s56, s56, 73728
    ds_read_b64_tr_b16 v[42:43], v1 offset:41216
    v_mfma_f32_16x16x32_bf16 v[68:71], v[24:27], v[216:219], v[68:71]
    v_exp_f32 v13, v13
    ds_read_b64_tr_b16 v[44:45], v2 offset:40960
    v_mfma_f32_16x16x32_bf16 v[68:71], v[28:31], v[220:223], v[68:71]
    v_exp_f32 v14, v14
    ds_read_b64_tr_b16 v[46:47], v2 offset:41216
    v_mfma_f32_16x16x32_bf16 v[92:95], v[88:91], v[24:27], v[92:95]
    v_exp_f32 v15, v15
    v_fma_f32 v12, v12, v21, v21
    s_add_u32 s63, s75, 0
    buffer_load_dwordx4 v[136:139], v100, s[16:19], s63 offen offset:0 sc1
    s_waitcnt lgkmcnt(4)
    v_mfma_f32_16x16x32_bf16 v[72:75], v[32:35], v[208:211], v[72:75]
    v_fma_f32 v13, v13, v21, v21
    v_fma_f32 v14, v14, v21, v21
    v_fma_f32 v15, v15, v21, v21
    s_add_u32 m0, s42, 90112
    ds_read_b64_tr_b16 v[24:25], v3 offset:40960
    buffer_load_dwordx4 v6, s[12:15], s56 offen lds
    v_mfma_f32_16x16x32_bf16 v[72:75], v[36:39], v[212:215], v[72:75]
    v_rcp_f32 v12, v12
    s_add_u32 s56, s69, 73728
    ds_read_b64_tr_b16 v[26:27], v3 offset:41216
    v_mfma_f32_16x16x32_bf16 v[76:79], v[32:35], v[216:219], v[76:79]
    v_rcp_f32 v13, v13
    v_rcp_f32 v14, v14
    s_add_u32 s57, s70, 73728
    ds_read_b64_tr_b16 v[28:29], v4 offset:40960
    v_mfma_f32_16x16x32_bf16 v[76:79], v[36:39], v[220:223], v[76:79]
    v_rcp_f32 v15, v15
    s_cmp_ge_u32 s37, 2
    s_cselect_b32 s56, s57, s56
    ds_read_b64_tr_b16 v[30:31], v4 offset:41216
    s_setprio 2
    s_waitcnt lgkmcnt(4)
    v_mfma_f32_16x16x32_bf16 v[64:67], v[40:43], v[224:227], v[64:67]
    v_mul_f32 v52, v52, v12
    v_mul_f32 v53, v53, v13
    v_mul_f32 v54, v54, v14
    s_add_u32 s56, s56, s81
    ds_read_b64_tr_b16 v[32:33], v1 offset:49152
    s_add_u32 s63, s75, 0
    buffer_load_dwordx4 v[140:143], v100, s[16:19], s63 offen offset:1024 sc1
    v_mfma_f32_16x16x32_bf16 v[64:67], v[44:47], v[228:231], v[64:67]
    v_mul_f32 v55, v55, v15
    v_cvt_pk_bf16_f32 v84, v52, v53
    v_cvt_pk_bf16_f32 v85, v54, v55
    ds_read_b64_tr_b16 v[34:35], v1 offset:49408
    v_mfma_f32_16x16x32_bf16 v[68:71], v[40:43], v[232:235], v[68:71]
    v_mul_f32 v12, v60, v60
    v_mul_f32 v13, v61, v61
    v_mul_f32 v14, v62, v62
    v_mul_f32 v15, v63, v63
    ds_read_b64_tr_b16 v[36:37], v2 offset:49152
    v_mfma_f32_16x16x32_bf16 v[68:71], v[44:47], v[236:239], v[68:71]
    v_fma_f32 v12, v12, v20, v19
    v_fma_f32 v13, v13, v20, v19
    ds_read_b64_tr_b16 v[38:39], v2 offset:49408
    v_mfma_f32_16x16x32_bf16 v[92:95], v[88:91], v[40:43], v[92:95]
    v_fma_f32 v14, v14, v20, v19
    v_fma_f32 v15, v15, v20, v19
    v_mul_f32 v12, v60, v12
    s_setprio 1
    s_waitcnt lgkmcnt(4)
    v_mfma_f32_16x16x32_bf16 v[72:75], v[24:27], v[224:227], v[72:75]
    v_mul_f32 v13, v61, v13
    v_mul_f32 v14, v62, v14
    v_mul_f32 v15, v63, v15
    s_add_u32 m0, s42, 98304
    ds_read_b64_tr_b16 v[40:41], v3 offset:49152
    buffer_load_dwordx4 v7, s[12:15], s56 offen lds
    v_mfma_f32_16x16x32_bf16 v[72:75], v[28:31], v[228:231], v[72:75]
    v_exp_f32 v12, v12
    s_add_u32 s56, s69, 73728
    ds_read_b64_tr_b16 v[42:43], v3 offset:49408
    v_mfma_f32_16x16x32_bf16 v[76:79], v[24:27], v[232:235], v[76:79]
    v_exp_f32 v13, v13
    v_exp_f32 v14, v14
    s_add_u32 s57, s70, 73728
    ds_read_b64_tr_b16 v[44:45], v4 offset:49152
    v_mfma_f32_16x16x32_bf16 v[76:79], v[28:31], v[236:239], v[76:79]
    v_exp_f32 v15, v15
    v_fma_f32 v12, v12, v21, v21
    s_cmp_ge_u32 s37, 2
    s_cselect_b32 s56, s57, s56
    ds_read_b64_tr_b16 v[46:47], v4 offset:49408
    s_waitcnt lgkmcnt(4)
    v_mfma_f32_16x16x32_bf16 v[64:67], v[32:35], v[240:243], v[64:67]
    v_fma_f32 v13, v13, v21, v21
    v_fma_f32 v14, v14, v21, v21
    v_fma_f32 v15, v15, v21, v21
    s_add_u32 s56, s56, s82
    v_add_u32 v5, 0x22000, v5
    ds_read_b64_tr_b16 v[24:25], v5 offset:0
    v_mfma_f32_16x16x32_bf16 v[64:67], v[36:39], v[244:247], v[64:67]
    v_rcp_f32 v12, v12
    ds_read_b64_tr_b16 v[26:27], v5 offset:2048
    v_mfma_f32_16x16x32_bf16 v[68:71], v[32:35], v[248:251], v[68:71]
    v_rcp_f32 v13, v13
    ds_read_b64_tr_b16 v[28:29], v5 offset:8192
    v_mfma_f32_16x16x32_bf16 v[68:71], v[36:39], v[252:255], v[68:71]
    v_rcp_f32 v14, v14
    v_rcp_f32 v15, v15
    s_add_u32 m0, s42, 106496
    ds_read_b64_tr_b16 v[30:31], v5 offset:10240
    buffer_load_dwordx4 v7, s[12:15], s56 offen lds
    v_mfma_f32_16x16x32_bf16 v[92:95], v[88:91], v[32:35], v[92:95]
    v_mul_f32 v60, v60, v12
    v_mul_f32 v61, v61, v13
    v_mul_f32 v62, v62, v14
    v_mul_f32 v63, v63, v15
    s_setprio 0
    s_waitcnt lgkmcnt(4)
    v_mfma_f32_16x16x32_bf16 v[72:75], v[40:43], v[240:243], v[72:75]
    v_cvt_pk_bf16_f32 v86, v60, v61
    v_cvt_pk_bf16_f32 v87, v62, v63
    s_cbranch_vccz LA_sw23
    v_swap_b32 v84, v86
    v_swap_b32 v85, v87
LA_sw23:
    s_add_u32 s63, s65, 33792
    buffer_store_dwordx4 v[84:87], v100, s[16:19], s63 offen sc1
    v_add_u32 v101, 0x22000, v101
    ds_read_b64_tr_b16 v[32:33], v101 offset:0
    v_mfma_f32_16x16x32_bf16 v[72:75], v[44:47], v[244:247], v[72:75]
    ds_read_b64_tr_b16 v[34:35], v101 offset:2048
    v_mfma_f32_16x16x32_bf16 v[76:79], v[40:43], v[248:251], v[76:79]
    ds_read_b64_tr_b16 v[36:37], v101 offset:8192
    v_mfma_f32_16x16x32_bf16 v[76:79], v[44:47], v[252:255], v[76:79]
    ds_read_b64_tr_b16 v[38:39], v101 offset:10240
    v_and_b32 v99, 15, v0
    v_lshl_add_u32 v99, v99, 4, s66
    ds_write_b32 v99, v92 offset:512
    s_cmp_eq_u32 s36, 0
    s_cbranch_scc0 LA_dw26
    s_waitcnt vmcnt(6)
    s_add_u32 s62, s96, 2
    v_subrev_u32 v108, s62, v108
    v_cmp_ne_u32 s[58:59], s97, v109
    v_cmp_lt_u32 s[60:61], 13, v108
    s_lshl_b32 s62, 1, s41
    s_andn2_b32 s62, 15, s62
    s_nop 0
    s_or_b32 s60, s60, s58
    s_and_b32 s60, s60, s62
    s_cbranch_scc0 LA_ok24
    s_mov_b32 s78, 200000
LA_sp25:
    s_sleep 1
    v_and_b32 v108, 3, v0
    v_lshlrev_b32 v108, 3, v108
    buffer_load_dwordx2 v[108:109], v108, s[16:19], s2 offen sc1
    s_waitcnt vmcnt(0)
    s_add_u32 s62, s96, 2
    v_subrev_u32 v108, s62, v108
    v_cmp_ne_u32 s[58:59], s97, v109
    v_cmp_lt_u32 s[60:61], 13, v108
    s_lshl_b32 s62, 1, s41
    s_andn2_b32 s62, 15, s62
    s_nop 0
    s_or_b32 s60, s60, s58
    s_and_b32 s60, s60, s62
    s_cbranch_scc0 LA_ok24
    s_sub_u32 s78, s78, 1
    s_cmp_lg_u32 s78, 0
    s_cbranch_scc1 LA_sp25
LA_ok24:
    s_nop 1
LA_dw26:
    s_waitcnt lgkmcnt(0)
    s_waitcnt vmcnt(18)
    s_barrier
    s_setprio 3
    v_mfma_f32_16x16x32_bf16 v[48:51], v[24:27], v[80:83], 0
    v_and_b32 v96, 15, v0
    v_lshl_add_u32 v22, v96, 4, s67
    ds_read_b64 v[12:13], v22 offset:512
    v_xor_b32 v22, 8, v22
    ds_read_b64 v[14:15], v22 offset:512
    v_lshl_add_u32 v96, v96, 1, s79
    s_add_u32 s56, s71, s80
    ds_read_b64_tr_b16 v[40:41], v5 offset:512
    s_add_u32 s63, s72, 16384
    buffer_load_dwordx4 v[144:147], v100, s[16:19], s63 offen offset:0 sc1
    s_waitcnt vmcnt(16)
    v_mfma_f32_16x16x32_bf16 v[48:51], v[28:31], v[112:115], v[48:51]
    ds_read_u16 v22, v96 offset:384
    v_xor_b32 v96, 32, v96
    ds_read_u16 v96, v96 offset:384
    s_add_u32 s56, s56, 73728
    ds_read_b64_tr_b16 v[42:43], v5 offset:2560
    v_mfma_f32_16x16x32_bf16 v[52:55], v[24:27], v[84:87], 0
    s_add_u32 m0, s42, 114688
    ds_read_b64_tr_b16 v[44:45], v5 offset:8704
    buffer_load_dwordx4 v6, s[12:15], s56 offen lds
    s_waitcnt vmcnt(15)
    v_mfma_f32_16x16x32_bf16 v[52:55], v[28:31], v[116:119], v[52:55]
    s_add_u32 s56, s68, s80
    ds_read_b64_tr_b16 v[46:47], v5 offset:10752
    v_mfma_f32_16x16x32_bf16 v[56:59], v[32:35], v[80:83], 0
    s_add_u32 s56, s56, 221184
    ds_read_b64_tr_b16 v[24:25], v101 offset:512
    v_mfma_f32_16x16x32_bf16 v[56:59], v[36:39], v[112:115], v[56:59]
    s_waitcnt lgkmcnt(8)
    v_add_f32 v12, v12, v13
    s_waitcnt lgkmcnt(7)
    v_add_f32 v14, v14, v15
    s_waitcnt lgkmcnt(5)
    v_lshlrev_b32 v22, 16, v22
    s_waitcnt lgkmcnt(4)
    v_lshlrev_b32 v96, 16, v96
    v_cvt_pk_bf16_f32 v23, v12, v22
    v_cvt_pk_bf16_f32 v97, v14, v96
    ds_read_b64_tr_b16 v[26:27], v101 offset:2560
    s_add_u32 s63, s72, 16384
    buffer_load_dwordx4 v[148:151], v100, s[16:19], s63 offen offset:1024 sc1
    v_mfma_f32_16x16x32_bf16 v[60:63], v[32:35], v[84:87], 0
    v_lshlrev_b32 v13, 16, v23
    v_lshlrev_b32 v15, 16, v97
    v_sub_f32 v12, v12, v13
    v_sub_f32 v14, v14, v15
    v_cvt_pk_bf16_f32 v22, v13, v12
    ds_read_b64_tr_b16 v[28:29], v101 offset:8704
    v_mfma_f32_16x16x32_bf16 v[60:63], v[36:39], v[116:119], v[60:63]
    v_cvt_pk_bf16_f32 v96, v15, v14
    ds_read_b64_tr_b16 v[30:31], v101 offset:10752
    s_setprio 2
    s_waitcnt lgkmcnt(4)
    v_mfma_f32_16x16x32_bf16 v[104:107], v[40:43], v[80:83], 0
    v_mfma_f32_16x16x16_bf16 v[232:235], v[22:23], v[8:9], v[64:67]
    v_mfma_f32_16x16x16_bf16 v[236:239], v[22:23], v[10:11], v[68:71]
    v_mfma_f32_16x16x16_bf16 v[240:243], v[96:97], v[8:9], v[72:75]
    v_mfma_f32_16x16x16_bf16 v[244:247], v[96:97], v[10:11], v[76:79]
    ds_read_b64_tr_b16 v[32:33], v102 offset:8192
    v_mfma_f32_16x16x32_bf16 v[104:107], v[44:47], v[112:115], v[104:107]
    ds_read_b64_tr_b16 v[34:35], v102 offset:9216
    v_mfma_f32_16x16x32_bf16 v[108:111], v[40:43], v[84:87], 0
    s_nop 0
    v_mul_f32 v12, v232, v232
    v_mul_f32 v13, v233, v233
    v_mul_f32 v14, v234, v234
    v_mul_f32 v15, v235, v235
    v_fma_f32 v12, v12, v17, v16
    v_fma_f32 v13, v13, v17, v16
    s_add_u32 m0, s42, 122880
    ds_read_b64_tr_b16 v[36:37], v102 offset:10240
    buffer_load_dwordx4 v6, s[12:15], s56 offen lds
    v_mfma_f32_16x16x32_bf16 v[108:111], v[44:47], v[116:119], v[108:111]
    v_fma_f32 v14, v14, v17, v16
    v_fma_f32 v15, v15, v17, v16
    v_mul_f32 v12, v232, v12
    v_mul_f32 v13, v233, v13
    v_mul_f32 v14, v234, v14
    s_add_u32 s56, s71, 73728
    ds_read_b64_tr_b16 v[38:39], v102 offset:11264
    s_add_u32 s63, s73, 16384
    buffer_load_dwordx4 v[152:155], v100, s[16:19], s63 offen offset:0 sc1
    s_waitcnt lgkmcnt(4)
    v_mfma_f32_16x16x32_bf16 v[248:251], v[24:27], v[80:83], 0
    v_mul_f32 v15, v235, v15
    v_exp_f32 v12, v12
    v_exp_f32 v13, v13
    s_add_u32 s57, s68, 221184
    ds_read_b64_tr_b16 v[40:41], v103 offset:8192
    v_mfma_f32_16x16x32_bf16 v[248:251], v[28:31], v[112:115], v[248:251]
    v_exp_f32 v14, v14
    v_exp_f32 v15, v15
    v_fma_f32 v12, v12, v18, v18
    s_cmp_ge_u32 s37, 2
    s_cselect_b32 s56, s57, s56
    ds_read_b64_tr_b16 v[42:43], v103 offset:9216
    v_mfma_f32_16x16x32_bf16 v[252:255], v[24:27], v[84:87], 0
    v_fma_f32 v13, v13, v18, v18
    v_fma_f32 v14, v14, v18, v18
    v_fma_f32 v15, v15, v18, v18
    v_rcp_f32 v12, v12
    s_add_u32 s56, s56, s81
    ds_read_b64_tr_b16 v[44:45], v103 offset:10240
    v_mfma_f32_16x16x32_bf16 v[252:255], v[28:31], v[116:119], v[252:255]
    v_rcp_f32 v13, v13
    v_rcp_f32 v14, v14
    ds_read_b64_tr_b16 v[46:47], v103 offset:11264
    s_setprio 1
    s_waitcnt lgkmcnt(4)
    v_mfma_f32_16x16x32_bf16 v[88:91], v[32:35], v[80:83], 0
    v_rcp_f32 v15, v15
    v_mul_f32 v232, v232, v12
    v_mul_f32 v233, v233, v13
    v_mul_f32 v234, v234, v14
    v_mul_f32 v235, v235, v15
    ds_read_b64_tr_b16 v[24:25], v102 offset:16384
    s_add_u32 s63, s73, 16384
    buffer_load_dwordx4 v[156:159], v100, s[16:19], s63 offen offset:1024 sc1
    v_mfma_f32_16x16x32_bf16 v[88:91], v[36:39], v[112:115], v[88:91]
    v_cvt_pk_bf16_f32 v176, v232, v233
    v_cvt_pk_bf16_f32 v177, v234, v235
    v_mul_f32 v12, v240, v240
    v_mul_f32 v13, v241, v241
    v_mul_f32 v14, v242, v242
    ds_read_b64_tr_b16 v[26:27], v102 offset:17408
    v_mfma_f32_16x16x32_bf16 v[92:95], v[32:35], v[84:87], 0
    v_mul_f32 v15, v243, v243
    v_fma_f32 v12, v12, v17, v16
    v_fma_f32 v13, v13, v17, v16
    v_fma_f32 v14, v14, v17, v16
    v_fma_f32 v15, v15, v17, v16
    ds_read_b64_tr_b16 v[28:29], v102 offset:18432
    v_mfma_f32_16x16x32_bf16 v[92:95], v[36:39], v[116:119], v[92:95]
    v_mul_f32 v12, v240, v12
    v_mul_f32 v13, v241, v13
    v_mul_f32 v14, v242, v14
    v_mul_f32 v15, v243, v15
    s_add_u32 m0, s42, 131072
    ds_read_b64_tr_b16 v[30:31], v102 offset:19456
    buffer_load_dwordx4 v7, s[12:15], s56 offen lds
    s_waitcnt lgkmcnt(4)
    v_mfma_f32_16x16x32_bf16 v[64:67], v[40:43], v[80:83], 0
    v_exp_f32 v12, v12
    v_exp_f32 v13, v13
    v_exp_f32 v14, v14
    ds_read_b64_tr_b16 v[32:33], v103 offset:16384
    v_mfma_f32_16x16x32_bf16 v[64:67], v[44:47], v[112:115], v[64:67]
    v_exp_f32 v15, v15
    v_fma_f32 v12, v12, v18, v18
    v_fma_f32 v13, v13, v18, v18
    v_fma_f32 v14, v14, v18, v18
    ds_read_b64_tr_b16 v[34:35], v103 offset:17408
    s_add_u32 s63, s74, 16384
    buffer_load_dwordx4 v[160:163], v100, s[16:19], s63 offen offset:0 sc1
    v_mfma_f32_16x16x32_bf16 v[68:71], v[40:43], v[84:87], 0
    v_fma_f32 v15, v15, v18, v18
    v_rcp_f32 v12, v12
    v_rcp_f32 v13, v13
    ds_read_b64_tr_b16 v[36:37], v103 offset:18432
    v_mfma_f32_16x16x32_bf16 v[68:71], v[44:47], v[116:119], v[68:71]
    v_rcp_f32 v14, v14
    v_rcp_f32 v15, v15
    v_mul_f32 v240, v240, v12
    ds_read_b64_tr_b16 v[38:39], v103 offset:19456
    s_setprio 0
    s_waitcnt lgkmcnt(4)
    v_mfma_f32_16x16x32_bf16 v[72:75], v[24:27], v[80:83], 0
    v_mul_f32 v241, v241, v13
    v_mul_f32 v242, v242, v14
    v_mul_f32 v243, v243, v15
    v_cvt_pk_bf16_f32 v178, v240, v241
    v_cvt_pk_bf16_f32 v179, v242, v243
    v_add_u32 v5, 0xfffe4000, v5
    ds_read_b64_tr_b16 v[40:41], v5 offset:0
    v_mfma_f32_16x16x32_bf16 v[72:75], v[28:31], v[112:115], v[72:75]
    s_cbranch_vccz LA_sw27
    v_swap_b32 v176, v178
    v_swap_b32 v177, v179
LA_sw27:
    s_add_u32 s63, s65, 49152
    buffer_store_dwordx4 v[176:179], v100, s[16:19], s63 offen sc1
    v_mul_f32 v12, v236, v236
    v_mul_f32 v13, v237, v237
    v_mul_f32 v14, v238, v238
    ds_read_b64_tr_b16 v[42:43], v5 offset:2048
    v_mfma_f32_16x16x32_bf16 v[76:79], v[24:27], v[84:87], 0
    v_mul_f32 v15, v239, v239
    v_fma_f32 v12, v12, v20, v19
    v_fma_f32 v13, v13, v20, v19
    v_fma_f32 v14, v14, v20, v19
    v_fma_f32 v15, v15, v20, v19
    ds_read_b64_tr_b16 v[44:45], v5 offset:8192
    s_add_u32 s63, s74, 16384
    buffer_load_dwordx4 v[164:167], v100, s[16:19], s63 offen offset:1024 sc1
    v_mfma_f32_16x16x32_bf16 v[76:79], v[28:31], v[116:119], v[76:79]
    v_mul_f32 v12, v236, v12
    v_mul_f32 v13, v237, v13
    v_mul_f32 v14, v238, v14
    v_mul_f32 v15, v239, v15
    ds_read_b64_tr_b16 v[46:47], v5 offset:10240
    s_waitcnt lgkmcnt(4)
    v_mfma_f32_16x16x32_bf16 v[8:11], v[32:35], v[80:83], 0
    v_exp_f32 v12, v12
    v_exp_f32 v13, v13
    v_exp_f32 v14, v14
    v_add_u32 v101, 0xfffe4000, v101
    ds_read_b64_tr_b16 v[24:25], v101 offset:0
    v_mfma_f32_16x16x32_bf16 v[8:11], v[36:39], v[112:115], v[8:11]
    v_exp_f32 v15, v15
    v_fma_f32 v12, v12, v21, v21
    v_fma_f32 v13, v13, v21, v21
    ds_read_b64_tr_b16 v[26:27], v101 offset:2048
    v_mfma_f32_16x16x32_bf16 v[96:99], v[32:35], v[84:87], 0
    v_fma_f32 v14, v14, v21, v21
    v_fma_f32 v15, v15, v21, v21
    v_rcp_f32 v12, v12
    ds_read_b64_tr_b16 v[28:29], v101 offset:8192
    v_mfma_f32_16x16x32_bf16 v[96:99], v[36:39], v[116:119], v[96:99]
    v_rcp_f32 v13, v13
    v_rcp_f32 v14, v14
    v_rcp_f32 v15, v15
    ds_read_b64_tr_b16 v[30:31], v101 offset:10240
    s_add_u32 s63, s75, 16384
    buffer_load_dwordx4 v[168:171], v100, s[16:19], s63 offen offset:0 sc1
    s_waitcnt vmcnt(22)
    s_waitcnt vmcnt(11)
    s_barrier
    s_cmp_eq_u32 s36, 0
    s_cbranch_scc0 LA_dw28
    s_add_u32 s63, s96, 3
    v_mov_b32 v2, s63
    v_mov_b32 v3, s97
    s_mul_i32 s62, s41, 120
    s_sub_u32 s62, s2, s62
    s_lshl_b32 s63, s41, 3
    s_lshl_b32 s63, 1, s63
    s_andn2_b32 exec_lo, 0x01010101, s63
    s_mov_b32 exec_hi, 0
    buffer_store_dwordx2 v[2:3], v100, s[16:19], s62 offen sc1
    s_mov_b64 exec, -1
LA_dw28:
    s_setprio 3
    s_waitcnt lgkmcnt(4)
    v_mfma_f32_16x16x32_bf16 v[48:51], v[40:43], v[120:123], v[48:51]
    v_mul_f32 v236, v236, v12
    v_mul_f32 v237, v237, v13
    v_mul_f32 v238, v238, v14
    v_mul_f32 v239, v239, v15
    v_cvt_pk_bf16_f32 v180, v236, v237
    s_add_u32 s56, s71, 73728
    ds_read_b64_tr_b16 v[32:33], v5 offset:512
    v_mfma_f32_16x16x32_bf16 v[48:51], v[44:47], v[128:131], v[48:51]
    v_cvt_pk_bf16_f32 v181, v238, v239
    v_mul_f32 v12, v244, v244
    v_mul_f32 v13, v245, v245
    v_mul_f32 v14, v246, v246
    v_mul_f32 v15, v247, v247
    s_add_u32 s57, s68, 221184
    ds_read_b64_tr_b16 v[34:35], v5 offset:2560
    v_mfma_f32_16x16x32_bf16 v[52:55], v[40:43], v[124:127], v[52:55]
    v_fma_f32 v12, v12, v20, v19
    v_fma_f32 v13, v13, v20, v19
    v_fma_f32 v14, v14, v20, v19
    v_fma_f32 v15, v15, v20, v19
    v_mul_f32 v12, v244, v12
    s_cmp_ge_u32 s37, 2
    s_cselect_b32 s56, s57, s56
    ds_read_b64_tr_b16 v[36:37], v5 offset:8704
    v_mfma_f32_16x16x32_bf16 v[52:55], v[44:47], v[132:135], v[52:55]
    v_mul_f32 v13, v245, v13
    v_mul_f32 v14, v246, v14
    v_mul_f32 v15, v247, v15
    v_exp_f32 v12, v12
    s_add_u32 s56, s56, s82
    ds_read_b64_tr_b16 v[38:39], v5 offset:10752
    s_waitcnt lgkmcnt(4)
    v_mfma_f32_16x16x32_bf16 v[56:59], v[24:27], v[120:123], v[56:59]
    v_exp_f32 v13, v13
    v_exp_f32 v14, v14
    s_add_u32 m0, s42, 139264
    ds_read_b64_tr_b16 v[40:41], v101 offset:512
    buffer_load_dwordx4 v7, s[12:15], s56 offen lds
    v_mfma_f32_16x16x32_bf16 v[56:59], v[28:31], v[128:131], v[56:59]
    v_exp_f32 v15, v15
    v_fma_f32 v12, v12, v21, v21
    v_fma_f32 v13, v13, v21, v21
    v_fma_f32 v14, v14, v21, v21
    v_fma_f32 v15, v15, v21, v21
    s_add_u32 s56, s69, s80
    ds_read_b64_tr_b16 v[42:43], v101 offset:2560
    s_add_u32 s63, s75, 16384
    buffer_load_dwordx4 v[172:175], v100, s[16:19], s63 offen offset:1024 sc1
    v_mfma_f32_16x16x32_bf16 v[60:63], v[24:27], v[124:127], v[60:63]
    v_rcp_f32 v12, v12
    v_rcp_f32 v13, v13
    s_add_u32 s56, s56, 147456
    ds_read_b64_tr_b16 v[44:45], v101 offset:8704
    v_mfma_f32_16x16x32_bf16 v[60:63], v[28:31], v[132:135], v[60:63]
    v_rcp_f32 v14, v14
    v_rcp_f32 v15, v15
    v_mul_f32 v244, v244, v12
    v_mul_f32 v245, v245, v13
    ds_read_b64_tr_b16 v[46:47], v101 offset:10752
    s_setprio 2
    s_waitcnt lgkmcnt(4)
    v_mfma_f32_16x16x32_bf16 v[104:107], v[32:35], v[120:123], v[104:107]
    v_mul_f32 v246, v246, v14
    v_mul_f32 v247, v247, v15
    v_cvt_pk_bf16_f32 v182, v244, v245
    v_cvt_pk_bf16_f32 v183, v246, v247
    s_cbranch_vccz LA_sw29
    v_swap_b32 v180, v182
    v_swap_b32 v181, v183
LA_sw29:
    s_add_u32 s63, s65, 50176
    buffer_store_dwordx4 v[180:183], v100, s[16:19], s63 offen sc1
    ds_read_b64_tr_b16 v[24:25], v102 offset:40960
    v_mfma_f32_16x16x32_bf16 v[104:107], v[36:39], v[128:131], v[104:107]
    ds_read_b64_tr_b16 v[26:27], v102 offset:41984
    v_mfma_f32_16x16x32_bf16 v[108:111], v[32:35], v[124:127], v[108:111]
    ds_read_b64_tr_b16 v[28:29], v102 offset:43008
    v_mfma_f32_16x16x32_bf16 v[108:111], v[36:39], v[132:135], v[108:111]
    ds_read_b64_tr_b16 v[30:31], v102 offset:44032
    s_waitcnt lgkmcnt(4)
    v_mfma_f32_16x16x32_bf16 v[248:251], v[40:43], v[120:123], v[248:251]
    s_add_u32 m0, s42, 147456
    ds_read_b64_tr_b16 v[32:33], v103 offset:40960
    buffer_load_dwordx4 v6, s[12:15], s56 offen lds
    v_mfma_f32_16x16x32_bf16 v[248:251], v[44:47], v[128:131], v[248:251]
    s_add_u32 s56, s70, s80
    ds_read_b64_tr_b16 v[34:35], v103 offset:41984
    v_mfma_f32_16x16x32_bf16 v[252:255], v[40:43], v[124:127], v[252:255]
    s_add_u32 s56, s56, 147456
    ds_read_b64_tr_b16 v[36:37], v103 offset:43008
    v_mfma_f32_16x16x32_bf16 v[252:255], v[44:47], v[132:135], v[252:255]
    ds_read_b64_tr_b16 v[38:39], v103 offset:44032
    s_setprio 1
    s_waitcnt lgkmcnt(4)
    v_mfma_f32_16x16x32_bf16 v[88:91], v[24:27], v[120:123], v[88:91]
    ds_read_b64_tr_b16 v[40:41], v102 offset:49152
    v_mfma_f32_16x16x32_bf16 v[88:91], v[28:31], v[128:131], v[88:91]
    ds_read_b64_tr_b16 v[42:43], v102 offset:50176
    v_mfma_f32_16x16x32_bf16 v[92:95], v[24:27], v[124:127], v[92:95]
    ds_read_b64_tr_b16 v[44:45], v102 offset:51200
    v_mfma_f32_16x16x32_bf16 v[92:95], v[28:31], v[132:135], v[92:95]
    s_add_u32 m0, s42, 8192
    ds_read_b64_tr_b16 v[46:47], v102 offset:52224
    buffer_load_dwordx4 v6, s[12:15], s56 offen lds
    s_waitcnt lgkmcnt(4)
    v_mfma_f32_16x16x32_bf16 v[64:67], v[32:35], v[120:123], v[64:67]
    s_add_u32 s56, s69, 147456
    ds_read_b64_tr_b16 v[24:25], v103 offset:49152
    v_mfma_f32_16x16x32_bf16 v[64:67], v[36:39], v[128:131], v[64:67]
    s_add_u32 s57, s70, 147456
    ds_read_b64_tr_b16 v[26:27], v103 offset:50176
    v_mfma_f32_16x16x32_bf16 v[68:71], v[32:35], v[124:127], v[68:71]
    s_cmp_ge_u32 s37, 2
    s_cselect_b32 s56, s57, s56
    ds_read_b64_tr_b16 v[28:29], v103 offset:51200
    v_mfma_f32_16x16x32_bf16 v[68:71], v[36:39], v[132:135], v[68:71]
    s_add_u32 s56, s56, s81
    ds_read_b64_tr_b16 v[30:31], v103 offset:52224
    s_setprio 0
    s_waitcnt lgkmcnt(4)
    v_mfma_f32_16x16x32_bf16 v[72:75], v[40:43], v[120:123], v[72:75]
    ds_read_b64_tr_b16 v[32:33], v5 offset:32768
    v_mfma_f32_16x16x32_bf16 v[72:75], v[44:47], v[128:131], v[72:75]
    ds_read_b64_tr_b16 v[34:35], v5 offset:34816
    v_mfma_f32_16x16x32_bf16 v[76:79], v[40:43], v[124:127], v[76:79]
    s_add_u32 m0, s42, 16384
    ds_read_b64_tr_b16 v[36:37], v5 offset:40960
    buffer_load_dwordx4 v7, s[12:15], s56 offen lds
    v_mfma_f32_16x16x32_bf16 v[76:79], v[44:47], v[132:135], v[76:79]
    ds_read_b64_tr_b16 v[38:39], v5 offset:43008
    s_waitcnt lgkmcnt(4)
    v_mfma_f32_16x16x32_bf16 v[8:11], v[24:27], v[120:123], v[8:11]
    ds_read_b64_tr_b16 v[40:41], v101 offset:32768
    v_mfma_f32_16x16x32_bf16 v[8:11], v[28:31], v[128:131], v[8:11]
    ds_read_b64_tr_b16 v[42:43], v101 offset:34816
    v_mfma_f32_16x16x32_bf16 v[96:99], v[24:27], v[124:127], v[96:99]
    ds_read_b64_tr_b16 v[44:45], v101 offset:40960
    v_mfma_f32_16x16x32_bf16 v[96:99], v[28:31], v[132:135], v[96:99]
    ds_read_b64_tr_b16 v[46:47], v101 offset:43008
    s_waitcnt vmcnt(3)
    s_barrier
    s_cmp_eq_u32 s36, 0
    s_cbranch_scc0 LA_dw30
    s_add_u32 s63, s96, 15
    v_mov_b32 v2, s63
    v_mov_b32 v3, s97
    s_mul_i32 s62, s41, 120
    s_sub_u32 s62, s2, s62
    s_lshl_b32 s63, s41, 3
    s_lshl_b32 s63, 1, s63
    s_andn2_b32 exec_lo, 0x01010101, s63
    s_mov_b32 exec_hi, 0
    buffer_store_dwordx2 v[2:3], v100, s[16:19], s62 offen sc1
    s_mov_b64 exec, -1
LA_dw30:
    s_setprio 3
    s_waitcnt lgkmcnt(4)
    v_mfma_f32_16x16x32_bf16 v[48:51], v[32:35], v[136:139], v[48:51]
    s_cmp_eq_u32 s36, 0
    s_cbranch_scc0 LA_dw31
    v_and_b32 v224, 3, v0
    v_lshlrev_b32 v224, 3, v224
    buffer_load_dwordx2 v[224:225], v224, s[16:19], s2 offen sc1
LA_dw31:
    s_add_u32 s56, s69, 147456
    ds_read_b64_tr_b16 v[24:25], v5 offset:33280
    v_mfma_f32_16x16x32_bf16 v[48:51], v[36:39], v[144:147], v[48:51]
    s_add_u32 s57, s70, 147456
    ds_read_b64_tr_b16 v[26:27], v5 offset:35328
    v_mfma_f32_16x16x32_bf16 v[52:55], v[32:35], v[140:143], v[52:55]
    s_cmp_ge_u32 s37, 2
    s_cselect_b32 s56, s57, s56
    ds_read_b64_tr_b16 v[28:29], v5 offset:41472
    v_mfma_f32_16x16x32_bf16 v[52:55], v[36:39], v[148:151], v[52:55]
    s_add_u32 s56, s56, s82
    ds_read_b64_tr_b16 v[30:31], v5 offset:43520
    s_waitcnt lgkmcnt(4)
    v_mfma_f32_16x16x32_bf16 v[56:59], v[40:43], v[136:139], v[56:59]
    s_add_u32 m0, s42, 24576
    ds_read_b64_tr_b16 v[32:33], v101 offset:33280
    buffer_load_dwordx4 v7, s[12:15], s56 offen lds
    v_mfma_f32_16x16x32_bf16 v[56:59], v[44:47], v[144:147], v[56:59]
    s_add_u32 s56, s71, s80
    ds_read_b64_tr_b16 v[34:35], v101 offset:35328
    v_mfma_f32_16x16x32_bf16 v[60:63], v[40:43], v[140:143], v[60:63]
    s_add_u32 s56, s56, 147456
    ds_read_b64_tr_b16 v[36:37], v101 offset:41472
    v_mfma_f32_16x16x32_bf16 v[60:63], v[44:47], v[148:151], v[60:63]
    ds_read_b64_tr_b16 v[38:39], v101 offset:43520
    s_setprio 2
    s_waitcnt lgkmcnt(4)
    v_mfma_f32_16x16x32_bf16 v[104:107], v[24:27], v[136:139], v[104:107]
    v_add_u32 v102, 0x12000, v102
    ds_read_b64_tr_b16 v[40:41], v102 offset:0
    v_mfma_f32_16x16x32_bf16 v[104:107], v[28:31], v[144:147], v[104:107]
    ds_read_b64_tr_b16 v[42:43], v102 offset:1024
    v_mfma_f32_16x16x32_bf16 v[108:111], v[24:27], v[140:143], v[108:111]
    ds_read_b64_tr_b16 v[44:45], v102 offset:2048
    v_mfma_f32_16x16x32_bf16 v[108:111], v[28:31], v[148:151], v[108:111]
    s_add_u32 m0, s42, 32768
    ds_read_b64_tr_b16 v[46:47], v102 offset:3072
    buffer_load_dwordx4 v6, s[12:15], s56 offen lds
    s_waitcnt lgkmcnt(4)
    v_mfma_f32_16x16x32_bf16 v[248:251], v[32:35], v[136:139], v[248:251]
    s_add_u32 s56, s69, s80
    v_add_u32 v103, 0x12000, v103
    ds_read_b64_tr_b16 v[24:25], v103 offset:0
    v_mfma_f32_16x16x32_bf16 v[248:251], v[36:39], v[144:147], v[248:251]
    s_add_u32 s56, s56, 221184
    ds_read_b64_tr_b16 v[26:27], v103 offset:1024
    v_mfma_f32_16x16x32_bf16 v[252:255], v[32:35], v[140:143], v[252:255]
    ds_read_b64_tr_b16 v[28:29], v103 offset:2048
    v_mfma_f32_16x16x32_bf16 v[252:255], v[36:39], v[148:151], v[252:255]
    ds_read_b64_tr_b16 v[30:31], v103 offset:3072
    s_setprio 1
    s_waitcnt lgkmcnt(4)
    v_mfma_f32_16x16x32_bf16 v[88:91], v[40:43], v[136:139], v[88:91]
    v_add_u32 v102, 0x14000, v102
    ds_read_b64_tr_b16 v[32:33], v102 offset:0
    v_mfma_f32_16x16x32_bf16 v[88:91], v[44:47], v[144:147], v[88:91]
    ds_read_b64_tr_b16 v[34:35], v102 offset:1024
    v_mfma_f32_16x16x32_bf16 v[92:95], v[40:43], v[140:143], v[92:95]
    s_add_u32 m0, s42, 40960
    ds_read_b64_tr_b16 v[36:37], v102 offset:2048
    buffer_load_dwordx4 v6, s[12:15], s56 offen lds
    v_mfma_f32_16x16x32_bf16 v[92:95], v[44:47], v[148:151], v[92:95]
    s_add_u32 s56, s71, 147456
    ds_read_b64_tr_b16 v[38:39], v102 offset:3072
    s_waitcnt lgkmcnt(4)
    v_mfma_f32_16x16x32_bf16 v[64:67], v[24:27], v[136:139], v[64:67]
    s_add_u32 s57, s69, 221184
    v_add_u32 v103, 0x14000, v103
    ds_read_b64_tr_b16 v[40:41], v103 offset:0
    v_mfma_f32_16x16x32_bf16 v[64:67], v[28:31], v[144:147], v[64:67]
    s_cmp_ge_u32 s37, 2
    s_cselect_b32 s56, s57, s56
    ds_read_b64_tr_b16 v[42:43], v103 offset:1024
    v_mfma_f32_16x16x32_bf16 v[68:71], v[24:27], v[140:143], v[68:71]
    s_add_u32 s56, s56, s81
    ds_read_b64_tr_b16 v[44:45], v103 offset:2048
    v_mfma_f32_16x16x32_bf16 v[68:71], v[28:31], v[148:151], v[68:71]
    ds_read_b64_tr_b16 v[46:47], v103 offset:3072
    s_setprio 0
    s_waitcnt lgkmcnt(4)
    v_mfma_f32_16x16x32_bf16 v[72:75], v[32:35], v[136:139], v[72:75]
    ds_read_b64_tr_b16 v[24:25], v5 offset:57344
    v_mfma_f32_16x16x32_bf16 v[72:75], v[36:39], v[144:147], v[72:75]
    s_add_u32 m0, s42, 49152
    ds_read_b64_tr_b16 v[26:27], v5 offset:59392
    buffer_load_dwordx4 v7, s[12:15], s56 offen lds
    v_mfma_f32_16x16x32_bf16 v[76:79], v[32:35], v[140:143], v[76:79]
    v_add_u32 v5, 0x10000, v5
    ds_read_b64_tr_b16 v[28:29], v5 offset:0
    v_mfma_f32_16x16x32_bf16 v[76:79], v[36:39], v[148:151], v[76:79]
    ds_read_b64_tr_b16 v[30:31], v5 offset:2048
    s_waitcnt lgkmcnt(4)
    v_mfma_f32_16x16x32_bf16 v[8:11], v[40:43], v[136:139], v[8:11]
    ds_read_b64_tr_b16 v[32:33], v101 offset:57344
    v_mfma_f32_16x16x32_bf16 v[8:11], v[44:47], v[144:147], v[8:11]
    ds_read_b64_tr_b16 v[34:35], v101 offset:59392
    v_mfma_f32_16x16x32_bf16 v[96:99], v[40:43], v[140:143], v[96:99]
    v_add_u32 v101, 0x10000, v101
    ds_read_b64_tr_b16 v[36:37], v101 offset:0
    v_mfma_f32_16x16x32_bf16 v[96:99], v[44:47], v[148:151], v[96:99]
    ds_read_b64_tr_b16 v[38:39], v101 offset:2048
    s_cmp_eq_u32 s36, 0
    s_cbranch_scc0 LA_dw34
    s_waitcnt vmcnt(4)
    s_add_u32 s62, s96, 3
    v_subrev_u32 v224, s62, v224
    v_cmp_ne_u32 s[58:59], s97, v225
    v_cmp_lt_u32 s[60:61], 12, v224
    s_lshl_b32 s62, 1, s41
    s_andn2_b32 s62, 15, s62
    s_nop 0
    s_or_b32 s60, s60, s58
    s_and_b32 s60, s60, s62
    s_cbranch_scc0 LA_ok32
    s_mov_b32 s78, 200000
LA_sp33:
    s_sleep 1
    v_and_b32 v224, 3, v0
    v_lshlrev_b32 v224, 3, v224
    buffer_load_dwordx2 v[224:225], v224, s[16:19], s2 offen sc1
    s_waitcnt vmcnt(0)
    s_add_u32 s62, s96, 3
    v_subrev_u32 v224, s62, v224
    v_cmp_ne_u32 s[58:59], s97, v225
    v_cmp_lt_u32 s[60:61], 12, v224
    s_lshl_b32 s62, 1, s41
    s_andn2_b32 s62, 15, s62
    s_nop 0
    s_or_b32 s60, s60, s58
    s_and_b32 s60, s60, s62
    s_cbranch_scc0 LA_ok32
    s_sub_u32 s78, s78, 1
    s_cmp_lg_u32 s78, 0
    s_cbranch_scc1 LA_sp33
LA_ok32:
    s_nop 1
LA_dw34:
    s_barrier
    s_setprio 3
    s_waitcnt lgkmcnt(4)
    v_mfma_f32_16x16x32_bf16 v[48:51], v[24:27], v[152:155], v[48:51]
    s_add_u32 s56, s71, 147456
    v_add_u32 v5, 0xffffe000, v5
    ds_read_b64_tr_b16 v[40:41], v5 offset:512
    s_add_u32 s63, s73, 32768
    buffer_load_dwordx4 v[184:187], v100, s[16:19], s63 offen offset:0 sc1
    v_mfma_f32_16x16x32_bf16 v[48:51], v[28:31], v[160:163], v[48:51]
    s_add_u32 s57, s69, 221184
    ds_read_b64_tr_b16 v[42:43], v5 offset:2560
    v_mfma_f32_16x16x32_bf16 v[52:55], v[24:27], v[156:159], v[52:55]
    s_cmp_ge_u32 s37, 2
    s_cselect_b32 s56, s57, s56
    ds_read_b64_tr_b16 v[44:45], v5 offset:8704
    v_mfma_f32_16x16x32_bf16 v[52:55], v[28:31], v[164:167], v[52:55]
    s_add_u32 s56, s56, s82
    ds_read_b64_tr_b16 v[46:47], v5 offset:10752
    s_waitcnt lgkmcnt(4)
    v_mfma_f32_16x16x32_bf16 v[56:59], v[32:35], v[152:155], v[56:59]
    s_add_u32 m0, s42, 57344
    v_add_u32 v101, 0xffffe000, v101
    ds_read_b64_tr_b16 v[24:25], v101 offset:512
    buffer_load_dwordx4 v7, s[12:15], s56 offen lds
    v_mfma_f32_16x16x32_bf16 v[56:59], v[36:39], v[160:163], v[56:59]
    s_add_u32 s56, s70, s80
    ds_read_b64_tr_b16 v[26:27], v101 offset:2560
    s_add_u32 s63, s73, 32768
    buffer_load_dwordx4 v[188:191], v100, s[16:19], s63 offen offset:1024 sc1
    v_mfma_f32_16x16x32_bf16 v[60:63], v[32:35], v[156:159], v[60:63]
    s_add_u32 s56, s56, 221184
    ds_read_b64_tr_b16 v[28:29], v101 offset:8704
    v_mfma_f32_16x16x32_bf16 v[60:63], v[36:39], v[164:167], v[60:63]
    ds_read_b64_tr_b16 v[30:31], v101 offset:10752
    s_setprio 2
    s_waitcnt lgkmcnt(4)
    v_mfma_f32_16x16x32_bf16 v[104:107], v[40:43], v[152:155], v[104:107]
    v_add_u32 v102, 0xffff2000, v102
    ds_read_b64_tr_b16 v[32:33], v102 offset:0
    v_mfma_f32_16x16x32_bf16 v[104:107], v[44:47], v[160:163], v[104:107]
    ds_read_b64_tr_b16 v[34:35], v102 offset:1024
    v_mfma_f32_16x16x32_bf16 v[108:111], v[40:43], v[156:159], v[108:111]
    ds_read_b64_tr_b16 v[36:37], v102 offset:2048
    s_add_u32 s63, s74, 32768
    buffer_load_dwordx4 v[192:195], v100, s[16:19], s63 offen offset:0 sc1
    v_mfma_f32_16x16x32_bf16 v[108:111], v[44:47], v[164:167], v[108:111]
    ds_read_b64_tr_b16 v[38:39], v102 offset:3072
    s_waitcnt lgkmcnt(4)
    v_mfma_f32_16x16x32_bf16 v[248:251], v[24:27], v[152:155], v[248:251]
    v_add_u32 v103, 0xffff2000, v103
    ds_read_b64_tr_b16 v[40:41], v103 offset:0
    v_mfma_f32_16x16x32_bf16 v[248:251], v[28:31], v[160:163], v[248:251]
    s_add_u32 m0, s42, 65536
    ds_read_b64_tr_b16 v[42:43], v103 offset:1024
    buffer_load_dwordx4 v6, s[12:15], s56 offen lds
    v_mfma_f32_16x16x32_bf16 v[252:255], v[24:27], v[156:159], v[252:255]
    s_add_u32 s56, s71, s80
    ds_read_b64_tr_b16 v[44:45], v103 offset:2048
    v_mfma_f32_16x16x32_bf16 v[252:255], v[28:31], v[164:167], v[252:255]
    s_add_u32 s56, s56, 221184
    ds_read_b64_tr_b16 v[46:47], v103 offset:3072
    s_add_u32 s63, s74, 32768
    buffer_load_dwordx4 v[196:199], v100, s[16:19], s63 offen offset:1024 sc1
    s_setprio 1
    s_waitcnt lgkmcnt(4)
    v_mfma_f32_16x16x32_bf16 v[88:91], v[32:35], v[152:155], v[88:91]
    ds_read_b64_tr_b16 v[24:25], v102 offset:8192
    v_mfma_f32_16x16x32_bf16 v[88:91], v[36:39], v[160:163], v[88:91]
    ds_read_b64_tr_b16 v[26:27], v102 offset:9216
    v_mfma_f32_16x16x32_bf16 v[92:95], v[32:35], v[156:159], v[92:95]
    ds_read_b64_tr_b16 v[28:29], v102 offset:10240
    v_mfma_f32_16x16x32_bf16 v[92:95], v[36:39], v[164:167], v[92:95]
    ds_read_b64_tr_b16 v[30:31], v102 offset:11264
    s_waitcnt lgkmcnt(4)
    v_mfma_f32_16x16x32_bf16 v[64:67], v[40:43], v[152:155], v[64:67]
    ds_read_b64_tr_b16 v[32:33], v103 offset:8192
    s_add_u32 s63, s75, 32768
    buffer_load_dwordx4 v[200:203], v100, s[16:19], s63 offen offset:0 sc1
    v_mfma_f32_16x16x32_bf16 v[64:67], v[44:47], v[160:163], v[64:67]
    ds_read_b64_tr_b16 v[34:35], v103 offset:9216
    v_mfma_f32_16x16x32_bf16 v[68:71], v[40:43], v[156:159], v[68:71]
    s_add_u32 m0, s42, 73728
    ds_read_b64_tr_b16 v[36:37], v103 offset:10240
    buffer_load_dwordx4 v6, s[12:15], s56 offen lds
    v_mfma_f32_16x16x32_bf16 v[68:71], v[44:47], v[164:167], v[68:71]
    s_add_u32 s56, s70, 221184
    ds_read_b64_tr_b16 v[38:39], v103 offset:11264
    s_setprio 0
    s_waitcnt lgkmcnt(4)
    v_mfma_f32_16x16x32_bf16 v[72:75], v[24:27], v[152:155], v[72:75]
    s_add_u32 s57, s71, 221184
    ds_read_b64_tr_b16 v[40:41], v5 offset:32768
    v_mfma_f32_16x16x32_bf16 v[72:75], v[28:31], v[160:163], v[72:75]
    s_cmp_ge_u32 s37, 2
    s_cselect_b32 s56, s57, s56
    ds_read_b64_tr_b16 v[42:43], v5 offset:34816
    s_add_u32 s63, s75, 32768
    buffer_load_dwordx4 v[204:207], v100, s[16:19], s63 offen offset:1024 sc1
    v_mfma_f32_16x16x32_bf16 v[76:79], v[24:27], v[156:159], v[76:79]
    s_add_u32 s56, s56, s81
    ds_read_b64_tr_b16 v[44:45], v5 offset:40960
    v_mfma_f32_16x16x32_bf16 v[76:79], v[28:31], v[164:167], v[76:79]
    ds_read_b64_tr_b16 v[46:47], v5 offset:43008
    s_waitcnt lgkmcnt(4)
    v_mfma_f32_16x16x32_bf16 v[8:11], v[32:35], v[152:155], v[8:11]
    ds_read_b64_tr_b16 v[24:25], v101 offset:32768
    v_mfma_f32_16x16x32_bf16 v[8:11], v[36:39], v[160:163], v[8:11]
    ds_read_b64_tr_b16 v[26:27], v101 offset:34816
    v_mfma_f32_16x16x32_bf16 v[96:99], v[32:35], v[156:159], v[96:99]
    s_add_u32 m0, s42, 155648
    ds_read_b64_tr_b16 v[28:29], v101 offset:40960
    buffer_load_dwordx4 v7, s[12:15], s56 offen lds
    v_mfma_f32_16x16x32_bf16 v[96:99], v[36:39], v[164:167], v[96:99]
    ds_read_b64_tr_b16 v[30:31], v101 offset:43008
    s_waitcnt vmcnt(13)
    s_barrier
    s_setprio 3
    s_waitcnt lgkmcnt(4)
    v_mfma_f32_16x16x32_bf16 v[48:51], v[40:43], v[168:171], v[48:51]
    s_cmp_eq_u32 s36, 0
    s_cbranch_scc0 LA_dw35
    v_and_b32 v224, 3, v0
    v_lshlrev_b32 v224, 3, v224
    buffer_load_dwordx2 v[224:225], v224, s[16:19], s2 offen sc1
LA_dw35:
    s_add_u32 s56, s70, 221184
    ds_read_b64_tr_b16 v[32:33], v5 offset:33280
    v_mfma_f32_16x16x32_bf16 v[48:51], v[44:47], v[176:179], v[48:51]
    s_add_u32 s57, s71, 221184
    ds_read_b64_tr_b16 v[34:35], v5 offset:35328
    v_mfma_f32_16x16x32_bf16 v[52:55], v[40:43], v[172:175], v[52:55]
    s_cmp_ge_u32 s37, 2
    s_cselect_b32 s56, s57, s56
    ds_read_b64_tr_b16 v[36:37], v5 offset:41472
    v_mfma_f32_16x16x32_bf16 v[52:55], v[44:47], v[180:183], v[52:55]
    s_add_u32 s56, s56, s82
    ds_read_b64_tr_b16 v[38:39], v5 offset:43520
    s_waitcnt lgkmcnt(4)
    v_mfma_f32_16x16x32_bf16 v[56:59], v[24:27], v[168:171], v[56:59]
    ds_read_b64_tr_b16 v[40:41], v101 offset:33280
    v_mfma_f32_16x16x32_bf16 v[56:59], v[28:31], v[176:179], v[56:59]
    s_add_u32 m0, s42, 81920
    ds_read_b64_tr_b16 v[42:43], v101 offset:35328
    buffer_load_dwordx4 v7, s[12:15], s56 offen lds
    v_mfma_f32_16x16x32_bf16 v[60:63], v[24:27], v[172:175], v[60:63]
    s_add_u32 s56, s70, s80
    ds_read_b64_tr_b16 v[44:45], v101 offset:41472
    v_mfma_f32_16x16x32_bf16 v[60:63], v[28:31], v[180:183], v[60:63]
    s_add_u32 s56, s56, 294912
    ds_read_b64_tr_b16 v[46:47], v101 offset:43520
    s_setprio 2
    s_waitcnt lgkmcnt(4)
    v_mfma_f32_16x16x32_bf16 v[104:107], v[32:35], v[168:171], v[104:107]
    ds_read_b64_tr_b16 v[24:25], v102 offset:32768
    v_mfma_f32_16x16x32_bf16 v[104:107], v[36:39], v[176:179], v[104:107]
    ds_read_b64_tr_b16 v[26:27], v102 offset:33792
    v_mfma_f32_16x16x32_bf16 v[108:111], v[32:35], v[172:175], v[108:111]
    ds_read_b64_tr_b16 v[28:29], v102 offset:34816
    v_mfma_f32_16x16x32_bf16 v[108:111], v[36:39], v[180:183], v[108:111]
    ds_read_b64_tr_b16 v[30:31], v102 offset:35840
    s_waitcnt lgkmcnt(4)
    v_mfma_f32_16x16x32_bf16 v[248:251], v[40:43], v[168:171], v[248:251]
    s_add_u32 m0, s42, 90112
    ds_read_b64_tr_b16 v[32:33], v103 offset:32768
    buffer_load_dwordx4 v6, s[12:15], s56 offen lds
    v_mfma_f32_16x16x32_bf16 v[248:251], v[44:47], v[176:179], v[248:251]
    s_add_u32 s56, s71, s80
    ds_read_b64_tr_b16 v[34:35], v103 offset:33792
    v_mfma_f32_16x16x32_bf16 v[252:255], v[40:43], v[172:175], v[252:255]
    s_add_u32 s56, s56, 294912
    ds_read_b64_tr_b16 v[36:37], v103 offset:34816
    v_mfma_f32_16x16x32_bf16 v[252:255], v[44:47], v[180:183], v[252:255]
    ds_read_b64_tr_b16 v[38:39], v103 offset:35840
    s_setprio 1
    s_waitcnt lgkmcnt(4)
    v_mfma_f32_16x16x32_bf16 v[88:91], v[24:27], v[168:171], v[88:91]
    ds_read_b64_tr_b16 v[40:41], v102 offset:40960
    v_mfma_f32_16x16x32_bf16 v[88:91], v[28:31], v[176:179], v[88:91]
    ds_read_b64_tr_b16 v[42:43], v102 offset:41984
    v_mfma_f32_16x16x32_bf16 v[92:95], v[24:27], v[172:175], v[92:95]
    ds_read_b64_tr_b16 v[44:45], v102 offset:43008
    v_mfma_f32_16x16x32_bf16 v[92:95], v[28:31], v[180:183], v[92:95]
    s_add_u32 m0, s42, 98304
    ds_read_b64_tr_b16 v[46:47], v102 offset:44032
    buffer_load_dwordx4 v6, s[12:15], s56 offen lds
    s_waitcnt lgkmcnt(4)
    v_mfma_f32_16x16x32_bf16 v[64:67], v[32:35], v[168:171], v[64:67]
    s_add_u32 s56, s70, 294912
    ds_read_b64_tr_b16 v[24:25], v103 offset:40960
    v_mfma_f32_16x16x32_bf16 v[64:67], v[36:39], v[176:179], v[64:67]
    s_add_u32 s57, s71, 294912
    ds_read_b64_tr_b16 v[26:27], v103 offset:41984
    v_mfma_f32_16x16x32_bf16 v[68:71], v[32:35], v[172:175], v[68:71]
    s_cmp_ge_u32 s37, 2
    s_cselect_b32 s56, s57, s56
    ds_read_b64_tr_b16 v[28:29], v103 offset:43008
    v_mfma_f32_16x16x32_bf16 v[68:71], v[36:39], v[180:183], v[68:71]
    s_add_u32 s56, s56, s81
    ds_read_b64_tr_b16 v[30:31], v103 offset:44032
    s_setprio 0
    s_waitcnt lgkmcnt(4)
    v_mfma_f32_16x16x32_bf16 v[72:75], v[40:43], v[168:171], v[72:75]
    v_add_u32 v5, 0x10000, v5
    ds_read_b64_tr_b16 v[32:33], v5 offset:0
    v_mfma_f32_16x16x32_bf16 v[72:75], v[44:47], v[176:179], v[72:75]
    ds_read_b64_tr_b16 v[34:35], v5 offset:2048
    v_mfma_f32_16x16x32_bf16 v[76:79], v[40:43], v[172:175], v[76:79]
    s_add_u32 m0, s42, 106496
    v_add_u32 v5, 0xfffde000, v5
    ds_read_b64_tr_b16 v[36:37], v5 offset:0
    buffer_load_dwordx4 v7, s[12:15], s56 offen lds
    v_mfma_f32_16x16x32_bf16 v[76:79], v[44:47], v[180:183], v[76:79]
    ds_read_b64_tr_b16 v[38:39], v5 offset:2048
    s_waitcnt lgkmcnt(4)
    v_mfma_f32_16x16x32_bf16 v[8:11], v[24:27], v[168:171], v[8:11]
    v_add_u32 v101, 0x10000, v101
    ds_read_b64_tr_b16 v[40:41], v101 offset:0
    v_mfma_f32_16x16x32_bf16 v[8:11], v[28:31], v[176:179], v[8:11]
    ds_read_b64_tr_b16 v[42:43], v101 offset:2048
    v_mfma_f32_16x16x32_bf16 v[96:99], v[24:27], v[172:175], v[96:99]
    v_add_u32 v101, 0xfffde000, v101
    ds_read_b64_tr_b16 v[44:45], v101 offset:0
    v_mfma_f32_16x16x32_bf16 v[96:99], v[28:31], v[180:183], v[96:99]
    ds_read_b64_tr_b16 v[46:47], v101 offset:2048
    s_cmp_eq_u32 s36, 0
    s_cbranch_scc0 LA_dw38
    s_waitcnt vmcnt(4)
    s_add_u32 s62, s96, 4
    v_subrev_u32 v224, s62, v224
    v_cmp_ne_u32 s[58:59], s97, v225
    v_cmp_lt_u32 s[60:61], 11, v224
    s_lshl_b32 s62, 1, s41
    s_andn2_b32 s62, 15, s62
    s_nop 0
    s_or_b32 s60, s60, s58
    s_and_b32 s60, s60, s62
    s_cbranch_scc0 LA_ok36
    s_mov_b32 s78, 200000
LA_sp37:
    s_sleep 1
    v_and_b32 v224, 3, v0
    v_lshlrev_b32 v224, 3, v224
    buffer_load_dwordx2 v[224:225], v224, s[16:19], s2 offen sc1
    s_waitcnt vmcnt(0)
    s_add_u32 s62, s96, 4
    v_subrev_u32 v224, s62, v224
    v_cmp_ne_u32 s[58:59], s97, v225
    v_cmp_lt_u32 s[60:61], 11, v224
    s_lshl_b32 s62, 1, s41
    s_andn2_b32 s62, 15, s62
    s_nop 0
    s_or_b32 s60, s60, s58
    s_and_b32 s60, s60, s62
    s_cbranch_scc0 LA_ok36
    s_sub_u32 s78, s78, 1
    s_cmp_lg_u32 s78, 0
    s_cbranch_scc1 LA_sp37
LA_ok36:
    s_nop 1
LA_dw38:
    s_waitcnt vmcnt(12)
    s_barrier
    s_setprio 3
    s_waitcnt lgkmcnt(4)
    v_mfma_f32_16x16x32_bf16 v[48:51], v[32:35], v[184:187], v[48:51]
    s_add_u32 s56, s70, 294912
    v_add_u32 v5, 0x22000, v5
    ds_read_b64_tr_b16 v[24:25], v5 offset:512
    s_add_u32 s63, s73, 49152
    buffer_load_dwordx4 v[208:211], v100, s[16:19], s63 offen offset:0 sc1
    s_waitcnt vmcnt(11)
    v_mfma_f32_16x16x32_bf16 v[48:51], v[36:39], v[192:195], v[48:51]
    s_add_u32 s57, s71, 294912
    ds_read_b64_tr_b16 v[26:27], v5 offset:2560
    v_mfma_f32_16x16x32_bf16 v[52:55], v[32:35], v[188:191], v[52:55]
    s_cmp_ge_u32 s37, 2
    s_cselect_b32 s56, s57, s56
    v_add_u32 v5, 0xfffde000, v5
    ds_read_b64_tr_b16 v[28:29], v5 offset:512
    s_waitcnt vmcnt(9)
    v_mfma_f32_16x16x32_bf16 v[52:55], v[36:39], v[196:199], v[52:55]
    s_add_u32 s56, s56, s82
    ds_read_b64_tr_b16 v[30:31], v5 offset:2560
    s_waitcnt lgkmcnt(4)
    v_mfma_f32_16x16x32_bf16 v[56:59], v[40:43], v[184:187], v[56:59]
    s_add_u32 m0, s42, 114688
    v_add_u32 v101, 0x22000, v101
    ds_read_b64_tr_b16 v[32:33], v101 offset:512
    buffer_load_dwordx4 v7, s[12:15], s56 offen lds
    v_mfma_f32_16x16x32_bf16 v[56:59], v[44:47], v[192:195], v[56:59]
    s_add_u32 s56, s68, 147456
    ds_read_b64_tr_b16 v[34:35], v101 offset:2560
    s_add_u32 s63, s73, 49152
    buffer_load_dwordx4 v[212:215], v100, s[16:19], s63 offen offset:1024 sc1
    v_mfma_f32_16x16x32_bf16 v[60:63], v[40:43], v[188:191], v[60:63]
    s_add_u32 s57, s68, 0
    v_add_u32 v101, 0xfffde000, v101
    ds_read_b64_tr_b16 v[36:37], v101 offset:512
    v_mfma_f32_16x16x32_bf16 v[60:63], v[44:47], v[196:199], v[60:63]
    s_cmp_ge_u32 s37, 2
    s_cselect_b32 s56, s57, s56
    ds_read_b64_tr_b16 v[38:39], v101 offset:2560
    s_setprio 2
    s_waitcnt lgkmcnt(4)
    v_mfma_f32_16x16x32_bf16 v[104:107], v[24:27], v[184:187], v[104:107]
    s_add_u32 s56, s56, s83
    v_add_u32 v102, 0xfffec000, v102
    ds_read_b64_tr_b16 v[40:41], v102 offset:0
    v_mfma_f32_16x16x32_bf16 v[104:107], v[28:31], v[192:195], v[104:107]
    ds_read_b64_tr_b16 v[42:43], v102 offset:1024
    v_mfma_f32_16x16x32_bf16 v[108:111], v[24:27], v[188:191], v[108:111]
    ds_read_b64_tr_b16 v[44:45], v102 offset:2048
    s_add_u32 s63, s74, 49152
    buffer_load_dwordx4 v[216:219], v100, s[16:19], s63 offen offset:0 sc1
    v_mfma_f32_16x16x32_bf16 v[108:111], v[28:31], v[196:199], v[108:111]
    ds_read_b64_tr_b16 v[46:47], v102 offset:3072
    s_waitcnt lgkmcnt(4)
    v_mfma_f32_16x16x32_bf16 v[248:251], v[32:35], v[184:187], v[248:251]
    v_add_u32 v103, 0xfffec000, v103
    ds_read_b64_tr_b16 v[24:25], v103 offset:0
    v_mfma_f32_16x16x32_bf16 v[248:251], v[36:39], v[192:195], v[248:251]
    s_add_u32 m0, s42, 122880
    ds_read_b64_tr_b16 v[26:27], v103 offset:1024
    buffer_load_dwordx4 v7, s[12:15], s56 offen lds
    v_mfma_f32_16x16x32_bf16 v[252:255], v[32:35], v[188:191], v[252:255]
    s_add_u32 s56, s69, 0
    ds_read_b64_tr_b16 v[28:29], v103 offset:2048
    v_mfma_f32_16x16x32_bf16 v[252:255], v[36:39], v[196:199], v[252:255]
    s_add_u32 s57, s70, 0
    ds_read_b64_tr_b16 v[30:31], v103 offset:3072
    s_add_u32 s63, s74, 49152
    buffer_load_dwordx4 v[220:223], v100, s[16:19], s63 offen offset:1024 sc1
    s_setprio 1
    s_waitcnt lgkmcnt(4)
    v_mfma_f32_16x16x32_bf16 v[88:91], v[40:43], v[184:187], v[88:91]
    s_cmp_ge_u32 s37, 2
    s_cselect_b32 s56, s57, s56
    ds_read_b64_tr_b16 v[32:33], v102 offset:8192
    v_mfma_f32_16x16x32_bf16 v[88:91], v[44:47], v[192:195], v[88:91]
    s_add_u32 s56, s56, s83
    ds_read_b64_tr_b16 v[34:35], v102 offset:9216
    v_mfma_f32_16x16x32_bf16 v[92:95], v[40:43], v[188:191], v[92:95]
    ds_read_b64_tr_b16 v[36:37], v102 offset:10240
    v_mfma_f32_16x16x32_bf16 v[92:95], v[44:47], v[196:199], v[92:95]
    ds_read_b64_tr_b16 v[38:39], v102 offset:11264
    s_waitcnt lgkmcnt(4)
    v_mfma_f32_16x16x32_bf16 v[64:67], v[24:27], v[184:187], v[64:67]
    ds_read_b64_tr_b16 v[40:41], v103 offset:8192
    s_add_u32 s63, s75, 49152
    buffer_load_dwordx4 v[224:227], v100, s[16:19], s63 offen offset:0 sc1
    v_mfma_f32_16x16x32_bf16 v[64:67], v[28:31], v[192:195], v[64:67]
    ds_read_b64_tr_b16 v[42:43], v103 offset:9216
    v_mfma_f32_16x16x32_bf16 v[68:71], v[24:27], v[188:191], v[68:71]
    s_add_u32 m0, s42, 131072
    ds_read_b64_tr_b16 v[44:45], v103 offset:10240
    buffer_load_dwordx4 v7, s[12:15], s56 offen lds
    v_mfma_f32_16x16x32_bf16 v[68:71], v[28:31], v[196:199], v[68:71]
    s_add_u32 s56, s71, 0
    ds_read_b64_tr_b16 v[46:47], v103 offset:11264
    s_setprio 0
    s_waitcnt lgkmcnt(4)
    v_mfma_f32_16x16x32_bf16 v[72:75], v[32:35], v[184:187], v[72:75]
    s_add_u32 s57, s68, 73728
    ds_read_b64_tr_b16 v[24:25], v5 offset:24576
    v_mfma_f32_16x16x32_bf16 v[72:75], v[36:39], v[192:195], v[72:75]
    s_cmp_ge_u32 s37, 2
    s_cselect_b32 s56, s57, s56
    ds_read_b64_tr_b16 v[26:27], v5 offset:26624
    s_add_u32 s63, s75, 49152
    buffer_load_dwordx4 v[228:231], v100, s[16:19], s63 offen offset:1024 sc1
    v_mfma_f32_16x16x32_bf16 v[76:79], v[32:35], v[188:191], v[76:79]
    s_add_u32 s56, s56, s83
    ds_read_b64_tr_b16 v[28:29], v5 offset:32768
    v_mfma_f32_16x16x32_bf16 v[76:79], v[36:39], v[196:199], v[76:79]
    ds_read_b64_tr_b16 v[30:31], v5 offset:34816
    s_waitcnt lgkmcnt(4)
    v_mfma_f32_16x16x32_bf16 v[8:11], v[40:43], v[184:187], v[8:11]
    ds_read_b64_tr_b16 v[32:33], v101 offset:24576
    v_mfma_f32_16x16x32_bf16 v[8:11], v[44:47], v[192:195], v[8:11]
    ds_read_b64_tr_b16 v[34:35], v101 offset:26624
    v_mfma_f32_16x16x32_bf16 v[96:99], v[40:43], v[188:191], v[96:99]
    s_add_u32 m0, s42, 139264
    ds_read_b64_tr_b16 v[36:37], v101 offset:32768
    buffer_load_dwordx4 v7, s[12:15], s56 offen lds
    v_mfma_f32_16x16x32_bf16 v[96:99], v[44:47], v[196:199], v[96:99]
    ds_read_b64_tr_b16 v[38:39], v101 offset:34816
    s_waitcnt vmcnt(13)
    s_barrier
    s_setprio 3
    s_waitcnt lgkmcnt(4)
    v_mfma_f32_16x16x32_bf16 v[48:51], v[24:27], v[200:203], v[48:51]
    s_cmp_eq_u32 s36, 0
    s_cbranch_scc0 LA_dw39
    v_and_b32 v22, 3, v0
    v_lshlrev_b32 v22, 3, v22
    buffer_load_dwordx2 v[22:23], v22, s[16:19], s2 offen sc1
LA_dw39:
    s_add_u32 s56, s69, 73728
    ds_read_b64_tr_b16 v[40:41], v5 offset:25088
    s_waitcnt vmcnt(9)
    v_mfma_f32_16x16x32_bf16 v[48:51], v[28:31], v[208:211], v[48:51]
    s_add_u32 s57, s70, 73728
    ds_read_b64_tr_b16 v[42:43], v5 offset:27136
    v_mfma_f32_16x16x32_bf16 v[52:55], v[24:27], v[204:207], v[52:55]
    s_cmp_ge_u32 s37, 2
    s_cselect_b32 s56, s57, s56
    ds_read_b64_tr_b16 v[44:45], v5 offset:33280
    s_waitcnt vmcnt(7)
    v_mfma_f32_16x16x32_bf16 v[52:55], v[28:31], v[212:215], v[52:55]
    s_add_u32 s56, s56, s83
    ds_read_b64_tr_b16 v[46:47], v5 offset:35328
    s_waitcnt lgkmcnt(4)
    v_mfma_f32_16x16x32_bf16 v[56:59], v[32:35], v[200:203], v[56:59]
    ds_read_b64_tr_b16 v[24:25], v101 offset:25088
    v_mfma_f32_16x16x32_bf16 v[56:59], v[36:39], v[208:211], v[56:59]
    s_add_u32 m0, s42, 147456
    ds_read_b64_tr_b16 v[26:27], v101 offset:27136
    buffer_load_dwordx4 v7, s[12:15], s56 offen lds
    v_mfma_f32_16x16x32_bf16 v[60:63], v[32:35], v[204:207], v[60:63]
    s_add_u32 s56, s71, 73728
    ds_read_b64_tr_b16 v[28:29], v101 offset:33280
    v_mfma_f32_16x16x32_bf16 v[60:63], v[36:39], v[212:215], v[60:63]
    s_add_u32 s57, s68, 221184
    ds_read_b64_tr_b16 v[30:31], v101 offset:35328
    s_setprio 2
    s_waitcnt lgkmcnt(4)
    v_mfma_f32_16x16x32_bf16 v[104:107], v[40:43], v[200:203], v[104:107]
    s_cmp_ge_u32 s37, 2
    s_cselect_b32 s56, s57, s56
    ds_read_b64_tr_b16 v[32:33], v102 offset:32768
    v_mfma_f32_16x16x32_bf16 v[104:107], v[44:47], v[208:211], v[104:107]
    s_add_u32 s56, s56, s83
    ds_read_b64_tr_b16 v[34:35], v102 offset:33792
    v_mfma_f32_16x16x32_bf16 v[108:111], v[40:43], v[204:207], v[108:111]
    ds_read_b64_tr_b16 v[36:37], v102 offset:34816
    v_mfma_f32_16x16x32_bf16 v[108:111], v[44:47], v[212:215], v[108:111]
    ds_read_b64_tr_b16 v[38:39], v102 offset:35840
    s_waitcnt lgkmcnt(4)
    v_mfma_f32_16x16x32_bf16 v[248:251], v[24:27], v[200:203], v[248:251]
    s_add_u32 m0, s42, 8192
    ds_read_b64_tr_b16 v[40:41], v103 offset:32768
    buffer_load_dwordx4 v7, s[12:15], s56 offen lds
    v_mfma_f32_16x16x32_bf16 v[248:251], v[28:31], v[208:211], v[248:251]
    s_add_u32 s56, s69, 147456
    ds_read_b64_tr_b16 v[42:43], v103 offset:33792
    v_mfma_f32_16x16x32_bf16 v[252:255], v[24:27], v[204:207], v[252:255]
    s_add_u32 s57, s70, 147456
    ds_read_b64_tr_b16 v[44:45], v103 offset:34816
    v_mfma_f32_16x16x32_bf16 v[252:255], v[28:31], v[212:215], v[252:255]
    s_cmp_ge_u32 s37, 2
    s_cselect_b32 s56, s57, s56
    ds_read_b64_tr_b16 v[46:47], v103 offset:35840
    s_setprio 1
    s_waitcnt lgkmcnt(4)
    v_mfma_f32_16x16x32_bf16 v[88:91], v[32:35], v[200:203], v[88:91]
    s_add_u32 s56, s56, s83
    ds_read_b64_tr_b16 v[24:25], v102 offset:40960
    v_mfma_f32_16x16x32_bf16 v[88:91], v[36:39], v[208:211], v[88:91]
    ds_read_b64_tr_b16 v[26:27], v102 offset:41984
    v_mfma_f32_16x16x32_bf16 v[92:95], v[32:35], v[204:207], v[92:95]
    ds_read_b64_tr_b16 v[28:29], v102 offset:43008
    v_mfma_f32_16x16x32_bf16 v[92:95], v[36:39], v[212:215], v[92:95]
    s_add_u32 m0, s42, 16384
    ds_read_b64_tr_b16 v[30:31], v102 offset:44032
    buffer_load_dwordx4 v7, s[12:15], s56 offen lds
    s_waitcnt lgkmcnt(4)
    v_mfma_f32_16x16x32_bf16 v[64:67], v[40:43], v[200:203], v[64:67]
    ds_read_b64_tr_b16 v[32:33], v103 offset:40960
    v_mfma_f32_16x16x32_bf16 v[64:67], v[44:47], v[208:211], v[64:67]
    ds_read_b64_tr_b16 v[34:35], v103 offset:41984
    v_mfma_f32_16x16x32_bf16 v[68:71], v[40:43], v[204:207], v[68:71]
    ds_read_b64_tr_b16 v[36:37], v103 offset:43008
    v_mfma_f32_16x16x32_bf16 v[68:71], v[44:47], v[212:215], v[68:71]
    ds_read_b64_tr_b16 v[38:39], v103 offset:44032
    s_setprio 0
    s_waitcnt lgkmcnt(4)
    v_mfma_f32_16x16x32_bf16 v[72:75], v[24:27], v[200:203], v[72:75]
    ds_read_b64_tr_b16 v[40:41], v5 offset:57344
    v_mfma_f32_16x16x32_bf16 v[72:75], v[28:31], v[208:211], v[72:75]
    ds_read_b64_tr_b16 v[42:43], v5 offset:59392
    v_mfma_f32_16x16x32_bf16 v[76:79], v[24:27], v[204:207], v[76:79]
    v_add_u32 v5, 0x10000, v5
    ds_read_b64_tr_b16 v[44:45], v5 offset:0
    v_mfma_f32_16x16x32_bf16 v[76:79], v[28:31], v[212:215], v[76:79]
    ds_read_b64_tr_b16 v[46:47], v5 offset:2048
    s_waitcnt lgkmcnt(4)
    v_mfma_f32_16x16x32_bf16 v[8:11], v[32:35], v[200:203], v[8:11]
    ds_read_b64_tr_b16 v[24:25], v101 offset:57344
    v_mfma_f32_16x16x32_bf16 v[8:11], v[36:39], v[208:211], v[8:11]
    ds_read_b64_tr_b16 v[26:27], v101 offset:59392
    v_mfma_f32_16x16x32_bf16 v[96:99], v[32:35], v[204:207], v[96:99]
    v_add_u32 v101, 0x10000, v101
    ds_read_b64_tr_b16 v[28:29], v101 offset:0
    v_mfma_f32_16x16x32_bf16 v[96:99], v[36:39], v[212:215], v[96:99]
    ds_read_b64_tr_b16 v[30:31], v101 offset:2048
    s_cmp_eq_u32 s36, 0
    s_cbranch_scc0 LA_dw42
    s_waitcnt vmcnt(3)
    s_add_u32 s62, s96, 5
    v_subrev_u32 v22, s62, v22
    v_cmp_ne_u32 s[58:59], s97, v23
    v_cmp_lt_u32 s[60:61], 10, v22
    s_lshl_b32 s62, 1, s41
    s_andn2_b32 s62, 15, s62
    s_nop 0
    s_or_b32 s60, s60, s58
    s_and_b32 s60, s60, s62
    s_cbranch_scc0 LA_ok40
    s_mov_b32 s78, 200000
LA_sp41:
    s_sleep 1
    v_and_b32 v22, 3, v0
    v_lshlrev_b32 v22, 3, v22
    buffer_load_dwordx2 v[22:23], v22, s[16:19], s2 offen sc1
    s_waitcnt vmcnt(0)
    s_add_u32 s62, s96, 5
    v_subrev_u32 v22, s62, v22
    v_cmp_ne_u32 s[58:59], s97, v23
    v_cmp_lt_u32 s[60:61], 10, v22
    s_lshl_b32 s62, 1, s41
    s_andn2_b32 s62, 15, s62
    s_nop 0
    s_or_b32 s60, s60, s58
    s_and_b32 s60, s60, s62
    s_cbranch_scc0 LA_ok40
    s_sub_u32 s78, s78, 1
    s_cmp_lg_u32 s78, 0
    s_cbranch_scc1 LA_sp41
LA_ok40:
    s_nop 1
LA_dw42:
    s_barrier
    s_setprio 3
    s_waitcnt lgkmcnt(4)
    s_waitcnt vmcnt(9)
    v_mfma_f32_16x16x32_bf16 v[48:51], v[40:43], v[216:219], v[48:51]
    s_add_u32 s56, s71, 147456
    v_add_u32 v5, 0xffffe000, v5
    ds_read_b64_tr_b16 v[32:33], v5 offset:512
    s_add_u32 s63, s74, 65536
    buffer_load_dwordx4 v[232:235], v100, s[16:19], s63 offen offset:0 sc1
    s_waitcnt vmcnt(7)
    v_mfma_f32_16x16x32_bf16 v[48:51], v[44:47], v[224:227], v[48:51]
    s_add_u32 s57, s69, 221184
    ds_read_b64_tr_b16 v[34:35], v5 offset:2560
    v_mfma_f32_16x16x32_bf16 v[52:55], v[40:43], v[220:223], v[52:55]
    s_cmp_ge_u32 s37, 2
    s_cselect_b32 s56, s57, s56
    ds_read_b64_tr_b16 v[36:37], v5 offset:8704
    s_waitcnt vmcnt(5)
    v_mfma_f32_16x16x32_bf16 v[52:55], v[44:47], v[228:231], v[52:55]
    s_add_u32 s56, s56, s83
    ds_read_b64_tr_b16 v[38:39], v5 offset:10752
    s_waitcnt lgkmcnt(4)
    v_mfma_f32_16x16x32_bf16 v[56:59], v[24:27], v[216:219], v[56:59]
    s_add_u32 m0, s42, 57344
    v_add_u32 v101, 0xffffe000, v101
    ds_read_b64_tr_b16 v[40:41], v101 offset:512
    buffer_load_dwordx4 v7, s[12:15], s56 offen lds
    v_mfma_f32_16x16x32_bf16 v[56:59], v[28:31], v[224:227], v[56:59]
    ds_read_b64_tr_b16 v[42:43], v101 offset:2560
    s_add_u32 s63, s74, 65536
    buffer_load_dwordx4 v[236:239], v100, s[16:19], s63 offen offset:1024 sc1
    v_mfma_f32_16x16x32_bf16 v[60:63], v[24:27], v[220:223], v[60:63]
    ds_read_b64_tr_b16 v[44:45], v101 offset:8704
    v_mfma_f32_16x16x32_bf16 v[60:63], v[28:31], v[228:231], v[60:63]
    ds_read_b64_tr_b16 v[46:47], v101 offset:10752
    s_setprio 2
    s_waitcnt lgkmcnt(4)
    v_mfma_f32_16x16x32_bf16 v[104:107], v[32:35], v[216:219], v[104:107]
    v_add_u32 v102, 0x22000, v102
    ds_read_b64_tr_b16 v[24:25], v102 offset:0
    v_mfma_f32_16x16x32_bf16 v[104:107], v[36:39], v[224:227], v[104:107]
    ds_read_b64_tr_b16 v[26:27], v102 offset:1024
    v_mfma_f32_16x16x32_bf16 v[108:111], v[32:35], v[220:223], v[108:111]
    ds_read_b64_tr_b16 v[28:29], v102 offset:2048
    s_add_u32 s63, s75, 65536
    buffer_load_dwordx4 v[240:243], v100, s[16:19], s63 offen offset:0 sc1
    v_mfma_f32_16x16x32_bf16 v[108:111], v[36:39], v[228:231], v[108:111]
    ds_read_b64_tr_b16 v[30:31], v102 offset:3072
    s_waitcnt lgkmcnt(4)
    v_mfma_f32_16x16x32_bf16 v[248:251], v[40:43], v[216:219], v[248:251]
    v_add_u32 v103, 0x22000, v103
    ds_read_b64_tr_b16 v[32:33], v103 offset:0
    v_mfma_f32_16x16x32_bf16 v[248:251], v[44:47], v[224:227], v[248:251]
    ds_read_b64_tr_b16 v[34:35], v103 offset:1024
    v_mfma_f32_16x16x32_bf16 v[252:255], v[40:43], v[220:223], v[252:255]
    ds_read_b64_tr_b16 v[36:37], v103 offset:2048
    v_mfma_f32_16x16x32_bf16 v[252:255], v[44:47], v[228:231], v[252:255]
    ds_read_b64_tr_b16 v[38:39], v103 offset:3072
    s_add_u32 s63, s75, 65536
    buffer_load_dwordx4 v[244:247], v100, s[16:19], s63 offen offset:1024 sc1
    s_setprio 1
    s_waitcnt lgkmcnt(4)
    v_mfma_f32_16x16x32_bf16 v[88:91], v[24:27], v[216:219], v[88:91]
    v_add_u32 v102, 0xfffee000, v102
    ds_read_b64_tr_b16 v[40:41], v102 offset:0
    v_mfma_f32_16x16x32_bf16 v[88:91], v[28:31], v[224:227], v[88:91]
    ds_read_b64_tr_b16 v[42:43], v102 offset:1024
    v_mfma_f32_16x16x32_bf16 v[92:95], v[24:27], v[220:223], v[92:95]
    ds_read_b64_tr_b16 v[44:45], v102 offset:2048
    v_mfma_f32_16x16x32_bf16 v[92:95], v[28:31], v[228:231], v[92:95]
    ds_read_b64_tr_b16 v[46:47], v102 offset:3072
    s_waitcnt lgkmcnt(4)
    v_mfma_f32_16x16x32_bf16 v[64:67], v[32:35], v[216:219], v[64:67]
    v_add_u32 v103, 0xfffee000, v103
    ds_read_b64_tr_b16 v[24:25], v103 offset:0
    v_mfma_f32_16x16x32_bf16 v[64:67], v[36:39], v[224:227], v[64:67]
    ds_read_b64_tr_b16 v[26:27], v103 offset:1024
    v_mfma_f32_16x16x32_bf16 v[68:71], v[32:35], v[220:223], v[68:71]
    ds_read_b64_tr_b16 v[28:29], v103 offset:2048
    v_mfma_f32_16x16x32_bf16 v[68:71], v[36:39], v[228:231], v[68:71]
    ds_read_b64_tr_b16 v[30:31], v103 offset:3072
    s_setprio 0
    s_waitcnt lgkmcnt(4)
    v_mfma_f32_16x16x32_bf16 v[72:75], v[40:43], v[216:219], v[72:75]
    ds_read_b64_tr_b16 v[32:33], v101 offset:24576
    v_mfma_f32_16x16x32_bf16 v[72:75], v[44:47], v[224:227], v[72:75]
    ds_read_b64_tr_b16 v[34:35], v101 offset:26624
    v_mfma_f32_16x16x32_bf16 v[76:79], v[40:43], v[220:223], v[76:79]
    ds_read_b64_tr_b16 v[36:37], v101 offset:32768
    v_mfma_f32_16x16x32_bf16 v[76:79], v[44:47], v[228:231], v[76:79]
    ds_read_b64_tr_b16 v[38:39], v101 offset:34816
    s_waitcnt lgkmcnt(4)
    v_mfma_f32_16x16x32_bf16 v[8:11], v[24:27], v[216:219], v[8:11]
    ds_read_b64_tr_b16 v[40:41], v101 offset:25088
    v_mfma_f32_16x16x32_bf16 v[8:11], v[28:31], v[224:227], v[8:11]
    ds_read_b64_tr_b16 v[42:43], v101 offset:27136
    v_mfma_f32_16x16x32_bf16 v[96:99], v[24:27], v[220:223], v[96:99]
    ds_read_b64_tr_b16 v[44:45], v101 offset:33280
    v_mfma_f32_16x16x32_bf16 v[96:99], v[28:31], v[228:231], v[96:99]
    ds_read_b64_tr_b16 v[46:47], v101 offset:35328
    s_waitcnt vmcnt(8)
    s_barrier
    s_setprio 3
    s_waitcnt lgkmcnt(4)
    s_waitcnt vmcnt(4)
    v_mfma_f32_16x16x32_bf16 v[56:59], v[32:35], v[232:235], v[56:59]
    s_add_u32 s56, s70, 221184
    ds_read_b64_tr_b16 v[24:25], v103 offset:24576
    s_waitcnt vmcnt(1)
    v_mfma_f32_16x16x32_bf16 v[56:59], v[36:39], v[240:243], v[56:59]
    s_add_u32 s57, s71, 221184
    ds_read_b64_tr_b16 v[26:27], v103 offset:25600
    v_mfma_f32_16x16x32_bf16 v[60:63], v[32:35], v[236:239], v[60:63]
    s_cmp_ge_u32 s37, 2
    s_cselect_b32 s56, s57, s56
    ds_read_b64_tr_b16 v[28:29], v103 offset:26624
    s_waitcnt vmcnt(0)
    v_mfma_f32_16x16x32_bf16 v[60:63], v[36:39], v[244:247], v[60:63]
    s_add_u32 s56, s56, s83
    ds_read_b64_tr_b16 v[30:31], v103 offset:27648
    v_add_u32 v1, s42, v100
    v_xor_b32 v4, 0x1000, v1
    s_waitcnt lgkmcnt(4)
    v_mfma_f32_16x16x32_bf16 v[248:251], v[40:43], v[232:235], v[248:251]
    s_add_u32 m0, s42, 65536
    ds_read_b64_tr_b16 v[32:33], v103 offset:32768
    buffer_load_dwordx4 v7, s[12:15], s56 offen lds
    v_mfma_f32_16x16x32_bf16 v[248:251], v[44:47], v[240:243], v[248:251]
    s_add_u32 s56, s70, 294912
    ds_read_b64_tr_b16 v[34:35], v103 offset:33792
    v_mfma_f32_16x16x32_bf16 v[252:255], v[40:43], v[236:239], v[252:255]
    s_add_u32 s57, s71, 294912
    ds_read_b64_tr_b16 v[36:37], v103 offset:34816
    v_mfma_f32_16x16x32_bf16 v[252:255], v[44:47], v[244:247], v[252:255]
    v_cvt_pk_bf16_f32 v56, v56, v57
    v_cvt_pk_bf16_f32 v57, v58, v59
    v_cvt_pk_bf16_f32 v58, v60, v61
    v_cvt_pk_bf16_f32 v59, v62, v63
    ds_write_b128 v1, v[56:59] offset:24576
    s_cmp_ge_u32 s37, 2
    s_cselect_b32 s56, s57, s56
    ds_read_b64_tr_b16 v[38:39], v103 offset:35840
    s_setprio 2
    s_waitcnt lgkmcnt(5)
    v_mfma_f32_16x16x32_bf16 v[64:67], v[24:27], v[232:235], v[64:67]
    s_add_u32 s56, s56, s83
    ds_read_b64_tr_b16 v[40:41], v5 offset:24576
    v_mfma_f32_16x16x32_bf16 v[64:67], v[28:31], v[240:243], v[64:67]
    ds_read_b64_tr_b16 v[42:43], v5 offset:26624
    v_mfma_f32_16x16x32_bf16 v[68:71], v[24:27], v[236:239], v[68:71]
    ds_read_b64_tr_b16 v[44:45], v5 offset:32768
    v_mfma_f32_16x16x32_bf16 v[68:71], v[28:31], v[244:247], v[68:71]
    v_cvt_pk_bf16_f32 v248, v248, v249
    v_cvt_pk_bf16_f32 v249, v250, v251
    v_cvt_pk_bf16_f32 v250, v252, v253
    v_cvt_pk_bf16_f32 v251, v254, v255
    ds_write_b128 v1, v[248:251] offset:32768
    s_add_u32 m0, s42, 73728
    ds_read_b64_tr_b16 v[46:47], v5 offset:34816
    buffer_load_dwordx4 v7, s[12:15], s56 offen lds
    s_waitcnt lgkmcnt(5)
    v_mfma_f32_16x16x32_bf16 v[8:11], v[32:35], v[232:235], v[8:11]
    ds_read_b64_tr_b16 v[24:25], v5 offset:25088
    v_mfma_f32_16x16x32_bf16 v[8:11], v[36:39], v[240:243], v[8:11]
    ds_read_b64_tr_b16 v[26:27], v5 offset:27136
    v_mfma_f32_16x16x32_bf16 v[96:99], v[32:35], v[236:239], v[96:99]
    ds_read_b64_tr_b16 v[28:29], v5 offset:33280
    v_mfma_f32_16x16x32_bf16 v[96:99], v[36:39], v[244:247], v[96:99]
    v_cvt_pk_bf16_f32 v64, v64, v65
    v_cvt_pk_bf16_f32 v65, v66, v67
    v_cvt_pk_bf16_f32 v66, v68, v69
    v_cvt_pk_bf16_f32 v67, v70, v71
    ds_write_b128 v1, v[64:67] offset:40960
    ds_read_b64_tr_b16 v[30:31], v5 offset:35328
    s_setprio 1
    s_waitcnt lgkmcnt(5)
    v_mfma_f32_16x16x32_bf16 v[48:51], v[40:43], v[232:235], v[48:51]
    ds_read_b64_tr_b16 v[32:33], v102 offset:24576
    v_mfma_f32_16x16x32_bf16 v[48:51], v[44:47], v[240:243], v[48:51]
    ds_read_b64_tr_b16 v[34:35], v102 offset:25600
    v_mfma_f32_16x16x32_bf16 v[52:55], v[40:43], v[236:239], v[52:55]
    ds_read_b64_tr_b16 v[36:37], v102 offset:26624
    v_mfma_f32_16x16x32_bf16 v[52:55], v[44:47], v[244:247], v[52:55]
    v_cvt_pk_bf16_f32 v8, v8, v9
    v_cvt_pk_bf16_f32 v9, v10, v11
    v_cvt_pk_bf16_f32 v10, v96, v97
    v_cvt_pk_bf16_f32 v11, v98, v99
    ds_write_b128 v1, v[8:11] offset:49152
    ds_read_b64_tr_b16 v[38:39], v102 offset:27648
    s_waitcnt lgkmcnt(5)
    v_mfma_f32_16x16x32_bf16 v[104:107], v[24:27], v[232:235], v[104:107]
    ds_read_b64_tr_b16 v[40:41], v102 offset:32768
    v_mfma_f32_16x16x32_bf16 v[104:107], v[28:31], v[240:243], v[104:107]
    ds_read_b64_tr_b16 v[42:43], v102 offset:33792
    v_mfma_f32_16x16x32_bf16 v[108:111], v[24:27], v[236:239], v[108:111]
    ds_read_b64_tr_b16 v[44:45], v102 offset:34816
    v_mfma_f32_16x16x32_bf16 v[108:111], v[28:31], v[244:247], v[108:111]
    ds_read_b64_tr_b16 v[46:47], v102 offset:35840
    s_setprio 0
    s_waitcnt lgkmcnt(4)
    v_mfma_f32_16x16x32_bf16 v[88:91], v[32:35], v[232:235], v[88:91]
    ds_read_b64_tr_b16 v[24:25], v102 offset:40960
    v_mfma_f32_16x16x32_bf16 v[88:91], v[36:39], v[240:243], v[88:91]
    ds_read_b64_tr_b16 v[26:27], v102 offset:41984
    v_mfma_f32_16x16x32_bf16 v[92:95], v[32:35], v[236:239], v[92:95]
    ds_read_b64_tr_b16 v[28:29], v102 offset:43008
    v_mfma_f32_16x16x32_bf16 v[92:95], v[36:39], v[244:247], v[92:95]
    ds_read_b64_tr_b16 v[30:31], v102 offset:44032
    s_waitcnt lgkmcnt(4)
    v_mfma_f32_16x16x32_bf16 v[72:75], v[40:43], v[232:235], v[72:75]
    ds_read_b64_tr_b16 v[32:33], v103 offset:40960
    v_mfma_f32_16x16x32_bf16 v[72:75], v[44:47], v[240:243], v[72:75]
    ds_read_b64_tr_b16 v[34:35], v103 offset:41984
    v_mfma_f32_16x16x32_bf16 v[76:79], v[40:43], v[236:239], v[76:79]
    ds_read_b64_tr_b16 v[36:37], v103 offset:43008
    v_mfma_f32_16x16x32_bf16 v[76:79], v[44:47], v[244:247], v[76:79]
    ds_read_b64_tr_b16 v[38:39], v103 offset:44032
    s_barrier
    s_setprio 3
    s_waitcnt lgkmcnt(4)
    v_mfma_f32_16x16x32_bf16 v[56:59], v[24:27], v[80:83], 0
    ds_read_b128 v[12:15], v4 offset:24576
    ds_read_b128 v[16:19], v4 offset:32768
    ds_read_b64_tr_b16 v[40:41], v102 offset:49152
    v_mfma_f32_16x16x32_bf16 v[56:59], v[28:31], v[112:115], v[56:59]
    ds_read_b128 v[64:67], v4 offset:40960
    ds_read_b128 v[68:71], v4 offset:49152
    v_lshlrev_b32 v23, 2, v0
    ds_read_b64_tr_b16 v[42:43], v102 offset:50176
    v_mfma_f32_16x16x32_bf16 v[60:63], v[24:27], v[84:87], 0
    ds_read_b64_tr_b16 v[44:45], v102 offset:51200
    v_mfma_f32_16x16x32_bf16 v[60:63], v[28:31], v[116:119], v[60:63]
    s_waitcnt lgkmcnt(6)
    v_lshlrev_b32 v20, 16, v12
    v_and_b32 v21, 0xffff0000, v12
    v_add_f32 v48, v48, v20
    v_add_f32 v49, v49, v21
    v_lshlrev_b32 v20, 16, v13
    v_and_b32 v21, 0xffff0000, v13
    ds_read_b64_tr_b16 v[46:47], v102 offset:52224
    v_mfma_f32_16x16x32_bf16 v[248:251], v[32:35], v[80:83], 0
    v_add_f32 v50, v50, v20
    v_add_f32 v51, v51, v21
    v_cvt_pk_bf16_f32 v48, v48, v49
    v_cvt_pk_bf16_f32 v49, v50, v51
    v_lshlrev_b32 v20, 16, v14
    ds_read_b64_tr_b16 v[24:25], v103 offset:49152
    v_mfma_f32_16x16x32_bf16 v[248:251], v[36:39], v[112:115], v[248:251]
    v_and_b32 v21, 0xffff0000, v14
    v_add_f32 v52, v52, v20
    v_add_f32 v53, v53, v21
    v_lshlrev_b32 v20, 16, v15
    v_and_b32 v21, 0xffff0000, v15
    ds_read_b64_tr_b16 v[26:27], v103 offset:50176
    v_mfma_f32_16x16x32_bf16 v[252:255], v[32:35], v[84:87], 0
    v_add_f32 v54, v54, v20
    v_add_f32 v55, v55, v21
    v_cvt_pk_bf16_f32 v50, v52, v53
    v_cvt_pk_bf16_f32 v51, v54, v55
    v_bitop3_b32 v52, v48, v49, v50 bitop3:0x96
    ds_read_b64_tr_b16 v[28:29], v103 offset:51200
    v_mfma_f32_16x16x32_bf16 v[252:255], v[36:39], v[116:119], v[252:255]
    v_bitop3_b32 v52, v52, v51, s96 bitop3:0x96
    s_and_b32 s62, s40, 2
    s_xor_b32 s62, s62, 2
    s_lshl4_add_u32 s62, s62, s40
    s_lshl_b32 s62, s62, 12
    s_add_u32 s62, s62, s76
    buffer_store_dwordx4 v[48:51], v100, s[16:19], s62 offen sc1
    buffer_store_dword v52, v23, s[16:19], s62 offen offset:1024 sc1
    s_waitcnt lgkmcnt(9)
    v_lshlrev_b32 v20, 16, v16
    v_and_b32 v21, 0xffff0000, v16
    v_add_f32 v104, v104, v20
    v_add_f32 v105, v105, v21
    ds_read_b64_tr_b16 v[30:31], v103 offset:52224
    s_setprio 2
    s_waitcnt lgkmcnt(4)
    v_mfma_f32_16x16x32_bf16 v[56:59], v[40:43], v[120:123], v[56:59]
    v_lshlrev_b32 v20, 16, v17
    v_and_b32 v21, 0xffff0000, v17
    v_add_f32 v106, v106, v20
    v_add_f32 v107, v107, v21
    v_cvt_pk_bf16_f32 v104, v104, v105
    ds_read_b64_tr_b16 v[32:33], v102 offset:57344
    v_mfma_f32_16x16x32_bf16 v[56:59], v[44:47], v[128:131], v[56:59]
    v_cvt_pk_bf16_f32 v105, v106, v107
    v_lshlrev_b32 v20, 16, v18
    v_and_b32 v21, 0xffff0000, v18
    v_add_f32 v108, v108, v20
    v_add_f32 v109, v109, v21
    ds_read_b64_tr_b16 v[34:35], v102 offset:58368
    v_mfma_f32_16x16x32_bf16 v[60:63], v[40:43], v[124:127], v[60:63]
    v_lshlrev_b32 v20, 16, v19
    v_and_b32 v21, 0xffff0000, v19
    v_add_f32 v110, v110, v20
    v_add_f32 v111, v111, v21
    v_cvt_pk_bf16_f32 v106, v108, v109
    ds_read_b64_tr_b16 v[36:37], v102 offset:59392
    v_mfma_f32_16x16x32_bf16 v[60:63], v[44:47], v[132:135], v[60:63]
    v_cvt_pk_bf16_f32 v107, v110, v111
    v_bitop3_b32 v108, v104, v105, v106 bitop3:0x96
    v_bitop3_b32 v108, v108, v107, s96 bitop3:0x96
    s_and_b32 s62, s40, 2
    s_xor_b32 s62, s62, 3
    s_lshl4_add_u32 s62, s62, s40
    s_lshl_b32 s62, s62, 12
    s_add_u32 s62, s62, s76
    buffer_store_dwordx4 v[104:107], v100, s[16:19], s62 offen sc1
    buffer_store_dword v108, v23, s[16:19], s62 offen offset:1024 sc1
    v_lshlrev_b32 v20, 16, v64
    v_and_b32 v21, 0xffff0000, v64
    ds_read_b64_tr_b16 v[38:39], v102 offset:60416
    s_setprio 1
    s_waitcnt lgkmcnt(4)
    v_mfma_f32_16x16x32_bf16 v[248:251], v[24:27], v[120:123], v[248:251]
    v_add_f32 v88, v88, v20
    v_add_f32 v89, v89, v21
    v_lshlrev_b32 v20, 16, v65
    v_and_b32 v21, 0xffff0000, v65
    v_add_f32 v90, v90, v20
    ds_read_b64_tr_b16 v[40:41], v103 offset:57344
    v_mfma_f32_16x16x32_bf16 v[248:251], v[28:31], v[128:131], v[248:251]
    v_add_f32 v91, v91, v21
    v_cvt_pk_bf16_f32 v88, v88, v89
    v_cvt_pk_bf16_f32 v89, v90, v91
    v_lshlrev_b32 v20, 16, v66
    v_and_b32 v21, 0xffff0000, v66
    ds_read_b64_tr_b16 v[42:43], v103 offset:58368
    v_mfma_f32_16x16x32_bf16 v[252:255], v[24:27], v[124:127], v[252:255]
    v_add_f32 v92, v92, v20
    v_add_f32 v93, v93, v21
    v_lshlrev_b32 v20, 16, v67
    v_and_b32 v21, 0xffff0000, v67
    v_add_f32 v94, v94, v20
    ds_read_b64_tr_b16 v[44:45], v103 offset:59392
    v_mfma_f32_16x16x32_bf16 v[252:255], v[28:31], v[132:135], v[252:255]
    v_add_f32 v95, v95, v21
    v_cvt_pk_bf16_f32 v90, v92, v93
    v_cvt_pk_bf16_f32 v91, v94, v95
    v_bitop3_b32 v92, v88, v89, v90 bitop3:0x96
    v_bitop3_b32 v92, v92, v91, s96 bitop3:0x96
    s_xor_b32 s62, s40, 1
    s_lshl4_add_u32 s62, s62, s40
    s_lshl_b32 s62, s62, 12
    s_add_u32 s62, s62, s76
    buffer_store_dwordx4 v[88:91], v100, s[16:19], s62 offen sc1
    buffer_store_dword v92, v23, s[16:19], s62 offen offset:1024 sc1
    ds_read_b64_tr_b16 v[46:47], v103 offset:60416
    s_waitcnt lgkmcnt(4)
    v_mfma_f32_16x16x32_bf16 v[56:59], v[32:35], v[136:139], v[56:59]
    v_lshlrev_b32 v20, 16, v68
    v_and_b32 v21, 0xffff0000, v68
    v_add_f32 v72, v72, v20
    v_add_f32 v73, v73, v21
    v_lshlrev_b32 v20, 16, v69
    v_add_u32 v102, 0x10000, v102
    ds_read_b64_tr_b16 v[24:25], v102 offset:0
    v_mfma_f32_16x16x32_bf16 v[56:59], v[36:39], v[144:147], v[56:59]
    v_and_b32 v21, 0xffff0000, v69
    v_add_f32 v74, v74, v20
    v_add_f32 v75, v75, v21
    v_cvt_pk_bf16_f32 v72, v72, v73
    ds_read_b64_tr_b16 v[26:27], v102 offset:1024
    v_mfma_f32_16x16x32_bf16 v[60:63], v[32:35], v[140:143], v[60:63]
    v_cvt_pk_bf16_f32 v73, v74, v75
    v_lshlrev_b32 v20, 16, v70
    v_and_b32 v21, 0xffff0000, v70
    v_add_f32 v76, v76, v20
    v_add_f32 v77, v77, v21
    ds_read_b64_tr_b16 v[28:29], v102 offset:2048
    v_mfma_f32_16x16x32_bf16 v[60:63], v[36:39], v[148:151], v[60:63]
    v_lshlrev_b32 v20, 16, v71
    v_and_b32 v21, 0xffff0000, v71
    v_add_f32 v78, v78, v20
    v_add_f32 v79, v79, v21
    v_cvt_pk_bf16_f32 v74, v76, v77
    ds_read_b64_tr_b16 v[30:31], v102 offset:3072
    s_setprio 0
    s_waitcnt lgkmcnt(4)
    v_mfma_f32_16x16x32_bf16 v[248:251], v[40:43], v[136:139], v[248:251]
    v_cvt_pk_bf16_f32 v75, v78, v79
    v_bitop3_b32 v76, v72, v73, v74 bitop3:0x96
    v_bitop3_b32 v76, v76, v75, s96 bitop3:0x96
    s_mov_b32 s62, 4
    s_lshl4_add_u32 s62, s62, s40
    s_lshl_b32 s62, s62, 12
    s_add_u32 s62, s62, s76
    buffer_store_dwordx4 v[72:75], v100, s[16:19], s62 offen sc1
    buffer_store_dword v76, v23, s[16:19], s62 offen offset:1024 sc1
    v_add_u32 v103, 0x10000, v103
    ds_read_b64_tr_b16 v[32:33], v103 offset:0
    v_mfma_f32_16x16x32_bf16 v[248:251], v[44:47], v[144:147], v[248:251]
    ds_read_b64_tr_b16 v[34:35], v103 offset:1024
    v_mfma_f32_16x16x32_bf16 v[252:255], v[40:43], v[140:143], v[252:255]
    ds_read_b64_tr_b16 v[36:37], v103 offset:2048
    v_mfma_f32_16x16x32_bf16 v[252:255], v[44:47], v[148:151], v[252:255]
    ds_read_b64_tr_b16 v[38:39], v103 offset:3072
    s_waitcnt vmcnt(8)
    s_barrier
    s_setprio 3
    s_waitcnt lgkmcnt(4)
    v_mfma_f32_16x16x32_bf16 v[56:59], v[24:27], v[152:155], v[56:59]
    v_add_u32 v102, 0xfffde000, v102
    ds_read_b64_tr_b16 v[40:41], v102 offset:0
    v_mfma_f32_16x16x32_bf16 v[56:59], v[28:31], v[160:163], v[56:59]
    ds_read_b64_tr_b16 v[42:43], v102 offset:1024
    v_mfma_f32_16x16x32_bf16 v[60:63], v[24:27], v[156:159], v[60:63]
    ds_read_b64_tr_b16 v[44:45], v102 offset:2048
    v_mfma_f32_16x16x32_bf16 v[60:63], v[28:31], v[164:167], v[60:63]
    ds_read_b64_tr_b16 v[46:47], v102 offset:3072
    s_waitcnt lgkmcnt(4)
    v_mfma_f32_16x16x32_bf16 v[248:251], v[32:35], v[152:155], v[248:251]
    v_add_u32 v103, 0xfffde000, v103
    ds_read_b64_tr_b16 v[24:25], v103 offset:0
    v_mfma_f32_16x16x32_bf16 v[248:251], v[36:39], v[160:163], v[248:251]
    ds_read_b64_tr_b16 v[26:27], v103 offset:1024
    v_mfma_f32_16x16x32_bf16 v[252:255], v[32:35], v[156:159], v[252:255]
    ds_read_b64_tr_b16 v[28:29], v103 offset:2048
    v_mfma_f32_16x16x32_bf16 v[252:255], v[36:39], v[164:167], v[252:255]
    ds_read_b64_tr_b16 v[30:31], v103 offset:3072
    s_setprio 2
    s_waitcnt lgkmcnt(4)
    v_mfma_f32_16x16x32_bf16 v[56:59], v[40:43], v[168:171], v[56:59]
    ds_read_b64_tr_b16 v[32:33], v102 offset:8192
    v_mfma_f32_16x16x32_bf16 v[56:59], v[44:47], v[176:179], v[56:59]
    ds_read_b64_tr_b16 v[34:35], v102 offset:9216
    v_mfma_f32_16x16x32_bf16 v[60:63], v[40:43], v[172:175], v[60:63]
    ds_read_b64_tr_b16 v[36:37], v102 offset:10240
    v_mfma_f32_16x16x32_bf16 v[60:63], v[44:47], v[180:183], v[60:63]
    ds_read_b64_tr_b16 v[38:39], v102 offset:11264
    s_setprio 1
    s_waitcnt lgkmcnt(4)
    v_mfma_f32_16x16x32_bf16 v[248:251], v[24:27], v[168:171], v[248:251]
    ds_read_b64_tr_b16 v[40:41], v103 offset:8192
    v_mfma_f32_16x16x32_bf16 v[248:251], v[28:31], v[176:179], v[248:251]
    ds_read_b64_tr_b16 v[42:43], v103 offset:9216
    v_mfma_f32_16x16x32_bf16 v[252:255], v[24:27], v[172:175], v[252:255]
    ds_read_b64_tr_b16 v[44:45], v103 offset:10240
    v_mfma_f32_16x16x32_bf16 v[252:255], v[28:31], v[180:183], v[252:255]
    ds_read_b64_tr_b16 v[46:47], v103 offset:11264
    s_waitcnt lgkmcnt(4)
    v_mfma_f32_16x16x32_bf16 v[56:59], v[32:35], v[184:187], v[56:59]
    ds_read_b64_tr_b16 v[24:25], v102 offset:49152
    v_mfma_f32_16x16x32_bf16 v[56:59], v[36:39], v[192:195], v[56:59]
    ds_read_b64_tr_b16 v[26:27], v102 offset:50176
    v_mfma_f32_16x16x32_bf16 v[60:63], v[32:35], v[188:191], v[60:63]
    ds_read_b64_tr_b16 v[28:29], v102 offset:51200
    v_mfma_f32_16x16x32_bf16 v[60:63], v[36:39], v[196:199], v[60:63]
    ds_read_b64_tr_b16 v[30:31], v102 offset:52224
    s_setprio 0
    s_waitcnt lgkmcnt(4)
    v_mfma_f32_16x16x32_bf16 v[248:251], v[40:43], v[184:187], v[248:251]
    ds_read_b64_tr_b16 v[32:33], v103 offset:49152
    v_mfma_f32_16x16x32_bf16 v[248:251], v[44:47], v[192:195], v[248:251]
    ds_read_b64_tr_b16 v[34:35], v103 offset:50176
    v_mfma_f32_16x16x32_bf16 v[252:255], v[40:43], v[188:191], v[252:255]
    ds_read_b64_tr_b16 v[36:37], v103 offset:51200
    v_mfma_f32_16x16x32_bf16 v[252:255], v[44:47], v[196:199], v[252:255]
    ds_read_b64_tr_b16 v[38:39], v103 offset:52224
    s_barrier
    s_setprio 3
    s_waitcnt lgkmcnt(4)
    v_mfma_f32_16x16x32_bf16 v[56:59], v[24:27], v[200:203], v[56:59]
    ds_read_b64_tr_b16 v[40:41], v102 offset:57344
    v_mfma_f32_16x16x32_bf16 v[56:59], v[28:31], v[208:211], v[56:59]
    ds_read_b64_tr_b16 v[42:43], v102 offset:58368
    v_mfma_f32_16x16x32_bf16 v[60:63], v[24:27], v[204:207], v[60:63]
    ds_read_b64_tr_b16 v[44:45], v102 offset:59392
    v_mfma_f32_16x16x32_bf16 v[60:63], v[28:31], v[212:215], v[60:63]
    ds_read_b64_tr_b16 v[46:47], v102 offset:60416
    s_waitcnt lgkmcnt(4)
    v_mfma_f32_16x16x32_bf16 v[248:251], v[32:35], v[200:203], v[248:251]
    ds_read_b64_tr_b16 v[24:25], v103 offset:57344
    v_mfma_f32_16x16x32_bf16 v[248:251], v[36:39], v[208:211], v[248:251]
    ds_read_b64_tr_b16 v[26:27], v103 offset:58368
    v_mfma_f32_16x16x32_bf16 v[252:255], v[32:35], v[204:207], v[252:255]
    ds_read_b64_tr_b16 v[28:29], v103 offset:59392
    v_mfma_f32_16x16x32_bf16 v[252:255], v[36:39], v[212:215], v[252:255]
    ds_read_b64_tr_b16 v[30:31], v103 offset:60416
    s_setprio 2
    s_waitcnt lgkmcnt(4)
    v_mfma_f32_16x16x32_bf16 v[56:59], v[40:43], v[216:219], v[56:59]
    v_add_u32 v102, 0x10000, v102
    ds_read_b64_tr_b16 v[32:33], v102 offset:0
    v_mfma_f32_16x16x32_bf16 v[56:59], v[44:47], v[224:227], v[56:59]
    ds_read_b64_tr_b16 v[34:35], v102 offset:1024
    v_mfma_f32_16x16x32_bf16 v[60:63], v[40:43], v[220:223], v[60:63]
    ds_read_b64_tr_b16 v[36:37], v102 offset:2048
    v_mfma_f32_16x16x32_bf16 v[60:63], v[44:47], v[228:231], v[60:63]
    ds_read_b64_tr_b16 v[38:39], v102 offset:3072
    s_setprio 1
    s_waitcnt lgkmcnt(4)
    v_mfma_f32_16x16x32_bf16 v[248:251], v[24:27], v[216:219], v[248:251]
    v_add_u32 v103, 0x10000, v103
    ds_read_b64_tr_b16 v[40:41], v103 offset:0
    v_mfma_f32_16x16x32_bf16 v[248:251], v[28:31], v[224:227], v[248:251]
    ds_read_b64_tr_b16 v[42:43], v103 offset:1024
    v_mfma_f32_16x16x32_bf16 v[252:255], v[24:27], v[220:223], v[252:255]
    ds_read_b64_tr_b16 v[44:45], v103 offset:2048
    v_mfma_f32_16x16x32_bf16 v[252:255], v[28:31], v[228:231], v[252:255]
    ds_read_b64_tr_b16 v[46:47], v103 offset:3072
    s_waitcnt lgkmcnt(4)
    v_mfma_f32_16x16x32_bf16 v[56:59], v[32:35], v[232:235], v[56:59]
    v_mfma_f32_16x16x32_bf16 v[56:59], v[36:39], v[240:243], v[56:59]
    v_mfma_f32_16x16x32_bf16 v[60:63], v[32:35], v[236:239], v[60:63]
    v_mfma_f32_16x16x32_bf16 v[60:63], v[36:39], v[244:247], v[60:63]
    s_setprio 0
    s_waitcnt lgkmcnt(0)
    v_mfma_f32_16x16x32_bf16 v[248:251], v[40:43], v[232:235], v[248:251]
    v_mfma_f32_16x16x32_bf16 v[248:251], v[44:47], v[240:243], v[248:251]
    v_mfma_f32_16x16x32_bf16 v[252:255], v[40:43], v[236:239], v[252:255]
    v_mfma_f32_16x16x32_bf16 v[252:255], v[44:47], v[244:247], v[252:255]
    s_lshl_b32 s54, s40, 16
    s_add_u32 s54, s54, s76
    s_add_u32 s62, s40, 1
    s_and_b32 s62, s62, 3
    s_lshl_b32 s62, s62, 12
    s_add_u32 s44, s62, s54
    s_add_u32 s62, s40, 2
    s_and_b32 s62, s62, 3
    s_lshl_b32 s62, s62, 12
    s_add_u32 s45, s62, s54
    s_add_u32 s62, s40, 3
    s_and_b32 s62, s62, 3
    s_lshl_b32 s62, s62, 12
    s_add_u32 s46, s62, s54
    buffer_load_dwordx4 v[112:115], v100, s[16:19], s44 offen sc1
    buffer_load_dword v116, v23, s[16:19], s44 offen offset:1024 sc1
    buffer_load_dwordx4 v[120:123], v100, s[16:19], s45 offen sc1
    buffer_load_dword v124, v23, s[16:19], s45 offen offset:1024 sc1
    buffer_load_dwordx4 v[128:131], v100, s[16:19], s46 offen sc1
    buffer_load_dword v132, v23, s[16:19], s46 offen offset:1024 sc1
    s_add_u32 s48, s76, 262144
    s_add_u32 s49, s76, 266240
    s_add_u32 s50, s76, 270336
    s_add_u32 s51, s76, 274432
    s_cmp_eq_u32 s37, s40
    s_cbranch_scc0 LA_nl43
    buffer_load_dwordx4 v[136:139], v100, s[16:19], s48 offen sc1
    buffer_load_dword v140, v23, s[16:19], s48 offen offset:1024 sc1
    buffer_load_dwordx4 v[144:147], v100, s[16:19], s49 offen sc1
    buffer_load_dword v148, v23, s[16:19], s49 offen offset:1024 sc1
    buffer_load_dwordx4 v[152:155], v100, s[16:19], s50 offen sc1
    buffer_load_dword v156, v23, s[16:19], s50 offen offset:1024 sc1
    buffer_load_dwordx4 v[160:163], v100, s[16:19], s51 offen sc1
    buffer_load_dword v164, v23, s[16:19], s51 offen offset:1024 sc1
LA_nl43:
    v_add_u32 v1, 0x26000, v1
    ds_write_b128 v1, v[248:251] offset:0
    v_add_u32 v1, 0xfffee000, v1
    ds_write_b128 v1, v[252:255] offset:0
    v_lshrrev_b32 v14, 4, v0
    s_lshl_b32 s62, s38, 5
    s_sub_u32 s63, s62, s43
    s_add_u32 s63, s63, 5120
    v_lshl_add_u32 v12, v14, 3, s63
    v_and_b32 v13, 15, v0
    v_mul_u32_u24 v13, 1152, v13
    v_lshl_add_u32 v13, v14, 3, v13
    s_lshl2_add_u32 s55, s39, s37
    s_mul_i32 s55, s55, 36864
    s_add_u32 s55, s55, s62
    s_waitcnt lgkmcnt(0)
    s_barrier
    v_add_u32 v4, 0x26000, v4
    ds_read_b128 v[24:27], v4 offset:0
    v_add_u32 v4, 0xfffee000, v4
    ds_read_b128 v[28:31], v4 offset:0
    v_add_u32 v32, s83, v12
    ds_read_b64 v[32:33], v32
    s_waitcnt lgkmcnt(0)
    v_lshlrev_b32 v36, 16, v32
    v_and_b32 v37, 0xffff0000, v32
    v_lshlrev_b32 v38, 16, v33
    v_and_b32 v39, 0xffff0000, v33
    v_add_f32 v56, v56, v24
    v_add_f32 v56, v56, v36
    v_add_f32 v57, v57, v25
    v_add_f32 v57, v57, v37
    v_add_f32 v58, v58, v26
    v_add_f32 v58, v58, v38
    v_add_f32 v59, v59, v27
    v_add_f32 v59, v59, v39
    v_add_f32 v60, v60, v28
    v_add_f32 v60, v60, v36
    v_add_f32 v61, v61, v29
    v_add_f32 v61, v61, v37
    v_add_f32 v62, v62, v30
    v_add_f32 v62, v62, v38
    v_add_f32 v63, v63, v31
    v_add_f32 v63, v63, v39
    s_waitcnt vmcnt(0)
    v_bitop3_b32 v117, v112, v113, v114 bitop3:0x96
    v_bitop3_b32 v117, v117, v115, v116 bitop3:0x96
    v_xor_b32 v117, s96, v117
    v_bitop3_b32 v125, v120, v121, v122 bitop3:0x96
    v_bitop3_b32 v125, v125, v123, v124 bitop3:0x96
    v_xor_b32 v125, s96, v125
    v_or_b32 v117, v117, v125
    v_bitop3_b32 v133, v128, v129, v130 bitop3:0x96
    v_bitop3_b32 v133, v133, v131, v132 bitop3:0x96
    v_xor_b32 v133, s96, v133
    v_or_b32 v117, v117, v133
    v_cmp_ne_u32 vcc, 0, v117
    s_nop 3
    s_cmp_lg_u64 vcc, 0
    s_cbranch_scc0 LA_fo44
    s_mov_b32 s78, 200000
LA_fs45:
    s_sleep 1
    buffer_load_dwordx4 v[112:115], v100, s[16:19], s44 offen sc1
    buffer_load_dword v116, v23, s[16:19], s44 offen offset:1024 sc1
    buffer_load_dwordx4 v[120:123], v100, s[16:19], s45 offen sc1
    buffer_load_dword v124, v23, s[16:19], s45 offen offset:1024 sc1
    buffer_load_dwordx4 v[128:131], v100, s[16:19], s46 offen sc1
    buffer_load_dword v132, v23, s[16:19], s46 offen offset:1024 sc1
    s_waitcnt vmcnt(0)
    v_bitop3_b32 v117, v112, v113, v114 bitop3:0x96
    v_bitop3_b32 v117, v117, v115, v116 bitop3:0x96
    v_xor_b32 v117, s96, v117
    v_bitop3_b32 v125, v120, v121, v122 bitop3:0x96
    v_bitop3_b32 v125, v125, v123, v124 bitop3:0x96
    v_xor_b32 v125, s96, v125
    v_or_b32 v117, v117, v125
    v_bitop3_b32 v133, v128, v129, v130 bitop3:0x96
    v_bitop3_b32 v133, v133, v131, v132 bitop3:0x96
    v_xor_b32 v133, s96, v133
    v_or_b32 v117, v117, v133
    v_cmp_ne_u32 vcc, 0, v117
    s_nop 3
    s_cmp_lg_u64 vcc, 0
    s_cbranch_scc0 LA_fo44
    s_sub_u32 s78, s78, 1
    s_cmp_lg_u32 s78, 0
    s_cbranch_scc1 LA_fs45
LA_fo44:
    v_lshlrev_b32 v118, 16, v112
    v_and_b32 v119, 0xffff0000, v112
    v_add_f32 v56, v56, v118
    v_add_f32 v57, v57, v119
    v_lshlrev_b32 v118, 16, v113
    v_and_b32 v119, 0xffff0000, v113
    v_add_f32 v58, v58, v118
    v_add_f32 v59, v59, v119
    v_lshlrev_b32 v118, 16, v114
    v_and_b32 v119, 0xffff0000, v114
    v_add_f32 v60, v60, v118
    v_add_f32 v61, v61, v119
    v_lshlrev_b32 v118, 16, v115
    v_and_b32 v119, 0xffff0000, v115
    v_add_f32 v62, v62, v118
    v_add_f32 v63, v63, v119
    v_lshlrev_b32 v126, 16, v120
    v_and_b32 v127, 0xffff0000, v120
    v_add_f32 v56, v56, v126
    v_add_f32 v57, v57, v127
    v_lshlrev_b32 v126, 16, v121
    v_and_b32 v127, 0xffff0000, v121
    v_add_f32 v58, v58, v126
    v_add_f32 v59, v59, v127
    v_lshlrev_b32 v126, 16, v122
    v_and_b32 v127, 0xffff0000, v122
    v_add_f32 v60, v60, v126
    v_add_f32 v61, v61, v127
    v_lshlrev_b32 v126, 16, v123
    v_and_b32 v127, 0xffff0000, v123
    v_add_f32 v62, v62, v126
    v_add_f32 v63, v63, v127
    v_lshlrev_b32 v134, 16, v128
    v_and_b32 v135, 0xffff0000, v128
    v_add_f32 v56, v56, v134
    v_add_f32 v57, v57, v135
    v_lshlrev_b32 v134, 16, v129
    v_and_b32 v135, 0xffff0000, v129
    v_add_f32 v58, v58, v134
    v_add_f32 v59, v59, v135
    v_lshlrev_b32 v134, 16, v130
    v_and_b32 v135, 0xffff0000, v130
    v_add_f32 v60, v60, v134
    v_add_f32 v61, v61, v135
    v_lshlrev_b32 v134, 16, v131
    v_and_b32 v135, 0xffff0000, v131
    v_add_f32 v62, v62, v134
    v_add_f32 v63, v63, v135
    s_cmp_eq_u32 s37, s40
    s_cbranch_scc0 LA_nl46
    v_add_u32 v32, s82, v12
    ds_read_b64 v[32:33], v32
    s_waitcnt lgkmcnt(0)
    v_lshlrev_b32 v36, 16, v32
    v_and_b32 v37, 0xffff0000, v32
    v_lshlrev_b32 v38, 16, v33
    v_and_b32 v39, 0xffff0000, v33
    v_mov_b32 v248, v36
    v_mov_b32 v249, v37
    v_mov_b32 v250, v38
    v_mov_b32 v251, v39
    v_mov_b32 v252, v36
    v_mov_b32 v253, v37
    v_mov_b32 v254, v38
    v_mov_b32 v255, v39
    s_waitcnt vmcnt(0)
    v_bitop3_b32 v141, v136, v137, v138 bitop3:0x96
    v_bitop3_b32 v141, v141, v139, v140 bitop3:0x96
    v_xor_b32 v141, s96, v141
    v_bitop3_b32 v149, v144, v145, v146 bitop3:0x96
    v_bitop3_b32 v149, v149, v147, v148 bitop3:0x96
    v_xor_b32 v149, s96, v149
    v_or_b32 v141, v141, v149
    v_bitop3_b32 v157, v152, v153, v154 bitop3:0x96
    v_bitop3_b32 v157, v157, v155, v156 bitop3:0x96
    v_xor_b32 v157, s96, v157
    v_or_b32 v141, v141, v157
    v_bitop3_b32 v165, v160, v161, v162 bitop3:0x96
    v_bitop3_b32 v165, v165, v163, v164 bitop3:0x96
    v_xor_b32 v165, s96, v165
    v_or_b32 v141, v141, v165
    v_cmp_ne_u32 vcc, 0, v141
    s_nop 3
    s_cmp_lg_u64 vcc, 0
    s_cbranch_scc0 LA_fo47
    s_mov_b32 s78, 200000
LA_fs48:
    s_sleep 1
    buffer_load_dwordx4 v[136:139], v100, s[16:19], s48 offen sc1
    buffer_load_dword v140, v23, s[16:19], s48 offen offset:1024 sc1
    buffer_load_dwordx4 v[144:147], v100, s[16:19], s49 offen sc1
    buffer_load_dword v148, v23, s[16:19], s49 offen offset:1024 sc1
    buffer_load_dwordx4 v[152:155], v100, s[16:19], s50 offen sc1
    buffer_load_dword v156, v23, s[16:19], s50 offen offset:1024 sc1
    buffer_load_dwordx4 v[160:163], v100, s[16:19], s51 offen sc1
    buffer_load_dword v164, v23, s[16:19], s51 offen offset:1024 sc1
    s_waitcnt vmcnt(0)
    v_bitop3_b32 v141, v136, v137, v138 bitop3:0x96
    v_bitop3_b32 v141, v141, v139, v140 bitop3:0x96
    v_xor_b32 v141, s96, v141
    v_bitop3_b32 v149, v144, v145, v146 bitop3:0x96
    v_bitop3_b32 v149, v149, v147, v148 bitop3:0x96
    v_xor_b32 v149, s96, v149
    v_or_b32 v141, v141, v149
    v_bitop3_b32 v157, v152, v153, v154 bitop3:0x96
    v_bitop3_b32 v157, v157, v155, v156 bitop3:0x96
    v_xor_b32 v157, s96, v157
    v_or_b32 v141, v141, v157
    v_bitop3_b32 v165, v160, v161, v162 bitop3:0x96
    v_bitop3_b32 v165, v165, v163, v164 bitop3:0x96
    v_xor_b32 v165, s96, v165
    v_or_b32 v141, v141, v165
    v_cmp_ne_u32 vcc, 0, v141
    s_nop 3
    s_cmp_lg_u64 vcc, 0
    s_cbranch_scc0 LA_fo47
    s_sub_u32 s78, s78, 1
    s_cmp_lg_u32 s78, 0
    s_cbranch_scc1 LA_fs48
LA_fo47:
    v_lshlrev_b32 v142, 16, v136
    v_and_b32 v143, 0xffff0000, v136
    v_add_f32 v248, v248, v142
    v_add_f32 v249, v249, v143
    v_lshlrev_b32 v142, 16, v137
    v_and_b32 v143, 0xffff0000, v137
    v_add_f32 v250, v250, v142
    v_add_f32 v251, v251, v143
    v_lshlrev_b32 v142, 16, v138
    v_and_b32 v143, 0xffff0000, v138
    v_add_f32 v252, v252, v142
    v_add_f32 v253, v253, v143
    v_lshlrev_b32 v142, 16, v139
    v_and_b32 v143, 0xffff0000, v139
    v_add_f32 v254, v254, v142
    v_add_f32 v255, v255, v143
    v_lshlrev_b32 v150, 16, v144
    v_and_b32 v151, 0xffff0000, v144
    v_add_f32 v248, v248, v150
    v_add_f32 v249, v249, v151
    v_lshlrev_b32 v150, 16, v145
    v_and_b32 v151, 0xffff0000, v145
    v_add_f32 v250, v250, v150
    v_add_f32 v251, v251, v151
    v_lshlrev_b32 v150, 16, v146
    v_and_b32 v151, 0xffff0000, v146
    v_add_f32 v252, v252, v150
    v_add_f32 v253, v253, v151
    v_lshlrev_b32 v150, 16, v147
    v_and_b32 v151, 0xffff0000, v147
    v_add_f32 v254, v254, v150
    v_add_f32 v255, v255, v151
    v_lshlrev_b32 v158, 16, v152
    v_and_b32 v159, 0xffff0000, v152
    v_add_f32 v248, v248, v158
    v_add_f32 v249, v249, v159
    v_lshlrev_b32 v158, 16, v153
    v_and_b32 v159, 0xffff0000, v153
    v_add_f32 v250, v250, v158
    v_add_f32 v251, v251, v159
    v_lshlrev_b32 v158, 16, v154
    v_and_b32 v159, 0xffff0000, v154
    v_add_f32 v252, v252, v158
    v_add_f32 v253, v253, v159
    v_lshlrev_b32 v158, 16, v155
    v_and_b32 v159, 0xffff0000, v155
    v_add_f32 v254, v254, v158
    v_add_f32 v255, v255, v159
    v_lshlrev_b32 v166, 16, v160
    v_and_b32 v167, 0xffff0000, v160
    v_add_f32 v248, v248, v166
    v_add_f32 v249, v249, v167
    v_lshlrev_b32 v166, 16, v161
    v_and_b32 v167, 0xffff0000, v161
    v_add_f32 v250, v250, v166
    v_add_f32 v251, v251, v167
    v_lshlrev_b32 v166, 16, v162
    v_and_b32 v167, 0xffff0000, v162
    v_add_f32 v252, v252, v166
    v_add_f32 v253, v253, v167
    v_lshlrev_b32 v166, 16, v163
    v_and_b32 v167, 0xffff0000, v163
    v_add_f32 v254, v254, v166
    v_add_f32 v255, v255, v167
    s_add_u32 s63, s55, s82
    v_cvt_pk_bf16_f32 v248, v248, v249
    v_cvt_pk_bf16_f32 v249, v250, v251
    buffer_store_dwordx2 v[248:249], v13, s[20:23], s63 offen
    v_cvt_pk_bf16_f32 v252, v252, v253
    v_cvt_pk_bf16_f32 v253, v254, v255
    s_add_u32 s63, s63, 18432
    buffer_store_dwordx2 v[252:253], v13, s[20:23], s63 offen
LA_nl46:
    s_add_u32 s63, s55, s83
    v_cvt_pk_bf16_f32 v56, v56, v57
    v_cvt_pk_bf16_f32 v57, v58, v59
    buffer_store_dwordx2 v[56:57], v13, s[20:23], s63 offen
    v_cvt_pk_bf16_f32 v60, v60, v61
    v_cvt_pk_bf16_f32 v61, v62, v63
    s_add_u32 s63, s63, 18432
    buffer_store_dwordx2 v[60:61], v13, s[20:23], s63 offen
    s_endpgm
L_typeB:
    s_waitcnt vmcnt(10)
    s_barrier
    s_setprio 3
    s_waitcnt lgkmcnt(4)
    v_mfma_f32_16x16x32_bf16 v[64:67], v[24:27], v[208:211], v[64:67]
    v_mul_f32 v56, v56, v12
    v_mul_f32 v57, v57, v13
    v_mul_f32 v58, v58, v14
    v_mul_f32 v59, v59, v15
    s_add_u32 m0, s42, 98304
    ds_read_b64_tr_b16 v[40:41], v1 offset:49152
    buffer_load_dwordx4 v5, s[8:11], s48 offen lds
    v_mfma_f32_16x16x32_bf16 v[64:67], v[28:31], v[212:215], v[64:67]
    v_cvt_pk_bf16_f32 v82, v56, v57
    v_cvt_pk_bf16_f32 v83, v58, v59
    s_cbranch_vccz LB_sw8
    v_swap_b32 v80, v82
    v_swap_b32 v81, v83
LB_sw8:
    s_add_u32 s63, s65, 0
    buffer_store_dwordx4 v[80:83], v100, s[16:19], s63 offen sc1
    ds_read_b64_tr_b16 v[42:43], v1 offset:49408
    v_mfma_f32_16x16x32_bf16 v[68:71], v[24:27], v[216:219], v[68:71]
    v_mul_f32 v12, v52, v52
    v_mul_f32 v13, v53, v53
    v_mul_f32 v14, v54, v54
    v_mul_f32 v15, v55, v55
    ds_read_b64_tr_b16 v[44:45], v2 offset:49152
    v_mfma_f32_16x16x32_bf16 v[68:71], v[28:31], v[220:223], v[68:71]
    v_fma_f32 v12, v12, v20, v19
    v_fma_f32 v13, v13, v20, v19
    v_fma_f32 v14, v14, v20, v19
    ds_read_b64_tr_b16 v[46:47], v2 offset:49408
    v_mfma_f32_16x16x32_bf16 v[92:95], v[88:91], v[24:27], v[92:95]
    v_fma_f32 v15, v15, v20, v19
    v_mul_f32 v12, v52, v12
    v_mul_f32 v13, v53, v13
    v_mul_f32 v14, v54, v14
    s_waitcnt lgkmcnt(4)
    v_mfma_f32_16x16x32_bf16 v[72:75], v[32:35], v[208:211], v[72:75]
    v_mul_f32 v15, v55, v15
    v_exp_f32 v12, v12
    ds_read_b64_tr_b16 v[24:25], v3 offset:49152
    v_mfma_f32_16x16x32_bf16 v[72:75], v[36:39], v[212:215], v[72:75]
    v_exp_f32 v13, v13
    v_exp_f32 v14, v14
    ds_read_b64_tr_b16 v[26:27], v3 offset:49408
    v_mfma_f32_16x16x32_bf16 v[76:79], v[32:35], v[216:219], v[76:79]
    v_exp_f32 v15, v15
    v_fma_f32 v12, v12, v21, v21
    s_add_u32 m0, s42, 106496
    ds_read_b64_tr_b16 v[28:29], v4 offset:49152
    buffer_load_dwordx4 v5, s[8:11], s49 offen lds
    v_mfma_f32_16x16x32_bf16 v[76:79], v[36:39], v[220:223], v[76:79]
    v_fma_f32 v13, v13, v21, v21
    v_fma_f32 v14, v14, v21, v21
    v_fma_f32 v15, v15, v21, v21
    ds_read_b64_tr_b16 v[30:31], v4 offset:49408
    s_setprio 2
    s_waitcnt lgkmcnt(4)
    v_mfma_f32_16x16x32_bf16 v[64:67], v[40:43], v[224:227], v[64:67]
    v_rcp_f32 v12, v12
    v_rcp_f32 v13, v13
    ds_read_b64_tr_b16 v[32:33], v1 offset:57344
    v_mfma_f32_16x16x32_bf16 v[64:67], v[44:47], v[228:231], v[64:67]
    v_rcp_f32 v14, v14
    v_rcp_f32 v15, v15
    ds_read_b64_tr_b16 v[34:35], v1 offset:57600
    v_mfma_f32_16x16x32_bf16 v[68:71], v[40:43], v[232:235], v[68:71]
    v_mul_f32 v52, v52, v12
    v_mul_f32 v53, v53, v13
    v_mul_f32 v54, v54, v14
    ds_read_b64_tr_b16 v[36:37], v2 offset:57344
    v_mfma_f32_16x16x32_bf16 v[68:71], v[44:47], v[236:239], v[68:71]
    v_mul_f32 v55, v55, v15
    v_cvt_pk_bf16_f32 v84, v52, v53
    v_cvt_pk_bf16_f32 v85, v54, v55
    v_mul_f32 v12, v60, v60
    ds_read_b64_tr_b16 v[38:39], v2 offset:57600
    v_mfma_f32_16x16x32_bf16 v[92:95], v[88:91], v[40:43], v[92:95]
    v_mul_f32 v13, v61, v61
    v_mul_f32 v14, v62, v62
    v_mul_f32 v15, v63, v63
    s_setprio 1
    s_waitcnt lgkmcnt(4)
    v_mfma_f32_16x16x32_bf16 v[72:75], v[24:27], v[224:227], v[72:75]
    v_fma_f32 v12, v12, v20, v19
    v_fma_f32 v13, v13, v20, v19
    v_fma_f32 v14, v14, v20, v19
    v_fma_f32 v15, v15, v20, v19
    s_add_u32 m0, s42, 114688
    ds_read_b64_tr_b16 v[40:41], v3 offset:57344
    buffer_load_dwordx4 v5, s[8:11], s50 offen lds
    v_mfma_f32_16x16x32_bf16 v[72:75], v[28:31], v[228:231], v[72:75]
    v_mul_f32 v12, v60, v12
    v_mul_f32 v13, v61, v13
    v_mul_f32 v14, v62, v14
    ds_read_b64_tr_b16 v[42:43], v3 offset:57600
    v_mfma_f32_16x16x32_bf16 v[76:79], v[24:27], v[232:235], v[76:79]
    v_mul_f32 v15, v63, v15
    v_exp_f32 v12, v12
    ds_read_b64_tr_b16 v[44:45], v4 offset:57344
    v_mfma_f32_16x16x32_bf16 v[76:79], v[28:31], v[236:239], v[76:79]
    v_exp_f32 v13, v13
    v_exp_f32 v14, v14
    ds_read_b64_tr_b16 v[46:47], v4 offset:57600
    s_waitcnt lgkmcnt(4)
    v_mfma_f32_16x16x32_bf16 v[64:67], v[32:35], v[240:243], v[64:67]
    v_exp_f32 v15, v15
    v_fma_f32 v12, v12, v21, v21
    v_fma_f32 v13, v13, v21, v21
    v_add_u32 v1, 0x10000, v1
    ds_read_b64_tr_b16 v[24:25], v1 offset:0
    v_mfma_f32_16x16x32_bf16 v[64:67], v[36:39], v[244:247], v[64:67]
    v_fma_f32 v14, v14, v21, v21
    v_fma_f32 v15, v15, v21, v21
    ds_read_b64_tr_b16 v[26:27], v1 offset:256
    v_mfma_f32_16x16x32_bf16 v[68:71], v[32:35], v[248:251], v[68:71]
    v_rcp_f32 v12, v12
    v_rcp_f32 v13, v13
    v_add_u32 v2, 0x10000, v2
    ds_read_b64_tr_b16 v[28:29], v2 offset:0
    v_mfma_f32_16x16x32_bf16 v[68:71], v[36:39], v[252:255], v[68:71]
    v_rcp_f32 v14, v14
    ds_read_b64_tr_b16 v[30:31], v2 offset:256
    v_mfma_f32_16x16x32_bf16 v[92:95], v[88:91], v[32:35], v[92:95]
    v_rcp_f32 v15, v15
    v_mul_f32 v60, v60, v12
    v_mul_f32 v61, v61, v13
    v_mul_f32 v62, v62, v14
    s_setprio 0
    s_waitcnt lgkmcnt(4)
    v_mfma_f32_16x16x32_bf16 v[72:75], v[40:43], v[240:243], v[72:75]
    v_mul_f32 v63, v63, v15
    v_cvt_pk_bf16_f32 v86, v60, v61
    v_cvt_pk_bf16_f32 v87, v62, v63
    s_cbranch_vccz LB_sw9
    v_swap_b32 v84, v86
    v_swap_b32 v85, v87
LB_sw9:
    s_add_u32 s63, s65, 1024
    buffer_store_dwordx4 v[84:87], v100, s[16:19], s63 offen sc1
    s_cmp_eq_u32 s36, 5
    s_cbranch_scc0 LB_dw10
    v_lshlrev_b32 v99, 7, v0
    s_and_b32 s62, s39, 7
    s_lshl2_add_u32 s62, s62, s41
    s_mul_i32 s62, s62, 41472
    s_mul_i32 s63, s40, 1327104
    s_add_u32 s62, s62, s63
    s_add_u32 s62, s62, 20736
    s_mov_b32 m0, 512
    s_mov_b32 exec_lo, 0xffffffff
    s_mov_b32 exec_hi, 0x3fffff
    buffer_load_dword v99, s[12:15], s62 offen lds
    s_mov_b64 exec, -1
LB_dw10:
    v_add_u32 v3, 0x10000, v3
    ds_read_b64_tr_b16 v[32:33], v3 offset:0
    v_mfma_f32_16x16x32_bf16 v[72:75], v[44:47], v[244:247], v[72:75]
    s_cmp_eq_u32 s36, 6
    s_cbranch_scc0 LB_dw11
    v_lshlrev_b32 v99, 7, v0
    s_and_b32 s62, s39, 7
    s_lshl2_add_u32 s62, s62, s41
    s_mul_i32 s62, s62, 41472
    s_mul_i32 s63, s40, 1327104
    s_add_u32 s62, s62, s63
    s_add_u32 s62, s62, 27648
    s_mov_b32 m0, 512
    s_mov_b32 exec_lo, 0xffffffff
    s_mov_b32 exec_hi, 0x3fffff
    buffer_load_dword v99, s[12:15], s62 offen lds
    s_mov_b64 exec, -1
LB_dw11:
    ds_read_b64_tr_b16 v[34:35], v3 offset:256
    v_mfma_f32_16x16x32_bf16 v[76:79], v[40:43], v[248:251], v[76:79]
    v_add_u32 v4, 0x10000, v4
    ds_read_b64_tr_b16 v[36:37], v4 offset:0
    v_mfma_f32_16x16x32_bf16 v[76:79], v[44:47], v[252:255], v[76:79]
    ds_read_b64_tr_b16 v[38:39], v4 offset:256
    v_and_b32 v99, 15, v0
    v_lshl_add_u32 v99, v99, 4, s66
    ds_write_b32 v99, v92 offset:512
    s_waitcnt lgkmcnt(0)
    s_waitcnt vmcnt(12)
    s_barrier
    s_setprio 3
    v_mfma_f32_16x16x32_bf16 v[48:51], v[24:27], v[112:115], 0
    s_cmp_eq_u32 s36, 7
    s_cbranch_scc0 LB_dw12
    v_lshlrev_b32 v99, 7, v0
    s_and_b32 s62, s39, 7
    s_lshl2_add_u32 s62, s62, s41
    s_mul_i32 s62, s62, 41472
    s_mul_i32 s63, s40, 1327104
    s_add_u32 s62, s62, s63
    s_add_u32 s62, s62, 34560
    s_mov_b32 m0, 512
    s_mov_b32 exec_lo, 0xffffffff
    s_mov_b32 exec_hi, 0x3fffff
    buffer_load_dword v99, s[12:15], s62 offen lds
    s_mov_b64 exec, -1
LB_dw12:
    v_and_b32 v96, 15, v0
    v_lshl_add_u32 v22, v96, 4, s67
    ds_read_b64 v[12:13], v22 offset:512
    v_xor_b32 v22, 8, v22
    s_add_u32 m0, s42, 122880
    v_add_u32 v1, 0xfffde000, v1
    ds_read_b64_tr_b16 v[40:41], v1 offset:0
    buffer_load_dwordx4 v5, s[8:11], s51 offen lds
    v_mfma_f32_16x16x32_bf16 v[48:51], v[28:31], v[116:119], v[48:51]
    ds_read_b64 v[14:15], v22 offset:512
    v_lshl_add_u32 v96, v96, 1, s79
    ds_read_u16 v22, v96 offset:128
    ds_read_b64_tr_b16 v[42:43], v1 offset:256
    v_mfma_f32_16x16x32_bf16 v[52:55], v[24:27], v[120:123], 0
    v_xor_b32 v96, 32, v96
    ds_read_u16 v96, v96 offset:128
    v_add_u32 v2, 0xfffde000, v2
    ds_read_b64_tr_b16 v[44:45], v2 offset:0
    v_mfma_f32_16x16x32_bf16 v[52:55], v[28:31], v[124:127], v[52:55]
    ds_read_b64_tr_b16 v[46:47], v2 offset:256
    v_mfma_f32_16x16x32_bf16 v[92:95], v[88:91], v[24:27], 0
    v_mfma_f32_16x16x32_bf16 v[56:59], v[32:35], v[112:115], 0
    v_add_u32 v3, 0xfffde000, v3
    ds_read_b64_tr_b16 v[24:25], v3 offset:0
    v_mfma_f32_16x16x32_bf16 v[56:59], v[36:39], v[116:119], v[56:59]
    s_waitcnt lgkmcnt(8)
    v_add_f32 v12, v12, v13
    s_waitcnt lgkmcnt(6)
    v_add_f32 v14, v14, v15
    s_waitcnt lgkmcnt(5)
    v_lshlrev_b32 v22, 16, v22
    ds_read_b64_tr_b16 v[26:27], v3 offset:256
    v_mfma_f32_16x16x32_bf16 v[60:63], v[32:35], v[120:123], 0
    s_waitcnt lgkmcnt(4)
    v_lshlrev_b32 v96, 16, v96
    v_cvt_pk_bf16_f32 v23, v12, v22
    s_add_u32 m0, s42, 131072
    v_add_u32 v4, 0xfffde000, v4
    ds_read_b64_tr_b16 v[28:29], v4 offset:0
    buffer_load_dwordx4 v5, s[8:11], s52 offen lds
    v_mfma_f32_16x16x32_bf16 v[60:63], v[36:39], v[124:127], v[60:63]
    v_cvt_pk_bf16_f32 v97, v14, v96
    v_lshlrev_b32 v13, 16, v23
    ds_read_b64_tr_b16 v[30:31], v4 offset:256
    s_setprio 2
    s_waitcnt lgkmcnt(4)
    v_mfma_f32_16x16x32_bf16 v[48:51], v[40:43], v[128:131], v[48:51]
    v_lshlrev_b32 v15, 16, v97
    v_sub_f32 v12, v12, v13
    ds_read_b64_tr_b16 v[32:33], v1 offset:8192
    v_mfma_f32_16x16x32_bf16 v[48:51], v[44:47], v[132:135], v[48:51]
    v_sub_f32 v14, v14, v15
    v_cvt_pk_bf16_f32 v22, v13, v12
    v_cvt_pk_bf16_f32 v96, v15, v14
    ds_read_b64_tr_b16 v[34:35], v1 offset:8448
    v_mfma_f32_16x16x32_bf16 v[52:55], v[40:43], v[136:139], v[52:55]
    v_mfma_f32_16x16x16_bf16 v[64:67], v[22:23], v[8:9], v[64:67]
    v_mfma_f32_16x16x16_bf16 v[68:71], v[22:23], v[10:11], v[68:71]
    ds_read_b64_tr_b16 v[36:37], v2 offset:8192
    v_mfma_f32_16x16x32_bf16 v[52:55], v[44:47], v[140:143], v[52:55]
    v_mfma_f32_16x16x16_bf16 v[72:75], v[96:97], v[8:9], v[72:75]
    v_mfma_f32_16x16x16_bf16 v[76:79], v[96:97], v[10:11], v[76:79]
    ds_read_b64_tr_b16 v[38:39], v2 offset:8448
    v_mfma_f32_16x16x32_bf16 v[92:95], v[88:91], v[40:43], v[92:95]
    s_setprio 1
    s_waitcnt lgkmcnt(4)
    v_mfma_f32_16x16x32_bf16 v[56:59], v[24:27], v[128:131], v[56:59]
    v_mul_f32 v12, v64, v64
    v_mul_f32 v13, v65, v65
    v_mul_f32 v14, v66, v66
    v_add_u32 v5, 128, v5
    s_add_u32 m0, s42, 139264
    ds_read_b64_tr_b16 v[40:41], v3 offset:8192
    buffer_load_dwordx4 v5, s[8:11], s44 offen lds
    v_mfma_f32_16x16x32_bf16 v[56:59], v[28:31], v[132:135], v[56:59]
    v_mul_f32 v15, v67, v67
    v_fma_f32 v12, v12, v17, v16
    ds_read_b64_tr_b16 v[42:43], v3 offset:8448
    v_mfma_f32_16x16x32_bf16 v[60:63], v[24:27], v[136:139], v[60:63]
    v_fma_f32 v13, v13, v17, v16
    v_fma_f32 v14, v14, v17, v16
    v_fma_f32 v15, v15, v17, v16
    ds_read_b64_tr_b16 v[44:45], v4 offset:8192
    v_mfma_f32_16x16x32_bf16 v[60:63], v[28:31], v[140:143], v[60:63]
    v_mul_f32 v12, v64, v12
    v_mul_f32 v13, v65, v13
    ds_read_b64_tr_b16 v[46:47], v4 offset:8448
    s_waitcnt lgkmcnt(4)
    v_mfma_f32_16x16x32_bf16 v[48:51], v[32:35], v[144:147], v[48:51]
    v_mul_f32 v14, v66, v14
    v_mul_f32 v15, v67, v15
    ds_read_b64_tr_b16 v[24:25], v1 offset:16384
    v_mfma_f32_16x16x32_bf16 v[48:51], v[36:39], v[148:151], v[48:51]
    v_exp_f32 v12, v12
    ds_read_b64_tr_b16 v[26:27], v1 offset:16640
    v_mfma_f32_16x16x32_bf16 v[52:55], v[32:35], v[152:155], v[52:55]
    v_exp_f32 v13, v13
    ds_read_b64_tr_b16 v[28:29], v2 offset:16384
    v_mfma_f32_16x16x32_bf16 v[52:55], v[36:39], v[156:159], v[52:55]
    v_exp_f32 v14, v14
    ds_read_b64_tr_b16 v[30:31], v2 offset:16640
    v_mfma_f32_16x16x32_bf16 v[92:95], v[88:91], v[32:35], v[92:95]
    v_exp_f32 v15, v15
    v_fma_f32 v12, v12, v18, v18
    s_setprio 0
    s_waitcnt lgkmcnt(4)
    v_mfma_f32_16x16x32_bf16 v[56:59], v[40:43], v[144:147], v[56:59]
    v_fma_f32 v13, v13, v18, v18
    v_fma_f32 v14, v14, v18, v18
    ds_read_b64_tr_b16 v[32:33], v3 offset:16384
    v_mfma_f32_16x16x32_bf16 v[56:59], v[44:47], v[148:151], v[56:59]
    v_fma_f32 v15, v15, v18, v18
    v_rcp_f32 v12, v12
    ds_read_b64_tr_b16 v[34:35], v3 offset:16640
    v_mfma_f32_16x16x32_bf16 v[60:63], v[40:43], v[152:155], v[60:63]
    v_rcp_f32 v13, v13
    ds_read_b64_tr_b16 v[36:37], v4 offset:16384
    v_mfma_f32_16x16x32_bf16 v[60:63], v[44:47], v[156:159], v[60:63]
    v_rcp_f32 v14, v14
    ds_read_b64_tr_b16 v[38:39], v4 offset:16640
    s_waitcnt vmcnt(12)
    s_waitcnt vmcnt(3)
    s_barrier
    s_cmp_eq_u32 s36, 0
    s_cbranch_scc0 LB_dw13
    s_add_u32 s63, s96, 1
    v_mov_b32 v98, s63
    v_mov_b32 v99, s97
    s_mul_i32 s62, s41, 120
    s_sub_u32 s62, s2, s62
    s_lshl_b32 s63, s41, 3
    s_lshl_b32 s63, 1, s63
    s_andn2_b32 exec_lo, 0x01010101, s63
    s_mov_b32 exec_hi, 0
    buffer_store_dwordx2 v[98:99], v100, s[16:19], s62 offen sc1
    s_mov_b64 exec, -1
LB_dw13:
    s_setprio 3
    s_waitcnt lgkmcnt(4)
    v_mfma_f32_16x16x32_bf16 v[48:51], v[24:27], v[160:163], v[48:51]
    v_rcp_f32 v15, v15
    v_mul_f32 v64, v64, v12
    s_add_u32 m0, s42, 147456
    ds_read_b64_tr_b16 v[40:41], v1 offset:24576
    buffer_load_dwordx4 v5, s[8:11], s45 offen lds
    v_mfma_f32_16x16x32_bf16 v[48:51], v[28:31], v[164:167], v[48:51]
    v_mul_f32 v65, v65, v13
    v_mul_f32 v66, v66, v14
    ds_read_b64_tr_b16 v[42:43], v1 offset:24832
    v_mfma_f32_16x16x32_bf16 v[52:55], v[24:27], v[168:171], v[52:55]
    v_mul_f32 v67, v67, v15
    v_cvt_pk_bf16_f32 v80, v64, v65
    v_cvt_pk_bf16_f32 v81, v66, v67
    ds_read_b64_tr_b16 v[44:45], v2 offset:24576
    v_mfma_f32_16x16x32_bf16 v[52:55], v[28:31], v[172:175], v[52:55]
    v_mul_f32 v12, v72, v72
    v_mul_f32 v13, v73, v73
    ds_read_b64_tr_b16 v[46:47], v2 offset:24832
    v_mfma_f32_16x16x32_bf16 v[92:95], v[88:91], v[24:27], v[92:95]
    v_mul_f32 v14, v74, v74
    v_mul_f32 v15, v75, v75
    v_fma_f32 v12, v12, v17, v16
    s_waitcnt lgkmcnt(4)
    v_mfma_f32_16x16x32_bf16 v[56:59], v[32:35], v[160:163], v[56:59]
    v_fma_f32 v13, v13, v17, v16
    v_fma_f32 v14, v14, v17, v16
    ds_read_b64_tr_b16 v[24:25], v3 offset:24576
    v_mfma_f32_16x16x32_bf16 v[56:59], v[36:39], v[164:167], v[56:59]
    v_fma_f32 v15, v15, v17, v16
    v_mul_f32 v12, v72, v12
    v_mul_f32 v13, v73, v13
    ds_read_b64_tr_b16 v[26:27], v3 offset:24832
    v_mfma_f32_16x16x32_bf16 v[60:63], v[32:35], v[168:171], v[60:63]
    v_mul_f32 v14, v74, v14
    v_mul_f32 v15, v75, v15
    s_add_u32 m0, s42, 8192
    ds_read_b64_tr_b16 v[28:29], v4 offset:24576
    buffer_load_dwordx4 v5, s[8:11], s46 offen lds
    v_mfma_f32_16x16x32_bf16 v[60:63], v[36:39], v[172:175], v[60:63]
    v_exp_f32 v12, v12
    ds_read_b64_tr_b16 v[30:31], v4 offset:24832
    s_setprio 2
    s_waitcnt lgkmcnt(4)
    v_mfma_f32_16x16x32_bf16 v[48:51], v[40:43], v[176:179], v[48:51]
    v_exp_f32 v13, v13
    ds_read_b64_tr_b16 v[32:33], v1 offset:32768
    v_mfma_f32_16x16x32_bf16 v[48:51], v[44:47], v[180:183], v[48:51]
    v_exp_f32 v14, v14
    ds_read_b64_tr_b16 v[34:35], v1 offset:33024
    v_mfma_f32_16x16x32_bf16 v[52:55], v[40:43], v[184:187], v[52:55]
    v_exp_f32 v15, v15
    v_fma_f32 v12, v12, v18, v18
    ds_read_b64_tr_b16 v[36:37], v2 offset:32768
    v_mfma_f32_16x16x32_bf16 v[52:55], v[44:47], v[188:191], v[52:55]
    v_fma_f32 v13, v13, v18, v18
    v_fma_f32 v14, v14, v18, v18
    ds_read_b64_tr_b16 v[38:39], v2 offset:33024
    v_mfma_f32_16x16x32_bf16 v[92:95], v[88:91], v[40:43], v[92:95]
    v_fma_f32 v15, v15, v18, v18
    v_rcp_f32 v12, v12
    s_setprio 1
    s_waitcnt lgkmcnt(4)
    v_mfma_f32_16x16x32_bf16 v[56:59], v[24:27], v[176:179], v[56:59]
    v_rcp_f32 v13, v13
    s_add_u32 m0, s42, 16384
    ds_read_b64_tr_b16 v[40:41], v3 offset:32768
    buffer_load_dwordx4 v5, s[8:11], s47 offen lds
    v_mfma_f32_16x16x32_bf16 v[56:59], v[28:31], v[180:183], v[56:59]
    v_rcp_f32 v14, v14
    ds_read_b64_tr_b16 v[42:43], v3 offset:33024
    v_mfma_f32_16x16x32_bf16 v[60:63], v[24:27], v[184:187], v[60:63]
    v_rcp_f32 v15, v15
    v_mul_f32 v72, v72, v12
    ds_read_b64_tr_b16 v[44:45], v4 offset:32768
    v_mfma_f32_16x16x32_bf16 v[60:63], v[28:31], v[188:191], v[60:63]
    v_mul_f32 v73, v73, v13
    v_mul_f32 v74, v74, v14
    ds_read_b64_tr_b16 v[46:47], v4 offset:33024
    s_waitcnt lgkmcnt(4)
    v_mfma_f32_16x16x32_bf16 v[48:51], v[32:35], v[192:195], v[48:51]
    v_mul_f32 v75, v75, v15
    v_cvt_pk_bf16_f32 v82, v72, v73
    v_cvt_pk_bf16_f32 v83, v74, v75
    ds_read_b64_tr_b16 v[24:25], v1 offset:40960
    v_mfma_f32_16x16x32_bf16 v[48:51], v[36:39], v[196:199], v[48:51]
    s_cbranch_vccz LB_sw14
    v_swap_b32 v80, v82
    v_swap_b32 v81, v83
LB_sw14:
    s_add_u32 s63, s65, 16384
    buffer_store_dwordx4 v[80:83], v100, s[16:19], s63 offen sc1
    v_mul_f32 v12, v68, v68
    ds_read_b64_tr_b16 v[26:27], v1 offset:41216
    v_mfma_f32_16x16x32_bf16 v[52:55], v[32:35], v[200:203], v[52:55]
    v_mul_f32 v13, v69, v69
    v_mul_f32 v14, v70, v70
    v_mul_f32 v15, v71, v71
    ds_read_b64_tr_b16 v[28:29], v2 offset:40960
    v_mfma_f32_16x16x32_bf16 v[52:55], v[36:39], v[204:207], v[52:55]
    v_fma_f32 v12, v12, v20, v19
    v_fma_f32 v13, v13, v20, v19
    ds_read_b64_tr_b16 v[30:31], v2 offset:41216
    v_mfma_f32_16x16x32_bf16 v[92:95], v[88:91], v[32:35], v[92:95]
    v_fma_f32 v14, v14, v20, v19
    v_fma_f32 v15, v15, v20, v19
    v_mul_f32 v12, v68, v12
    s_setprio 0
    s_waitcnt lgkmcnt(4)
    v_mfma_f32_16x16x32_bf16 v[56:59], v[40:43], v[192:195], v[56:59]
    v_mul_f32 v13, v69, v13
    v_mul_f32 v14, v70, v14
    ds_read_b64_tr_b16 v[32:33], v3 offset:40960
    v_mfma_f32_16x16x32_bf16 v[56:59], v[44:47], v[196:199], v[56:59]
    v_mul_f32 v15, v71, v15
    v_exp_f32 v12, v12
    ds_read_b64_tr_b16 v[34:35], v3 offset:41216
    v_mfma_f32_16x16x32_bf16 v[60:63], v[40:43], v[200:203], v[60:63]
    v_exp_f32 v13, v13
    ds_read_b64_tr_b16 v[36:37], v4 offset:40960
    v_mfma_f32_16x16x32_bf16 v[60:63], v[44:47], v[204:207], v[60:63]
    v_exp_f32 v14, v14
    ds_read_b64_tr_b16 v[38:39], v4 offset:41216
    s_barrier
    s_setprio 3
    s_waitcnt lgkmcnt(4)
    v_mfma_f32_16x16x32_bf16 v[48:51], v[24:27], v[208:211], v[48:51]
    v_exp_f32 v15, v15
    v_fma_f32 v12, v12, v21, v21
    s_add_u32 m0, s42, 24576
    ds_read_b64_tr_b16 v[40:41], v1 offset:49152
    buffer_load_dwordx4 v5, s[8:11], s48 offen lds
    v_mfma_f32_16x16x32_bf16 v[48:51], v[28:31], v[212:215], v[48:51]
    v_fma_f32 v13, v13, v21, v21
    v_fma_f32 v14, v14, v21, v21
    ds_read_b64_tr_b16 v[42:43], v1 offset:49408
    v_mfma_f32_16x16x32_bf16 v[52:55], v[24:27], v[216:219], v[52:55]
    v_fma_f32 v15, v15, v21, v21
    v_rcp_f32 v12, v12
    ds_read_b64_tr_b16 v[44:45], v2 offset:49152
    v_mfma_f32_16x16x32_bf16 v[52:55], v[28:31], v[220:223], v[52:55]
    v_rcp_f32 v13, v13
    ds_read_b64_tr_b16 v[46:47], v2 offset:49408
    v_mfma_f32_16x16x32_bf16 v[92:95], v[88:91], v[24:27], v[92:95]
    v_rcp_f32 v14, v14
    s_waitcnt lgkmcnt(4)
    v_mfma_f32_16x16x32_bf16 v[56:59], v[32:35], v[208:211], v[56:59]
    v_rcp_f32 v15, v15
    v_mul_f32 v68, v68, v12
    ds_read_b64_tr_b16 v[24:25], v3 offset:49152
    v_mfma_f32_16x16x32_bf16 v[56:59], v[36:39], v[212:215], v[56:59]
    v_mul_f32 v69, v69, v13
    v_mul_f32 v70, v70, v14
    ds_read_b64_tr_b16 v[26:27], v3 offset:49408
    v_mfma_f32_16x16x32_bf16 v[60:63], v[32:35], v[216:219], v[60:63]
    v_mul_f32 v71, v71, v15
    v_cvt_pk_bf16_f32 v84, v68, v69
    v_cvt_pk_bf16_f32 v85, v70, v71
    s_add_u32 m0, s42, 32768
    ds_read_b64_tr_b16 v[28:29], v4 offset:49152
    buffer_load_dwordx4 v5, s[8:11], s49 offen lds
    v_mfma_f32_16x16x32_bf16 v[60:63], v[36:39], v[220:223], v[60:63]
    v_mul_f32 v12, v76, v76
    v_mul_f32 v13, v77, v77
    ds_read_b64_tr_b16 v[30:31], v4 offset:49408
    s_setprio 2
    s_waitcnt lgkmcnt(4)
    v_mfma_f32_16x16x32_bf16 v[48:51], v[40:43], v[224:227], v[48:51]
    v_mul_f32 v14, v78, v78
    v_mul_f32 v15, v79, v79
    v_fma_f32 v12, v12, v20, v19
    ds_read_b64_tr_b16 v[32:33], v1 offset:57344
    v_mfma_f32_16x16x32_bf16 v[48:51], v[44:47], v[228:231], v[48:51]
    v_fma_f32 v13, v13, v20, v19
    v_fma_f32 v14, v14, v20, v19
    ds_read_b64_tr_b16 v[34:35], v1 offset:57600
    v_mfma_f32_16x16x32_bf16 v[52:55], v[40:43], v[232:235], v[52:55]
    v_fma_f32 v15, v15, v20, v19
    v_mul_f32 v12, v76, v12
    v_mul_f32 v13, v77, v13
    ds_read_b64_tr_b16 v[36:37], v2 offset:57344
    v_mfma_f32_16x16x32_bf16 v[52:55], v[44:47], v[236:239], v[52:55]
    v_mul_f32 v14, v78, v14
    v_mul_f32 v15, v79, v15
    ds_read_b64_tr_b16 v[38:39], v2 offset:57600
    v_mfma_f32_16x16x32_bf16 v[92:95], v[88:91], v[40:43], v[92:95]
    v_exp_f32 v12, v12
    s_setprio 1
    s_waitcnt lgkmcnt(4)
    v_mfma_f32_16x16x32_bf16 v[56:59], v[24:27], v[224:227], v[56:59]
    v_exp_f32 v13, v13
    s_add_u32 m0, s42, 40960
    ds_read_b64_tr_b16 v[40:41], v3 offset:57344
    buffer_load_dwordx4 v5, s[8:11], s50 offen lds
    v_mfma_f32_16x16x32_bf16 v[56:59], v[28:31], v[228:231], v[56:59]
    v_exp_f32 v14, v14
    ds_read_b64_tr_b16 v[42:43], v3 offset:57600
    v_mfma_f32_16x16x32_bf16 v[60:63], v[24:27], v[232:235], v[60:63]
    v_exp_f32 v15, v15
    v_fma_f32 v12, v12, v21, v21
    ds_read_b64_tr_b16 v[44:45], v4 offset:57344
    v_mfma_f32_16x16x32_bf16 v[60:63], v[28:31], v[236:239], v[60:63]
    v_fma_f32 v13, v13, v21, v21
    v_fma_f32 v14, v14, v21, v21
    v_fma_f32 v15, v15, v21, v21
    ds_read_b64_tr_b16 v[46:47], v4 offset:57600
    s_waitcnt lgkmcnt(4)
    v_mfma_f32_16x16x32_bf16 v[48:51], v[32:35], v[240:243], v[48:51]
    v_rcp_f32 v12, v12
    v_add_u32 v1, 0x10000, v1
    ds_read_b64_tr_b16 v[24:25], v1 offset:0
    v_mfma_f32_16x16x32_bf16 v[48:51], v[36:39], v[244:247], v[48:51]
    v_rcp_f32 v13, v13
    ds_read_b64_tr_b16 v[26:27], v1 offset:256
    v_mfma_f32_16x16x32_bf16 v[52:55], v[32:35], v[248:251], v[52:55]
    v_rcp_f32 v14, v14
    v_add_u32 v2, 0x10000, v2
    ds_read_b64_tr_b16 v[28:29], v2 offset:0
    v_mfma_f32_16x16x32_bf16 v[52:55], v[36:39], v[252:255], v[52:55]
    v_rcp_f32 v15, v15
    v_mul_f32 v76, v76, v12
    ds_read_b64_tr_b16 v[30:31], v2 offset:256
    v_mfma_f32_16x16x32_bf16 v[92:95], v[88:91], v[32:35], v[92:95]
    v_mul_f32 v77, v77, v13
    v_mul_f32 v78, v78, v14
    v_mul_f32 v79, v79, v15
    s_setprio 0
    s_waitcnt lgkmcnt(4)
    v_mfma_f32_16x16x32_bf16 v[56:59], v[40:43], v[240:243], v[56:59]
    v_cvt_pk_bf16_f32 v86, v76, v77
    v_cvt_pk_bf16_f32 v87, v78, v79
    s_cbranch_vccz LB_sw15
    v_swap_b32 v84, v86
    v_swap_b32 v85, v87
LB_sw15:
    s_add_u32 s63, s65, 17408
    buffer_store_dwordx4 v[84:87], v100, s[16:19], s63 offen sc1
    v_add_u32 v3, 0x10000, v3
    ds_read_b64_tr_b16 v[32:33], v3 offset:0
    v_mfma_f32_16x16x32_bf16 v[56:59], v[44:47], v[244:247], v[56:59]
    ds_read_b64_tr_b16 v[34:35], v3 offset:256
    v_mfma_f32_16x16x32_bf16 v[60:63], v[40:43], v[248:251], v[60:63]
    v_add_u32 v4, 0x10000, v4
    ds_read_b64_tr_b16 v[36:37], v4 offset:0
    v_mfma_f32_16x16x32_bf16 v[60:63], v[44:47], v[252:255], v[60:63]
    ds_read_b64_tr_b16 v[38:39], v4 offset:256
    v_and_b32 v99, 15, v0
    v_lshl_add_u32 v99, v99, 4, s66
    ds_write_b32 v99, v92 offset:0
    s_waitcnt lgkmcnt(0)
    s_barrier
    s_setprio 3
    v_mfma_f32_16x16x32_bf16 v[64:67], v[24:27], v[112:115], 0
    v_and_b32 v96, 15, v0
    v_lshl_add_u32 v22, v96, 4, s67
    ds_read_b64 v[12:13], v22 offset:0
    v_xor_b32 v22, 8, v22
    ds_read_b64 v[14:15], v22 offset:0
    s_add_u32 m0, s42, 49152
    v_add_u32 v1, 0x14000, v1
    ds_read_b64_tr_b16 v[40:41], v1 offset:0
    buffer_load_dwordx4 v5, s[8:11], s51 offen lds
    v_mfma_f32_16x16x32_bf16 v[64:67], v[28:31], v[116:119], v[64:67]
    v_lshl_add_u32 v96, v96, 1, s79
    ds_read_u16 v22, v96 offset:256
    ds_read_b64_tr_b16 v[42:43], v1 offset:256
    v_mfma_f32_16x16x32_bf16 v[68:71], v[24:27], v[120:123], 0
    v_xor_b32 v96, 32, v96
    ds_read_u16 v96, v96 offset:256
    v_add_u32 v2, 0x14000, v2
    ds_read_b64_tr_b16 v[44:45], v2 offset:0
    v_mfma_f32_16x16x32_bf16 v[68:71], v[28:31], v[124:127], v[68:71]
    ds_read_b64_tr_b16 v[46:47], v2 offset:256
    v_mfma_f32_16x16x32_bf16 v[92:95], v[88:91], v[24:27], 0
    v_mfma_f32_16x16x32_bf16 v[72:75], v[32:35], v[112:115], 0
    v_add_u32 v3, 0x14000, v3
    ds_read_b64_tr_b16 v[24:25], v3 offset:0
    v_mfma_f32_16x16x32_bf16 v[72:75], v[36:39], v[116:119], v[72:75]
    s_waitcnt lgkmcnt(8)
    v_add_f32 v12, v12, v13
    s_waitcnt lgkmcnt(7)
    v_add_f32 v14, v14, v15
    s_waitcnt lgkmcnt(5)
    v_lshlrev_b32 v22, 16, v22
    ds_read_b64_tr_b16 v[26:27], v3 offset:256
    v_mfma_f32_16x16x32_bf16 v[76:79], v[32:35], v[120:123], 0
    s_waitcnt lgkmcnt(4)
    v_lshlrev_b32 v96, 16, v96
    v_cvt_pk_bf16_f32 v23, v12, v22
    s_add_u32 m0, s42, 57344
    v_add_u32 v4, 0x14000, v4
    ds_read_b64_tr_b16 v[28:29], v4 offset:0
    buffer_load_dwordx4 v5, s[8:11], s52 offen lds
    v_mfma_f32_16x16x32_bf16 v[76:79], v[36:39], v[124:127], v[76:79]
    v_cvt_pk_bf16_f32 v97, v14, v96
    v_lshlrev_b32 v13, 16, v23
    s_add_u32 s56, s68, s80
    ds_read_b64_tr_b16 v[30:31], v4 offset:256
    s_setprio 2
    s_waitcnt lgkmcnt(4)
    v_mfma_f32_16x16x32_bf16 v[64:67], v[40:43], v[128:131], v[64:67]
    v_lshlrev_b32 v15, 16, v97
    v_sub_f32 v12, v12, v13
    s_add_u32 s56, s56, 221184
    v_add_u32 v1, 0xfffee000, v1
    ds_read_b64_tr_b16 v[32:33], v1 offset:0
    v_mfma_f32_16x16x32_bf16 v[64:67], v[44:47], v[132:135], v[64:67]
    v_sub_f32 v14, v14, v15
    v_cvt_pk_bf16_f32 v22, v13, v12
    ds_read_b64_tr_b16 v[34:35], v1 offset:256
    v_mfma_f32_16x16x32_bf16 v[68:71], v[40:43], v[136:139], v[68:71]
    v_cvt_pk_bf16_f32 v96, v15, v14
    v_add_u32 v2, 0xfffee000, v2
    ds_read_b64_tr_b16 v[36:37], v2 offset:0
    v_mfma_f32_16x16x32_bf16 v[68:71], v[44:47], v[140:143], v[68:71]
    v_mfma_f32_16x16x16_bf16 v[48:51], v[22:23], v[8:9], v[48:51]
    v_mfma_f32_16x16x16_bf16 v[52:55], v[22:23], v[10:11], v[52:55]
    v_mfma_f32_16x16x16_bf16 v[56:59], v[96:97], v[8:9], v[56:59]
    ds_read_b64_tr_b16 v[38:39], v2 offset:256
    v_mfma_f32_16x16x32_bf16 v[92:95], v[88:91], v[40:43], v[92:95]
    v_mfma_f32_16x16x16_bf16 v[60:63], v[96:97], v[10:11], v[60:63]
    s_setprio 1
    s_waitcnt lgkmcnt(4)
    v_mfma_f32_16x16x32_bf16 v[72:75], v[24:27], v[128:131], v[72:75]
    s_add_u32 m0, s42, 65536
    v_add_u32 v3, 0xfffee000, v3
    ds_read_b64_tr_b16 v[40:41], v3 offset:0
    buffer_load_dwordx4 v6, s[12:15], s56 offen lds
    v_mfma_f32_16x16x32_bf16 v[72:75], v[28:31], v[132:135], v[72:75]
    v_mul_f32 v12, v48, v48
    v_mul_f32 v13, v49, v49
    v_mul_f32 v14, v50, v50
    ds_read_b64_tr_b16 v[42:43], v3 offset:256
    v_mfma_f32_16x16x32_bf16 v[76:79], v[24:27], v[136:139], v[76:79]
    v_mul_f32 v15, v51, v51
    v_fma_f32 v12, v12, v17, v16
    v_add_u32 v4, 0xfffee000, v4
    ds_read_b64_tr_b16 v[44:45], v4 offset:0
    v_mfma_f32_16x16x32_bf16 v[76:79], v[28:31], v[140:143], v[76:79]
    v_fma_f32 v13, v13, v17, v16
    v_fma_f32 v14, v14, v17, v16
    ds_read_b64_tr_b16 v[46:47], v4 offset:256
    s_waitcnt lgkmcnt(4)
    v_mfma_f32_16x16x32_bf16 v[64:67], v[32:35], v[144:147], v[64:67]
    v_fma_f32 v15, v15, v17, v16
    v_mul_f32 v12, v48, v12
    ds_read_b64_tr_b16 v[24:25], v1 offset:8192
    v_mfma_f32_16x16x32_bf16 v[64:67], v[36:39], v[148:151], v[64:67]
    v_mul_f32 v13, v49, v13
    v_mul_f32 v14, v50, v14
    v_mul_f32 v15, v51, v15
    ds_read_b64_tr_b16 v[26:27], v1 offset:8448
    v_mfma_f32_16x16x32_bf16 v[68:71], v[32:35], v[152:155], v[68:71]
    v_exp_f32 v12, v12
    ds_read_b64_tr_b16 v[28:29], v2 offset:8192
    v_mfma_f32_16x16x32_bf16 v[68:71], v[36:39], v[156:159], v[68:71]
    v_exp_f32 v13, v13
    ds_read_b64_tr_b16 v[30:31], v2 offset:8448
    v_mfma_f32_16x16x32_bf16 v[92:95], v[88:91], v[32:35], v[92:95]
    v_exp_f32 v14, v14
    s_setprio 0
    s_waitcnt lgkmcnt(4)
    v_mfma_f32_16x16x32_bf16 v[72:75], v[40:43], v[144:147], v[72:75]
    v_exp_f32 v15, v15
    v_fma_f32 v12, v12, v18, v18
    ds_read_b64_tr_b16 v[32:33], v3 offset:8192
    v_mfma_f32_16x16x32_bf16 v[72:75], v[44:47], v[148:151], v[72:75]
    v_fma_f32 v13, v13, v18, v18
    v_fma_f32 v14, v14, v18, v18
    ds_read_b64_tr_b16 v[34:35], v3 offset:8448
    v_mfma_f32_16x16x32_bf16 v[76:79], v[40:43], v[152:155], v[76:79]
    v_fma_f32 v15, v15, v18, v18
    v_rcp_f32 v12, v12
    ds_read_b64_tr_b16 v[36:37], v4 offset:8192
    v_mfma_f32_16x16x32_bf16 v[76:79], v[44:47], v[156:159], v[76:79]
    v_rcp_f32 v13, v13
    ds_read_b64_tr_b16 v[38:39], v4 offset:8448
    s_waitcnt vmcnt(12)
    s_waitcnt vmcnt(3)
    s_barrier
    s_cmp_eq_u32 s36, 0
    s_cbranch_scc0 LB_dw16
    s_add_u32 s63, s96, 2
    v_mov_b32 v98, s63
    v_mov_b32 v99, s97
    s_mul_i32 s62, s41, 120
    s_sub_u32 s62, s2, s62
    s_lshl_b32 s63, s41, 3
    s_lshl_b32 s63, 1, s63
    s_andn2_b32 exec_lo, 0x01010101, s63
    s_mov_b32 exec_hi, 0
    buffer_store_dwordx2 v[98:99], v100, s[16:19], s62 offen sc1
    s_mov_b64 exec, -1
LB_dw16:
    s_setprio 3
    s_waitcnt lgkmcnt(4)
    v_mfma_f32_16x16x32_bf16 v[64:67], v[24:27], v[160:163], v[64:67]
    v_rcp_f32 v14, v14
    s_add_u32 s56, s68, s80
    ds_read_b64_tr_b16 v[40:41], v1 offset:16384
    v_mfma_f32_16x16x32_bf16 v[64:67], v[28:31], v[164:167], v[64:67]
    v_rcp_f32 v15, v15
    v_mul_f32 v48, v48, v12
    s_add_u32 m0, s42, 73728
    ds_read_b64_tr_b16 v[42:43], v1 offset:16640
    buffer_load_dwordx4 v6, s[12:15], s56 offen lds
    v_mfma_f32_16x16x32_bf16 v[68:71], v[24:27], v[168:171], v[68:71]
    v_mul_f32 v49, v49, v13
    v_mul_f32 v50, v50, v14
    s_add_u32 s56, s68, 221184
    ds_read_b64_tr_b16 v[44:45], v2 offset:16384
    v_mfma_f32_16x16x32_bf16 v[68:71], v[28:31], v[172:175], v[68:71]
    v_mul_f32 v51, v51, v15
    v_cvt_pk_bf16_f32 v80, v48, v49
    v_cvt_pk_bf16_f32 v81, v50, v51
    s_add_u32 s57, s68, 0
    ds_read_b64_tr_b16 v[46:47], v2 offset:16640
    v_mfma_f32_16x16x32_bf16 v[92:95], v[88:91], v[24:27], v[92:95]
    v_mul_f32 v12, v56, v56
    v_mul_f32 v13, v57, v57
    s_cmp_ge_u32 s37, 2
    s_cselect_b32 s56, s57, s56
    s_waitcnt lgkmcnt(4)
    v_mfma_f32_16x16x32_bf16 v[72:75], v[32:35], v[160:163], v[72:75]
    v_mul_f32 v14, v58, v58
    v_mul_f32 v15, v59, v59
    v_fma_f32 v12, v12, v17, v16
    s_add_u32 s56, s56, s81
    ds_read_b64_tr_b16 v[24:25], v3 offset:16384
    v_mfma_f32_16x16x32_bf16 v[72:75], v[36:39], v[164:167], v[72:75]
    v_fma_f32 v13, v13, v17, v16
    v_fma_f32 v14, v14, v17, v16
    ds_read_b64_tr_b16 v[26:27], v3 offset:16640
    v_mfma_f32_16x16x32_bf16 v[76:79], v[32:35], v[168:171], v[76:79]
    v_fma_f32 v15, v15, v17, v16
    v_mul_f32 v12, v56, v12
    v_mul_f32 v13, v57, v13
    ds_read_b64_tr_b16 v[28:29], v4 offset:16384
    v_mfma_f32_16x16x32_bf16 v[76:79], v[36:39], v[172:175], v[76:79]
    v_mul_f32 v14, v58, v14
    v_mul_f32 v15, v59, v15
    s_add_u32 m0, s42, 155648
    ds_read_b64_tr_b16 v[30:31], v4 offset:16640
    buffer_load_dwordx4 v7, s[12:15], s56 offen lds
    s_setprio 2
    s_waitcnt lgkmcnt(4)
    v_mfma_f32_16x16x32_bf16 v[64:67], v[40:43], v[176:179], v[64:67]
    v_exp_f32 v12, v12
    s_add_u32 s56, s69, s80
    ds_read_b64_tr_b16 v[32:33], v1 offset:24576
    v_mfma_f32_16x16x32_bf16 v[64:67], v[44:47], v[180:183], v[64:67]
    v_exp_f32 v13, v13
    ds_read_b64_tr_b16 v[34:35], v1 offset:24832
    v_mfma_f32_16x16x32_bf16 v[68:71], v[40:43], v[184:187], v[68:71]
    v_exp_f32 v14, v14
    ds_read_b64_tr_b16 v[36:37], v2 offset:24576
    v_mfma_f32_16x16x32_bf16 v[68:71], v[44:47], v[188:191], v[68:71]
    v_exp_f32 v15, v15
    v_fma_f32 v12, v12, v18, v18
    ds_read_b64_tr_b16 v[38:39], v2 offset:24832
    v_mfma_f32_16x16x32_bf16 v[92:95], v[88:91], v[40:43], v[92:95]
    v_fma_f32 v13, v13, v18, v18
    v_fma_f32 v14, v14, v18, v18
    v_fma_f32 v15, v15, v18, v18
    s_setprio 1
    s_waitcnt lgkmcnt(4)
    v_mfma_f32_16x16x32_bf16 v[72:75], v[24:27], v[176:179], v[72:75]
    v_rcp_f32 v12, v12
    ds_read_b64_tr_b16 v[40:41], v3 offset:24576
    v_mfma_f32_16x16x32_bf16 v[72:75], v[28:31], v[180:183], v[72:75]
    v_rcp_f32 v13, v13
    s_add_u32 m0, s42, 81920
    ds_read_b64_tr_b16 v[42:43], v3 offset:24832
    buffer_load_dwordx4 v6, s[12:15], s56 offen lds
    v_mfma_f32_16x16x32_bf16 v[76:79], v[24:27], v[184:187], v[76:79]
    v_rcp_f32 v14, v14
    ds_read_b64_tr_b16 v[44:45], v4 offset:24576
    v_mfma_f32_16x16x32_bf16 v[76:79], v[28:31], v[188:191], v[76:79]
    v_rcp_f32 v15, v15
    v_mul_f32 v56, v56, v12
    ds_read_b64_tr_b16 v[46:47], v4 offset:24832
    s_waitcnt lgkmcnt(4)
    v_mfma_f32_16x16x32_bf16 v[64:67], v[32:35], v[192:195], v[64:67]
    v_mul_f32 v57, v57, v13
    v_mul_f32 v58, v58, v14
    v_mul_f32 v59, v59, v15
    ds_read_b64_tr_b16 v[24:25], v1 offset:32768
    v_mfma_f32_16x16x32_bf16 v[64:67], v[36:39], v[196:199], v[64:67]
    v_cvt_pk_bf16_f32 v82, v56, v57
    v_cvt_pk_bf16_f32 v83, v58, v59
    ds_read_b64_tr_b16 v[26:27], v1 offset:33024
    v_mfma_f32_16x16x32_bf16 v[68:71], v[32:35], v[200:203], v[68:71]
    s_cbranch_vccz LB_sw17
    v_swap_b32 v80, v82
    v_swap_b32 v81, v83
LB_sw17:
    s_add_u32 s63, s65, 32768
    buffer_store_dwordx4 v[80:83], v100, s[16:19], s63 offen sc1
    v_mul_f32 v12, v52, v52
    v_mul_f32 v13, v53, v53
    ds_read_b64_tr_b16 v[28:29], v2 offset:32768
    v_mfma_f32_16x16x32_bf16 v[68:71], v[36:39], v[204:207], v[68:71]
    v_mul_f32 v14, v54, v54
    v_mul_f32 v15, v55, v55
    ds_read_b64_tr_b16 v[30:31], v2 offset:33024
    v_mfma_f32_16x16x32_bf16 v[92:95], v[88:91], v[32:35], v[92:95]
    v_fma_f32 v12, v12, v20, v19
    v_fma_f32 v13, v13, v20, v19
    v_fma_f32 v14, v14, v20, v19
    s_setprio 0
    s_waitcnt lgkmcnt(4)
    v_mfma_f32_16x16x32_bf16 v[72:75], v[40:43], v[192:195], v[72:75]
    v_fma_f32 v15, v15, v20, v19
    v_mul_f32 v12, v52, v12
    ds_read_b64_tr_b16 v[32:33], v3 offset:32768
    v_mfma_f32_16x16x32_bf16 v[72:75], v[44:47], v[196:199], v[72:75]
    v_mul_f32 v13, v53, v13
    v_mul_f32 v14, v54, v14
    v_mul_f32 v15, v55, v15
    ds_read_b64_tr_b16 v[34:35], v3 offset:33024
    v_mfma_f32_16x16x32_bf16 v[76:79], v[40:43], v[200:203], v[76:79]
    v_exp_f32 v12, v12
    ds_read_b64_tr_b16 v[36:37], v4 offset:32768
    v_mfma_f32_16x16x32_bf16 v[76:79], v[44:47], v[204:207], v[76:79]
    v_exp_f32 v13, v13
    ds_read_b64_tr_b16 v[38:39], v4 offset:33024
    s_barrier
    s_setprio 3
    s_waitcnt lgkmcnt(4)
    v_mfma_f32_16x16x32_bf16 v[64:67], v[24:27], v[208:211], v[64:67]
    v_exp_f32 v14, v14
    s_add_u32 s56, s70, s80
    ds_read_b64_tr_b16 v[40:41], v1 offset:40960
    v_mfma_f32_16x16x32_bf16 v[64:67], v[28:31], v[212:215], v[64:67]
    v_exp_f32 v15, v15
    v_fma_f32 v12, v12, v21, v21
    s_add_u32 m0, s42, 90112
    ds_read_b64_tr_b16 v[42:43], v1 offset:41216
    buffer_load_dwordx4 v6, s[12:15], s56 offen lds
    v_mfma_f32_16x16x32_bf16 v[68:71], v[24:27], v[216:219], v[68:71]
    v_fma_f32 v13, v13, v21, v21
    v_fma_f32 v14, v14, v21, v21
    v_fma_f32 v15, v15, v21, v21
    s_add_u32 s56, s69, 0
    ds_read_b64_tr_b16 v[44:45], v2 offset:40960
    v_mfma_f32_16x16x32_bf16 v[68:71], v[28:31], v[220:223], v[68:71]
    v_rcp_f32 v12, v12
    s_add_u32 s57, s70, 0
    ds_read_b64_tr_b16 v[46:47], v2 offset:41216
    v_mfma_f32_16x16x32_bf16 v[92:95], v[88:91], v[24:27], v[92:95]
    v_rcp_f32 v13, v13
    s_cmp_ge_u32 s37, 2
    s_cselect_b32 s56, s57, s56
    s_waitcnt lgkmcnt(4)
    v_mfma_f32_16x16x32_bf16 v[72:75], v[32:35], v[208:211], v[72:75]
    v_rcp_f32 v14, v14
    s_add_u32 s56, s56, s81
    ds_read_b64_tr_b16 v[24:25], v3 offset:40960
    v_mfma_f32_16x16x32_bf16 v[72:75], v[36:39], v[212:215], v[72:75]
    v_rcp_f32 v15, v15
    v_mul_f32 v52, v52, v12
    ds_read_b64_tr_b16 v[26:27], v3 offset:41216
    v_mfma_f32_16x16x32_bf16 v[76:79], v[32:35], v[216:219], v[76:79]
    v_mul_f32 v53, v53, v13
    v_mul_f32 v54, v54, v14
    v_mul_f32 v55, v55, v15
    ds_read_b64_tr_b16 v[28:29], v4 offset:40960
    v_mfma_f32_16x16x32_bf16 v[76:79], v[36:39], v[220:223], v[76:79]
    v_cvt_pk_bf16_f32 v84, v52, v53
    v_cvt_pk_bf16_f32 v85, v54, v55
    s_add_u32 m0, s42, 98304
    ds_read_b64_tr_b16 v[30:31], v4 offset:41216
    buffer_load_dwordx4 v7, s[12:15], s56 offen lds
    s_setprio 2
    s_waitcnt lgkmcnt(4)
    v_mfma_f32_16x16x32_bf16 v[64:67], v[40:43], v[224:227], v[64:67]
    v_mul_f32 v12, v60, v60
    v_mul_f32 v13, v61, v61
    v_mul_f32 v14, v62, v62
    s_add_u32 s56, s71, s80
    ds_read_b64_tr_b16 v[32:33], v1 offset:49152
    v_mfma_f32_16x16x32_bf16 v[64:67], v[44:47], v[228:231], v[64:67]
    v_mul_f32 v15, v63, v63
    v_fma_f32 v12, v12, v20, v19
    ds_read_b64_tr_b16 v[34:35], v1 offset:49408
    v_mfma_f32_16x16x32_bf16 v[68:71], v[40:43], v[232:235], v[68:71]
    v_fma_f32 v13, v13, v20, v19
    v_fma_f32 v14, v14, v20, v19
    v_fma_f32 v15, v15, v20, v19
    ds_read_b64_tr_b16 v[36:37], v2 offset:49152
    v_mfma_f32_16x16x32_bf16 v[68:71], v[44:47], v[236:239], v[68:71]
    v_mul_f32 v12, v60, v12
    v_mul_f32 v13, v61, v13
    v_mul_f32 v14, v62, v14
    ds_read_b64_tr_b16 v[38:39], v2 offset:49408
    v_mfma_f32_16x16x32_bf16 v[92:95], v[88:91], v[40:43], v[92:95]
    v_mul_f32 v15, v63, v15
    s_setprio 1
    s_waitcnt lgkmcnt(4)
    v_mfma_f32_16x16x32_bf16 v[72:75], v[24:27], v[224:227], v[72:75]
    v_exp_f32 v12, v12
    ds_read_b64_tr_b16 v[40:41], v3 offset:49152
    v_mfma_f32_16x16x32_bf16 v[72:75], v[28:31], v[228:231], v[72:75]
    v_exp_f32 v13, v13
    s_add_u32 m0, s42, 106496
    ds_read_b64_tr_b16 v[42:43], v3 offset:49408
    buffer_load_dwordx4 v6, s[12:15], s56 offen lds
    v_mfma_f32_16x16x32_bf16 v[76:79], v[24:27], v[232:235], v[76:79]
    v_exp_f32 v14, v14
    ds_read_b64_tr_b16 v[44:45], v4 offset:49152
    v_mfma_f32_16x16x32_bf16 v[76:79], v[28:31], v[236:239], v[76:79]
    v_exp_f32 v15, v15
    v_fma_f32 v12, v12, v21, v21
    v_fma_f32 v13, v13, v21, v21
    ds_read_b64_tr_b16 v[46:47], v4 offset:49408
    s_waitcnt lgkmcnt(4)
    v_mfma_f32_16x16x32_bf16 v[64:67], v[32:35], v[240:243], v[64:67]
    v_fma_f32 v14, v14, v21, v21
    v_fma_f32 v15, v15, v21, v21
    ds_read_b64_tr_b16 v[24:25], v1 offset:57344
    v_mfma_f32_16x16x32_bf16 v[64:67], v[36:39], v[244:247], v[64:67]
    v_rcp_f32 v12, v12
    ds_read_b64_tr_b16 v[26:27], v1 offset:57600
    v_mfma_f32_16x16x32_bf16 v[68:71], v[32:35], v[248:251], v[68:71]
    v_rcp_f32 v13, v13
    v_rcp_f32 v14, v14
    ds_read_b64_tr_b16 v[28:29], v2 offset:57344
    v_mfma_f32_16x16x32_bf16 v[68:71], v[36:39], v[252:255], v[68:71]
    v_rcp_f32 v15, v15
    v_mul_f32 v60, v60, v12
    ds_read_b64_tr_b16 v[30:31], v2 offset:57600
    v_mfma_f32_16x16x32_bf16 v[92:95], v[88:91], v[32:35], v[92:95]
    v_mul_f32 v61, v61, v13
    v_mul_f32 v62, v62, v14
    v_mul_f32 v63, v63, v15
    s_setprio 0
    s_waitcnt lgkmcnt(4)
    v_mfma_f32_16x16x32_bf16 v[72:75], v[40:43], v[240:243], v[72:75]
    v_cvt_pk_bf16_f32 v86, v60, v61
    v_cvt_pk_bf16_f32 v87, v62, v63
    s_cbranch_vccz LB_sw18
    v_swap_b32 v84, v86
    v_swap_b32 v85, v87
LB_sw18:
    s_add_u32 s63, s65, 33792
    buffer_store_dwordx4 v[84:87], v100, s[16:19], s63 offen sc1
    ds_read_b64_tr_b16 v[32:33], v3 offset:57344
    v_mfma_f32_16x16x32_bf16 v[72:75], v[44:47], v[244:247], v[72:75]
    ds_read_b64_tr_b16 v[34:35], v3 offset:57600
    v_mfma_f32_16x16x32_bf16 v[76:79], v[40:43], v[248:251], v[76:79]
    ds_read_b64_tr_b16 v[36:37], v4 offset:57344
    v_mfma_f32_16x16x32_bf16 v[76:79], v[44:47], v[252:255], v[76:79]
    ds_read_b64_tr_b16 v[38:39], v4 offset:57600
    v_and_b32 v99, 15, v0
    v_lshl_add_u32 v99, v99, 4, s66
    ds_write_b32 v99, v92 offset:512
    s_waitcnt lgkmcnt(0)
    s_barrier
    s_setprio 3
    v_mfma_f32_16x16x32_bf16 v[48:51], v[24:27], v[112:115], 0
    s_cmp_eq_u32 s36, 0
    s_cbranch_scc0 LB_dw19
    v_and_b32 v104, 3, v0
    v_lshlrev_b32 v104, 3, v104
    buffer_load_dwordx2 v[104:105], v104, s[16:19], s2 offen sc1
LB_dw19:
    v_bfe_u32 v106, v0, 2, 3
    s_add_u32 s56, s68, s80
    v_add_u32 v1, 0x10000, v1
    ds_read_b64_tr_b16 v[40:41], v1 offset:0
    v_mfma_f32_16x16x32_bf16 v[48:51], v[28:31], v[116:119], v[48:51]
    v_lshlrev_b32 v106, 6, v106
    v_and_b32 v107, 3, v0
    s_add_u32 s56, s56, 73728
    ds_read_b64_tr_b16 v[42:43], v1 offset:256
    v_mfma_f32_16x16x32_bf16 v[52:55], v[24:27], v[120:123], 0
    v_lshl_add_u32 v106, v107, 3, v106
    v_bfe_u32 v107, v0, 4, 1
    v_xor_b32 v107, s38, v107
    s_add_u32 m0, s42, 114688
    v_add_u32 v2, 0x10000, v2
    ds_read_b64_tr_b16 v[44:45], v2 offset:0
    buffer_load_dwordx4 v6, s[12:15], s56 offen lds
    v_mfma_f32_16x16x32_bf16 v[52:55], v[28:31], v[124:127], v[52:55]
    v_lshl_add_u32 v106, v107, 5, v106
    s_add_u32 s56, s71, 0
    ds_read_b64_tr_b16 v[46:47], v2 offset:256
    v_mfma_f32_16x16x32_bf16 v[92:95], v[88:91], v[24:27], 0
    v_lshl_add_u32 v106, s38, 12, v106
    v_lshrrev_b32 v107, 5, v0
    v_lshl_add_u32 v5, v107, 10, v106
    s_add_u32 s57, s68, 73728
    v_mfma_f32_16x16x32_bf16 v[56:59], v[32:35], v[112:115], 0
    v_lshl_add_u32 v102, v107, 9, v106
    v_xor_b32 v101, 32, v5
    v_xor_b32 v103, 32, v102
    s_cmp_ge_u32 s37, 2
    s_cselect_b32 s56, s57, s56
    v_add_u32 v3, 0x10000, v3
    ds_read_b64_tr_b16 v[24:25], v3 offset:0
    v_mfma_f32_16x16x32_bf16 v[56:59], v[36:39], v[116:119], v[56:59]
    v_and_b32 v96, 15, v0
    s_add_u32 s56, s56, s81
    ds_read_b64_tr_b16 v[26:27], v3 offset:256
    v_mfma_f32_16x16x32_bf16 v[60:63], v[32:35], v[120:123], 0
    v_lshl_add_u32 v22, v96, 4, s67
    ds_read_b64 v[12:13], v22 offset:512
    v_xor_b32 v22, 8, v22
    ds_read_b64 v[14:15], v22 offset:512
    v_lshl_add_u32 v96, v96, 1, s79
    v_add_u32 v4, 0x10000, v4
    ds_read_b64_tr_b16 v[28:29], v4 offset:0
    v_mfma_f32_16x16x32_bf16 v[60:63], v[36:39], v[124:127], v[60:63]
    ds_read_u16 v22, v96 offset:384
    v_xor_b32 v96, 32, v96
    ds_read_u16 v96, v96 offset:384
    ds_read_b64_tr_b16 v[30:31], v4 offset:256
    s_setprio 2
    s_waitcnt lgkmcnt(8)
    v_mfma_f32_16x16x32_bf16 v[48:51], v[40:43], v[128:131], v[48:51]
    s_add_u32 m0, s42, 122880
    v_add_u32 v1, 0xfffde000, v1
    ds_read_b64_tr_b16 v[32:33], v1 offset:0
    buffer_load_dwordx4 v7, s[12:15], s56 offen lds
    v_mfma_f32_16x16x32_bf16 v[48:51], v[44:47], v[132:135], v[48:51]
    s_add_u32 s56, s69, s80
    ds_read_b64_tr_b16 v[34:35], v1 offset:256
    v_mfma_f32_16x16x32_bf16 v[52:55], v[40:43], v[136:139], v[52:55]
    s_add_u32 s56, s56, 73728
    v_add_u32 v2, 0xfffde000, v2
    ds_read_b64_tr_b16 v[36:37], v2 offset:0
    v_mfma_f32_16x16x32_bf16 v[52:55], v[44:47], v[140:143], v[52:55]
    s_waitcnt lgkmcnt(8)
    v_add_f32 v12, v12, v13
    s_waitcnt lgkmcnt(7)
    v_add_f32 v14, v14, v15
    s_waitcnt lgkmcnt(5)
    v_lshlrev_b32 v22, 16, v22
    ds_read_b64_tr_b16 v[38:39], v2 offset:256
    v_mfma_f32_16x16x32_bf16 v[92:95], v[88:91], v[40:43], v[92:95]
    s_waitcnt lgkmcnt(5)
    v_lshlrev_b32 v96, 16, v96
    v_cvt_pk_bf16_f32 v23, v12, v22
    v_cvt_pk_bf16_f32 v97, v14, v96
    s_setprio 1
    s_waitcnt lgkmcnt(4)
    v_mfma_f32_16x16x32_bf16 v[56:59], v[24:27], v[128:131], v[56:59]
    v_lshlrev_b32 v13, 16, v23
    v_lshlrev_b32 v15, 16, v97
    v_sub_f32 v12, v12, v13
    v_add_u32 v3, 0xfffde000, v3
    ds_read_b64_tr_b16 v[40:41], v3 offset:0
    v_mfma_f32_16x16x32_bf16 v[56:59], v[28:31], v[132:135], v[56:59]
    v_sub_f32 v14, v14, v15
    ds_read_b64_tr_b16 v[42:43], v3 offset:256
    v_mfma_f32_16x16x32_bf16 v[60:63], v[24:27], v[136:139], v[60:63]
    v_cvt_pk_bf16_f32 v22, v13, v12
    v_cvt_pk_bf16_f32 v96, v15, v14
    s_add_u32 m0, s42, 131072
    v_add_u32 v4, 0xfffde000, v4
    ds_read_b64_tr_b16 v[44:45], v4 offset:0
    buffer_load_dwordx4 v6, s[12:15], s56 offen lds
    v_mfma_f32_16x16x32_bf16 v[60:63], v[28:31], v[140:143], v[60:63]
    v_mfma_f32_16x16x16_bf16 v[64:67], v[22:23], v[8:9], v[64:67]
    v_mfma_f32_16x16x16_bf16 v[68:71], v[22:23], v[10:11], v[68:71]
    v_mfma_f32_16x16x16_bf16 v[72:75], v[96:97], v[8:9], v[72:75]
    ds_read_b64_tr_b16 v[46:47], v4 offset:256
    s_waitcnt lgkmcnt(4)
    v_mfma_f32_16x16x32_bf16 v[48:51], v[32:35], v[144:147], v[48:51]
    v_mfma_f32_16x16x16_bf16 v[76:79], v[96:97], v[10:11], v[76:79]
    ds_read_b64_tr_b16 v[24:25], v1 offset:8192
    v_mfma_f32_16x16x32_bf16 v[48:51], v[36:39], v[148:151], v[48:51]
    ds_read_b64_tr_b16 v[26:27], v1 offset:8448
    v_mfma_f32_16x16x32_bf16 v[52:55], v[32:35], v[152:155], v[52:55]
    v_mul_f32 v12, v64, v64
    v_mul_f32 v13, v65, v65
    v_mul_f32 v14, v66, v66
    ds_read_b64_tr_b16 v[28:29], v2 offset:8192
    v_mfma_f32_16x16x32_bf16 v[52:55], v[36:39], v[156:159], v[52:55]
    v_mul_f32 v15, v67, v67
    v_fma_f32 v12, v12, v17, v16
    v_fma_f32 v13, v13, v17, v16
    ds_read_b64_tr_b16 v[30:31], v2 offset:8448
    v_mfma_f32_16x16x32_bf16 v[92:95], v[88:91], v[32:35], v[92:95]
    v_fma_f32 v14, v14, v17, v16
    v_fma_f32 v15, v15, v17, v16
    s_setprio 0
    s_waitcnt lgkmcnt(4)
    v_mfma_f32_16x16x32_bf16 v[56:59], v[40:43], v[144:147], v[56:59]
    v_mul_f32 v12, v64, v12
    v_mul_f32 v13, v65, v13
    v_mul_f32 v14, v66, v14
    ds_read_b64_tr_b16 v[32:33], v3 offset:8192
    v_mfma_f32_16x16x32_bf16 v[56:59], v[44:47], v[148:151], v[56:59]
    v_mul_f32 v15, v67, v15
    v_exp_f32 v12, v12
    ds_read_b64_tr_b16 v[34:35], v3 offset:8448
    v_mfma_f32_16x16x32_bf16 v[60:63], v[40:43], v[152:155], v[60:63]
    v_exp_f32 v13, v13
    ds_read_b64_tr_b16 v[36:37], v4 offset:8192
    v_mfma_f32_16x16x32_bf16 v[60:63], v[44:47], v[156:159], v[60:63]
    v_exp_f32 v14, v14
    ds_read_b64_tr_b16 v[38:39], v4 offset:8448
    s_cmp_eq_u32 s36, 0
    s_cbranch_scc0 LB_dw22
    s_waitcnt vmcnt(3)
    s_add_u32 s62, s96, 1
    v_subrev_u32 v104, s62, v104
    v_cmp_ne_u32 s[58:59], s97, v105
    v_cmp_lt_u32 s[60:61], 14, v104
    s_lshl_b32 s62, 1, s41
    s_andn2_b32 s62, 15, s62
    s_nop 0
    s_or_b32 s60, s60, s58
    s_and_b32 s60, s60, s62
    s_cbranch_scc0 LB_ok20
    s_mov_b32 s78, 200000
LB_sp21:
    s_sleep 1
    v_and_b32 v104, 3, v0
    v_lshlrev_b32 v104, 3, v104
    buffer_load_dwordx2 v[104:105], v104, s[16:19], s2 offen sc1
    s_waitcnt vmcnt(0)
    s_add_u32 s62, s96, 1
    v_subrev_u32 v104, s62, v104
    v_cmp_ne_u32 s[58:59], s97, v105
    v_cmp_lt_u32 s[60:61], 14, v104
    s_lshl_b32 s62, 1, s41
    s_andn2_b32 s62, 15, s62
    s_nop 0
    s_or_b32 s60, s60, s58
    s_and_b32 s60, s60, s62
    s_cbranch_scc0 LB_ok20
    s_sub_u32 s78, s78, 1
    s_cmp_lg_u32 s78, 0
    s_cbranch_scc1 LB_sp21
LB_ok20:
    s_nop 1
LB_dw22:
    s_waitcnt vmcnt(12)
    s_waitcnt vmcnt(3)
    s_barrier
    s_cmp_eq_u32 s36, 0
    s_cbranch_scc0 LB_dw23
    s_add_u32 s63, s96, 3
    v_mov_b32 v98, s63
    v_mov_b32 v99, s97
    s_mul_i32 s62, s41, 120
    s_sub_u32 s62, s2, s62
    s_lshl_b32 s63, s41, 3
    s_lshl_b32 s63, 1, s63
    s_andn2_b32 exec_lo, 0x01010101, s63
    s_mov_b32 exec_hi, 0
    buffer_store_dwordx2 v[98:99], v100, s[16:19], s62 offen sc1
    s_mov_b64 exec, -1
LB_dw23:
    s_setprio 3
    s_waitcnt lgkmcnt(4)
    v_mfma_f32_16x16x32_bf16 v[48:51], v[24:27], v[160:163], v[48:51]
    s_cmp_eq_u32 s36, 0
    s_cbranch_scc0 LB_dw24
    v_and_b32 v108, 3, v0
    v_lshlrev_b32 v108, 3, v108
    buffer_load_dwordx2 v[108:109], v108, s[16:19], s2 offen sc1
LB_dw24:
    s_add_u32 s56, s70, s80
    ds_read_b64_tr_b16 v[40:41], v1 offset:16384
    s_add_u32 s63, s72, 0
    buffer_load_dwordx4 v[112:115], v100, s[16:19], s63 offen offset:0 sc1
    v_mfma_f32_16x16x32_bf16 v[48:51], v[28:31], v[164:167], v[48:51]
    v_exp_f32 v15, v15
    v_fma_f32 v12, v12, v18, v18
    s_add_u32 s56, s56, 73728
    ds_read_b64_tr_b16 v[42:43], v1 offset:16640
    v_mfma_f32_16x16x32_bf16 v[52:55], v[24:27], v[168:171], v[52:55]
    v_fma_f32 v13, v13, v18, v18
    v_fma_f32 v14, v14, v18, v18
    v_fma_f32 v15, v15, v18, v18
    s_add_u32 m0, s42, 139264
    ds_read_b64_tr_b16 v[44:45], v2 offset:16384
    buffer_load_dwordx4 v6, s[12:15], s56 offen lds
    v_mfma_f32_16x16x32_bf16 v[52:55], v[28:31], v[172:175], v[52:55]
    v_rcp_f32 v12, v12
    s_add_u32 s56, s69, 73728
    ds_read_b64_tr_b16 v[46:47], v2 offset:16640
    v_mfma_f32_16x16x32_bf16 v[92:95], v[88:91], v[24:27], v[92:95]
    v_rcp_f32 v13, v13
    s_add_u32 s57, s70, 73728
    s_waitcnt lgkmcnt(4)
    v_mfma_f32_16x16x32_bf16 v[56:59], v[32:35], v[160:163], v[56:59]
    v_rcp_f32 v14, v14
    s_cmp_ge_u32 s37, 2
    s_cselect_b32 s56, s57, s56
    ds_read_b64_tr_b16 v[24:25], v3 offset:16384
    s_add_u32 s63, s72, 0
    buffer_load_dwordx4 v[116:119], v100, s[16:19], s63 offen offset:1024 sc1
    v_mfma_f32_16x16x32_bf16 v[56:59], v[36:39], v[164:167], v[56:59]
    v_rcp_f32 v15, v15
    v_mul_f32 v64, v64, v12
    s_add_u32 s56, s56, s81
    ds_read_b64_tr_b16 v[26:27], v3 offset:16640
    v_mfma_f32_16x16x32_bf16 v[60:63], v[32:35], v[168:171], v[60:63]
    v_mul_f32 v65, v65, v13
    v_mul_f32 v66, v66, v14
    v_mul_f32 v67, v67, v15
    ds_read_b64_tr_b16 v[28:29], v4 offset:16384
    v_mfma_f32_16x16x32_bf16 v[60:63], v[36:39], v[172:175], v[60:63]
    v_cvt_pk_bf16_f32 v80, v64, v65
    v_cvt_pk_bf16_f32 v81, v66, v67
    v_mul_f32 v12, v72, v72
    ds_read_b64_tr_b16 v[30:31], v4 offset:16640
    s_setprio 2
    s_waitcnt lgkmcnt(4)
    v_mfma_f32_16x16x32_bf16 v[48:51], v[40:43], v[176:179], v[48:51]
    v_mul_f32 v13, v73, v73
    v_mul_f32 v14, v74, v74
    v_mul_f32 v15, v75, v75
    ds_read_b64_tr_b16 v[32:33], v1 offset:24576
    v_mfma_f32_16x16x32_bf16 v[48:51], v[44:47], v[180:183], v[48:51]
    v_fma_f32 v12, v12, v17, v16
    v_fma_f32 v13, v13, v17, v16
    s_add_u32 m0, s42, 147456
    ds_read_b64_tr_b16 v[34:35], v1 offset:24832
    buffer_load_dwordx4 v7, s[12:15], s56 offen lds
    v_mfma_f32_16x16x32_bf16 v[52:55], v[40:43], v[184:187], v[52:55]
    v_fma_f32 v14, v14, v17, v16
    v_fma_f32 v15, v15, v17, v16
    v_mul_f32 v12, v72, v12
    s_add_u32 s56, s71, s80
    ds_read_b64_tr_b16 v[36:37], v2 offset:24576
    s_add_u32 s63, s73, 0
    buffer_load_dwordx4 v[120:123], v100, s[16:19], s63 offen offset:0 sc1
    v_mfma_f32_16x16x32_bf16 v[52:55], v[44:47], v[188:191], v[52:55]
    v_mul_f32 v13, v73, v13
    v_mul_f32 v14, v74, v14
    v_mul_f32 v15, v75, v15
    s_add_u32 s56, s56, 73728
    ds_read_b64_tr_b16 v[38:39], v2 offset:24832
    v_mfma_f32_16x16x32_bf16 v[92:95], v[88:91], v[40:43], v[92:95]
    v_exp_f32 v12, v12
    s_setprio 1
    s_waitcnt lgkmcnt(4)
    v_mfma_f32_16x16x32_bf16 v[56:59], v[24:27], v[176:179], v[56:59]
    v_exp_f32 v13, v13
    ds_read_b64_tr_b16 v[40:41], v3 offset:24576
    v_mfma_f32_16x16x32_bf16 v[56:59], v[28:31], v[180:183], v[56:59]
    v_exp_f32 v14, v14
    ds_read_b64_tr_b16 v[42:43], v3 offset:24832
    v_mfma_f32_16x16x32_bf16 v[60:63], v[24:27], v[184:187], v[60:63]
    v_exp_f32 v15, v15
    v_fma_f32 v12, v12, v18, v18
    ds_read_b64_tr_b16 v[44:45], v4 offset:24576
    s_add_u32 s63, s73, 0
    buffer_load_dwordx4 v[124:127], v100, s[16:19], s63 offen offset:1024 sc1
    v_mfma_f32_16x16x32_bf16 v[60:63], v[28:31], v[188:191], v[60:63]
    v_fma_f32 v13, v13, v18, v18
    v_fma_f32 v14, v14, v18, v18
    v_fma_f32 v15, v15, v18, v18
    ds_read_b64_tr_b16 v[46:47], v4 offset:24832
    s_waitcnt lgkmcnt(4)
    v_mfma_f32_16x16x32_bf16 v[48:51], v[32:35], v[192:195], v[48:51]
    v_rcp_f32 v12, v12
    ds_read_b64_tr_b16 v[24:25], v1 offset:32768
    v_mfma_f32_16x16x32_bf16 v[48:51], v[36:39], v[196:199], v[48:51]
    v_rcp_f32 v13, v13
    s_add_u32 m0, s42, 8192
    ds_read_b64_tr_b16 v[26:27], v1 offset:33024
    buffer_load_dwordx4 v6, s[12:15], s56 offen lds
    v_mfma_f32_16x16x32_bf16 v[52:55], v[32:35], v[200:203], v[52:55]
    v_rcp_f32 v14, v14
    ds_read_b64_tr_b16 v[28:29], v2 offset:32768
    v_mfma_f32_16x16x32_bf16 v[52:55], v[36:39], v[204:207], v[52:55]
    v_rcp_f32 v15, v15
    v_mul_f32 v72, v72, v12
    ds_read_b64_tr_b16 v[30:31], v2 offset:33024
    s_add_u32 s63, s74, 0
    buffer_load_dwordx4 v[128:131], v100, s[16:19], s63 offen offset:0 sc1
    v_mfma_f32_16x16x32_bf16 v[92:95], v[88:91], v[32:35], v[92:95]
    v_mul_f32 v73, v73, v13
    v_mul_f32 v74, v74, v14
    v_mul_f32 v75, v75, v15
    s_setprio 0
    s_waitcnt lgkmcnt(4)
    v_mfma_f32_16x16x32_bf16 v[56:59], v[40:43], v[192:195], v[56:59]
    v_cvt_pk_bf16_f32 v82, v72, v73
    v_cvt_pk_bf16_f32 v83, v74, v75
    s_cbranch_vccz LB_sw25
    v_swap_b32 v80, v82
    v_swap_b32 v81, v83
LB_sw25:
    s_add_u32 s63, s65, 49152
    buffer_store_dwordx4 v[80:83], v100, s[16:19], s63 offen sc1
    ds_read_b64_tr_b16 v[32:33], v3 offset:32768
    v_mfma_f32_16x16x32_bf16 v[56:59], v[44:47], v[196:199], v[56:59]
    v_mul_f32 v12, v68, v68
    v_mul_f32 v13, v69, v69
    v_mul_f32 v14, v70, v70
    ds_read_b64_tr_b16 v[34:35], v3 offset:33024
    v_mfma_f32_16x16x32_bf16 v[60:63], v[40:43], v[200:203], v[60:63]
    v_mul_f32 v15, v71, v71
    v_fma_f32 v12, v12, v20, v19
    v_fma_f32 v13, v13, v20, v19
    ds_read_b64_tr_b16 v[36:37], v4 offset:32768
    v_mfma_f32_16x16x32_bf16 v[60:63], v[44:47], v[204:207], v[60:63]
    v_fma_f32 v14, v14, v20, v19
    v_fma_f32 v15, v15, v20, v19
    v_mul_f32 v12, v68, v12
    ds_read_b64_tr_b16 v[38:39], v4 offset:33024
    s_add_u32 s63, s74, 0
    buffer_load_dwordx4 v[132:135], v100, s[16:19], s63 offen offset:1024 sc1
    s_cmp_eq_u32 s36, 0
    s_cbranch_scc0 LB_dw28
    s_waitcnt vmcnt(10)
    s_add_u32 s62, s96, 2
    v_subrev_u32 v108, s62, v108
    v_cmp_ne_u32 s[58:59], s97, v109
    v_cmp_lt_u32 s[60:61], 13, v108
    s_lshl_b32 s62, 1, s41
    s_andn2_b32 s62, 15, s62
    s_nop 0
    s_or_b32 s60, s60, s58
    s_and_b32 s60, s60, s62
    s_cbranch_scc0 LB_ok26
    s_mov_b32 s78, 200000
LB_sp27:
    s_sleep 1
    v_and_b32 v108, 3, v0
    v_lshlrev_b32 v108, 3, v108
    buffer_load_dwordx2 v[108:109], v108, s[16:19], s2 offen sc1
    s_waitcnt vmcnt(0)
    s_add_u32 s62, s96, 2
    v_subrev_u32 v108, s62, v108
    v_cmp_ne_u32 s[58:59], s97, v109
    v_cmp_lt_u32 s[60:61], 13, v108
    s_lshl_b32 s62, 1, s41
    s_andn2_b32 s62, 15, s62
    s_nop 0
    s_or_b32 s60, s60, s58
    s_and_b32 s60, s60, s62
    s_cbranch_scc0 LB_ok26
    s_sub_u32 s78, s78, 1
    s_cmp_lg_u32 s78, 0
    s_cbranch_scc1 LB_sp27
LB_ok26:
    s_nop 1
LB_dw28:
    s_barrier
    s_setprio 3
    s_waitcnt lgkmcnt(4)
    v_mfma_f32_16x16x32_bf16 v[48:51], v[24:27], v[208:211], v[48:51]
    v_mul_f32 v13, v69, v13
    v_mul_f32 v14, v70, v14
    v_mul_f32 v15, v71, v15
    s_add_u32 s56, s68, s80
    ds_read_b64_tr_b16 v[40:41], v1 offset:40960
    v_mfma_f32_16x16x32_bf16 v[48:51], v[28:31], v[212:215], v[48:51]
    v_exp_f32 v12, v12
    s_add_u32 s56, s56, 294912
    ds_read_b64_tr_b16 v[42:43], v1 offset:41216
    v_mfma_f32_16x16x32_bf16 v[52:55], v[24:27], v[216:219], v[52:55]
    v_exp_f32 v13, v13
    s_add_u32 m0, s42, 16384
    ds_read_b64_tr_b16 v[44:45], v2 offset:40960
    buffer_load_dwordx4 v6, s[12:15], s56 offen lds
    v_mfma_f32_16x16x32_bf16 v[52:55], v[28:31], v[220:223], v[52:55]
    v_exp_f32 v14, v14
    s_add_u32 s56, s71, 73728
    ds_read_b64_tr_b16 v[46:47], v2 offset:41216
    v_mfma_f32_16x16x32_bf16 v[92:95], v[88:91], v[24:27], v[92:95]
    v_exp_f32 v15, v15
    v_fma_f32 v12, v12, v21, v21
    s_add_u32 s57, s68, 294912
    s_add_u32 s63, s75, 0
    buffer_load_dwordx4 v[136:139], v100, s[16:19], s63 offen offset:0 sc1
    s_waitcnt lgkmcnt(4)
    v_mfma_f32_16x16x32_bf16 v[56:59], v[32:35], v[208:211], v[56:59]
    v_fma_f32 v13, v13, v21, v21
    v_fma_f32 v14, v14, v21, v21
    v_fma_f32 v15, v15, v21, v21
    s_cmp_ge_u32 s37, 2
    s_cselect_b32 s56, s57, s56
    ds_read_b64_tr_b16 v[24:25], v3 offset:40960
    v_mfma_f32_16x16x32_bf16 v[56:59], v[36:39], v[212:215], v[56:59]
    v_rcp_f32 v12, v12
    s_add_u32 s56, s56, s81
    ds_read_b64_tr_b16 v[26:27], v3 offset:41216
    v_mfma_f32_16x16x32_bf16 v[60:63], v[32:35], v[216:219], v[60:63]
    v_rcp_f32 v13, v13
    v_rcp_f32 v14, v14
    ds_read_b64_tr_b16 v[28:29], v4 offset:40960
    v_mfma_f32_16x16x32_bf16 v[60:63], v[36:39], v[220:223], v[60:63]
    v_rcp_f32 v15, v15
    ds_read_b64_tr_b16 v[30:31], v4 offset:41216
    s_setprio 2
    s_waitcnt lgkmcnt(4)
    v_mfma_f32_16x16x32_bf16 v[48:51], v[40:43], v[224:227], v[48:51]
    v_mul_f32 v68, v68, v12
    v_mul_f32 v69, v69, v13
    v_mul_f32 v70, v70, v14
    ds_read_b64_tr_b16 v[32:33], v1 offset:49152
    s_add_u32 s63, s75, 0
    buffer_load_dwordx4 v[140:143], v100, s[16:19], s63 offen offset:1024 sc1
    v_mfma_f32_16x16x32_bf16 v[48:51], v[44:47], v[228:231], v[48:51]
    v_mul_f32 v71, v71, v15
    v_cvt_pk_bf16_f32 v84, v68, v69
    v_cvt_pk_bf16_f32 v85, v70, v71
    ds_read_b64_tr_b16 v[34:35], v1 offset:49408
    v_mfma_f32_16x16x32_bf16 v[52:55], v[40:43], v[232:235], v[52:55]
    v_mul_f32 v12, v76, v76
    v_mul_f32 v13, v77, v77
    v_mul_f32 v14, v78, v78
    v_mul_f32 v15, v79, v79
    s_add_u32 m0, s42, 24576
    ds_read_b64_tr_b16 v[36:37], v2 offset:49152
    buffer_load_dwordx4 v7, s[12:15], s56 offen lds
    v_mfma_f32_16x16x32_bf16 v[52:55], v[44:47], v[236:239], v[52:55]
    v_fma_f32 v12, v12, v20, v19
    v_fma_f32 v13, v13, v20, v19
    s_add_u32 s56, s68, s80
    ds_read_b64_tr_b16 v[38:39], v2 offset:49408
    v_mfma_f32_16x16x32_bf16 v[92:95], v[88:91], v[40:43], v[92:95]
    v_fma_f32 v14, v14, v20, v19
    v_fma_f32 v15, v15, v20, v19
    v_mul_f32 v12, v76, v12
    s_add_u32 s56, s56, 147456
    s_setprio 1
    s_waitcnt lgkmcnt(4)
    v_mfma_f32_16x16x32_bf16 v[56:59], v[24:27], v[224:227], v[56:59]
    v_mul_f32 v13, v77, v13
    v_mul_f32 v14, v78, v14
    v_mul_f32 v15, v79, v15
    ds_read_b64_tr_b16 v[40:41], v3 offset:49152
    s_add_u32 s63, s72, 16384
    buffer_load_dwordx4 v[144:147], v100, s[16:19], s63 offen offset:0 sc1
    v_mfma_f32_16x16x32_bf16 v[56:59], v[28:31], v[228:231], v[56:59]
    v_exp_f32 v12, v12
    ds_read_b64_tr_b16 v[42:43], v3 offset:49408
    v_mfma_f32_16x16x32_bf16 v[60:63], v[24:27], v[232:235], v[60:63]
    v_exp_f32 v13, v13
    v_exp_f32 v14, v14
    ds_read_b64_tr_b16 v[44:45], v4 offset:49152
    v_mfma_f32_16x16x32_bf16 v[60:63], v[28:31], v[236:239], v[60:63]
    v_exp_f32 v15, v15
    v_fma_f32 v12, v12, v21, v21
    ds_read_b64_tr_b16 v[46:47], v4 offset:49408
    s_waitcnt lgkmcnt(4)
    v_mfma_f32_16x16x32_bf16 v[48:51], v[32:35], v[240:243], v[48:51]
    v_fma_f32 v13, v13, v21, v21
    v_fma_f32 v14, v14, v21, v21
    v_fma_f32 v15, v15, v21, v21
    v_add_u32 v5, 0x10000, v5
    ds_read_b64_tr_b16 v[24:25], v5 offset:0
    v_mfma_f32_16x16x32_bf16 v[48:51], v[36:39], v[244:247], v[48:51]
    v_rcp_f32 v12, v12
    s_add_u32 m0, s42, 32768
    ds_read_b64_tr_b16 v[26:27], v5 offset:2048
    buffer_load_dwordx4 v6, s[12:15], s56 offen lds
    v_mfma_f32_16x16x32_bf16 v[52:55], v[32:35], v[248:251], v[52:55]
    v_rcp_f32 v13, v13
    ds_read_b64_tr_b16 v[28:29], v5 offset:8192
    s_add_u32 s63, s72, 16384
    buffer_load_dwordx4 v[148:151], v100, s[16:19], s63 offen offset:1024 sc1
    v_mfma_f32_16x16x32_bf16 v[52:55], v[36:39], v[252:255], v[52:55]
    v_rcp_f32 v14, v14
    v_rcp_f32 v15, v15
    ds_read_b64_tr_b16 v[30:31], v5 offset:10240
    v_mfma_f32_16x16x32_bf16 v[92:95], v[88:91], v[32:35], v[92:95]
    v_mul_f32 v76, v76, v12
    v_mul_f32 v77, v77, v13
    v_mul_f32 v78, v78, v14
    v_mul_f32 v79, v79, v15
    s_setprio 0
    s_waitcnt lgkmcnt(4)
    v_mfma_f32_16x16x32_bf16 v[56:59], v[40:43], v[240:243], v[56:59]
    v_cvt_pk_bf16_f32 v86, v76, v77
    v_cvt_pk_bf16_f32 v87, v78, v79
    s_cbranch_vccz LB_sw29
    v_swap_b32 v84, v86
    v_swap_b32 v85, v87
LB_sw29:
    s_add_u32 s63, s65, 50176
    buffer_store_dwordx4 v[84:87], v100, s[16:19], s63 offen sc1
    v_add_u32 v101, 0x10000, v101
    ds_read_b64_tr_b16 v[32:33], v101 offset:0
    v_mfma_f32_16x16x32_bf16 v[56:59], v[44:47], v[244:247], v[56:59]
    ds_read_b64_tr_b16 v[34:35], v101 offset:2048
    v_mfma_f32_16x16x32_bf16 v[60:63], v[40:43], v[248:251], v[60:63]
    ds_read_b64_tr_b16 v[36:37], v101 offset:8192
    s_add_u32 s63, s73, 16384
    buffer_load_dwordx4 v[152:155], v100, s[16:19], s63 offen offset:0 sc1
    v_mfma_f32_16x16x32_bf16 v[60:63], v[44:47], v[252:255], v[60:63]
    ds_read_b64_tr_b16 v[38:39], v101 offset:10240
    v_and_b32 v99, 15, v0
    v_lshl_add_u32 v99, v99, 4, s66
    ds_write_b32 v99, v92 offset:0
    s_waitcnt lgkmcnt(0)
    s_barrier
    s_setprio 3
    v_mfma_f32_16x16x32_bf16 v[64:67], v[24:27], v[80:83], 0
    s_cmp_eq_u32 s36, 0
    s_cbranch_scc0 LB_dw30
    v_and_b32 v224, 3, v0
    v_lshlrev_b32 v224, 3, v224
    buffer_load_dwordx2 v[224:225], v224, s[16:19], s2 offen sc1
LB_dw30:
    v_and_b32 v96, 15, v0
    v_lshl_add_u32 v22, v96, 4, s67
    ds_read_b64 v[12:13], v22 offset:0
    v_xor_b32 v22, 8, v22
    ds_read_b64 v[14:15], v22 offset:0
    v_lshl_add_u32 v96, v96, 1, s79
    s_add_u32 s56, s69, s80
    ds_read_b64_tr_b16 v[40:41], v5 offset:512
    s_waitcnt vmcnt(18)
    v_mfma_f32_16x16x32_bf16 v[64:67], v[28:31], v[112:115], v[64:67]
    ds_read_u16 v22, v96 offset:512
    v_xor_b32 v96, 32, v96
    ds_read_u16 v96, v96 offset:512
    s_add_u32 s56, s56, 147456
    ds_read_b64_tr_b16 v[42:43], v5 offset:2560
    v_mfma_f32_16x16x32_bf16 v[68:71], v[24:27], v[84:87], 0
    s_add_u32 m0, s42, 40960
    ds_read_b64_tr_b16 v[44:45], v5 offset:8704
    buffer_load_dwordx4 v6, s[12:15], s56 offen lds
    s_waitcnt vmcnt(17)
    v_mfma_f32_16x16x32_bf16 v[68:71], v[28:31], v[116:119], v[68:71]
    s_add_u32 s56, s68, 147456
    ds_read_b64_tr_b16 v[46:47], v5 offset:10752
    s_add_u32 s63, s73, 16384
    buffer_load_dwordx4 v[156:159], v100, s[16:19], s63 offen offset:1024 sc1
    v_mfma_f32_16x16x32_bf16 v[72:75], v[32:35], v[80:83], 0
    s_add_u32 s57, s69, 147456
    ds_read_b64_tr_b16 v[24:25], v101 offset:512
    v_mfma_f32_16x16x32_bf16 v[72:75], v[36:39], v[112:115], v[72:75]
    s_waitcnt lgkmcnt(8)
    v_add_f32 v12, v12, v13
    s_waitcnt lgkmcnt(7)
    v_add_f32 v14, v14, v15
    s_waitcnt lgkmcnt(5)
    v_lshlrev_b32 v22, 16, v22
    s_waitcnt lgkmcnt(4)
    v_lshlrev_b32 v96, 16, v96
    v_cvt_pk_bf16_f32 v23, v12, v22
    v_cvt_pk_bf16_f32 v97, v14, v96
    s_cmp_ge_u32 s37, 2
    s_cselect_b32 s56, s57, s56
    ds_read_b64_tr_b16 v[26:27], v101 offset:2560
    v_mfma_f32_16x16x32_bf16 v[76:79], v[32:35], v[84:87], 0
    v_lshlrev_b32 v13, 16, v23
    v_lshlrev_b32 v15, 16, v97
    v_sub_f32 v12, v12, v13
    v_sub_f32 v14, v14, v15
    v_cvt_pk_bf16_f32 v22, v13, v12
    s_add_u32 s56, s56, s81
    ds_read_b64_tr_b16 v[28:29], v101 offset:8704
    v_mfma_f32_16x16x32_bf16 v[76:79], v[36:39], v[116:119], v[76:79]
    v_cvt_pk_bf16_f32 v96, v15, v14
    ds_read_b64_tr_b16 v[30:31], v101 offset:10752
    s_setprio 2
    s_waitcnt lgkmcnt(4)
    v_mfma_f32_16x16x32_bf16 v[104:107], v[40:43], v[80:83], 0
    v_mfma_f32_16x16x16_bf16 v[232:235], v[22:23], v[8:9], v[48:51]
    v_mfma_f32_16x16x16_bf16 v[236:239], v[22:23], v[10:11], v[52:55]
    v_mfma_f32_16x16x16_bf16 v[240:243], v[96:97], v[8:9], v[56:59]
    v_mfma_f32_16x16x16_bf16 v[244:247], v[96:97], v[10:11], v[60:63]
    v_add_u32 v102, 0x26000, v102
    ds_read_b64_tr_b16 v[32:33], v102 offset:0
    s_add_u32 s63, s74, 16384
    buffer_load_dwordx4 v[160:163], v100, s[16:19], s63 offen offset:0 sc1
    v_mfma_f32_16x16x32_bf16 v[104:107], v[44:47], v[112:115], v[104:107]
    ds_read_b64_tr_b16 v[34:35], v102 offset:1024
    v_mfma_f32_16x16x32_bf16 v[108:111], v[40:43], v[84:87], 0
    v_mul_f32 v12, v232, v232
    v_mul_f32 v13, v233, v233
    v_mul_f32 v14, v234, v234
    v_mul_f32 v15, v235, v235
    v_fma_f32 v12, v12, v17, v16
    v_fma_f32 v13, v13, v17, v16
    ds_read_b64_tr_b16 v[36:37], v102 offset:2048
    v_mfma_f32_16x16x32_bf16 v[108:111], v[44:47], v[116:119], v[108:111]
    v_fma_f32 v14, v14, v17, v16
    v_fma_f32 v15, v15, v17, v16
    v_mul_f32 v12, v232, v12
    v_mul_f32 v13, v233, v13
    v_mul_f32 v14, v234, v14
    s_add_u32 m0, s42, 49152
    ds_read_b64_tr_b16 v[38:39], v102 offset:3072
    buffer_load_dwordx4 v7, s[12:15], s56 offen lds
    s_setprio 1
    s_waitcnt lgkmcnt(4)
    v_mfma_f32_16x16x32_bf16 v[248:251], v[24:27], v[80:83], 0
    v_mul_f32 v15, v235, v15
    v_exp_f32 v12, v12
    v_exp_f32 v13, v13
    s_add_u32 s56, s70, s80
    v_add_u32 v103, 0x26000, v103
    ds_read_b64_tr_b16 v[40:41], v103 offset:0
    v_mfma_f32_16x16x32_bf16 v[248:251], v[28:31], v[112:115], v[248:251]
    v_exp_f32 v14, v14
    v_exp_f32 v15, v15
    s_add_u32 s56, s56, 147456
    ds_read_b64_tr_b16 v[42:43], v103 offset:1024
    s_add_u32 s63, s74, 16384
    buffer_load_dwordx4 v[164:167], v100, s[16:19], s63 offen offset:1024 sc1
    v_mfma_f32_16x16x32_bf16 v[252:255], v[24:27], v[84:87], 0
    v_fma_f32 v12, v12, v18, v18
    v_fma_f32 v13, v13, v18, v18
    v_fma_f32 v14, v14, v18, v18
    v_fma_f32 v15, v15, v18, v18
    ds_read_b64_tr_b16 v[44:45], v103 offset:2048
    v_mfma_f32_16x16x32_bf16 v[252:255], v[28:31], v[116:119], v[252:255]
    v_rcp_f32 v12, v12
    v_rcp_f32 v13, v13
    v_rcp_f32 v14, v14
    ds_read_b64_tr_b16 v[46:47], v103 offset:3072
    s_waitcnt lgkmcnt(4)
    v_mfma_f32_16x16x32_bf16 v[88:91], v[32:35], v[80:83], 0
    v_rcp_f32 v15, v15
    v_mul_f32 v232, v232, v12
    v_mul_f32 v233, v233, v13
    v_mul_f32 v234, v234, v14
    ds_read_b64_tr_b16 v[24:25], v5 offset:16384
    v_mfma_f32_16x16x32_bf16 v[88:91], v[36:39], v[112:115], v[88:91]
    v_mul_f32 v235, v235, v15
    v_cvt_pk_bf16_f32 v176, v232, v233
    v_cvt_pk_bf16_f32 v177, v234, v235
    v_mul_f32 v12, v240, v240
    v_mul_f32 v13, v241, v241
    ds_read_b64_tr_b16 v[26:27], v5 offset:18432
    v_mfma_f32_16x16x32_bf16 v[92:95], v[32:35], v[84:87], 0
    v_mul_f32 v14, v242, v242
    v_mul_f32 v15, v243, v243
    v_fma_f32 v12, v12, v17, v16
    v_fma_f32 v13, v13, v17, v16
    v_fma_f32 v14, v14, v17, v16
    ds_read_b64_tr_b16 v[28:29], v5 offset:24576
    s_add_u32 s63, s75, 16384
    buffer_load_dwordx4 v[168:171], v100, s[16:19], s63 offen offset:0 sc1
    v_mfma_f32_16x16x32_bf16 v[92:95], v[36:39], v[116:119], v[92:95]
    v_fma_f32 v15, v15, v17, v16
    v_mul_f32 v12, v240, v12
    v_mul_f32 v13, v241, v13
    v_mul_f32 v14, v242, v14
    v_mul_f32 v15, v243, v15
    ds_read_b64_tr_b16 v[30:31], v5 offset:26624
    s_setprio 0
    s_waitcnt lgkmcnt(4)
    v_mfma_f32_16x16x32_bf16 v[48:51], v[40:43], v[80:83], 0
    v_exp_f32 v12, v12
    v_exp_f32 v13, v13
    s_add_u32 m0, s42, 57344
    ds_read_b64_tr_b16 v[32:33], v101 offset:16384
    buffer_load_dwordx4 v6, s[12:15], s56 offen lds
    v_mfma_f32_16x16x32_bf16 v[48:51], v[44:47], v[112:115], v[48:51]
    v_exp_f32 v14, v14
    v_exp_f32 v15, v15
    v_fma_f32 v12, v12, v18, v18
    v_fma_f32 v13, v13, v18, v18
    ds_read_b64_tr_b16 v[34:35], v101 offset:18432
    v_mfma_f32_16x16x32_bf16 v[52:55], v[40:43], v[84:87], 0
    v_fma_f32 v14, v14, v18, v18
    v_fma_f32 v15, v15, v18, v18
    v_rcp_f32 v12, v12
    ds_read_b64_tr_b16 v[36:37], v101 offset:24576
    v_mfma_f32_16x16x32_bf16 v[52:55], v[44:47], v[116:119], v[52:55]
    v_rcp_f32 v13, v13
    v_rcp_f32 v14, v14
    v_rcp_f32 v15, v15
    ds_read_b64_tr_b16 v[38:39], v101 offset:26624
    s_add_u32 s63, s75, 16384
    buffer_load_dwordx4 v[172:175], v100, s[16:19], s63 offen offset:1024 sc1
    s_cmp_eq_u32 s36, 0
    s_cbranch_scc0 LB_dw33
    s_waitcnt vmcnt(8)
    s_add_u32 s62, s96, 3
    v_subrev_u32 v224, s62, v224
    v_cmp_ne_u32 s[58:59], s97, v225
    v_cmp_lt_u32 s[60:61], 12, v224
    s_lshl_b32 s62, 1, s41
    s_andn2_b32 s62, 15, s62
    s_nop 0
    s_or_b32 s60, s60, s58
    s_and_b32 s60, s60, s62
    s_cbranch_scc0 LB_ok31
    s_mov_b32 s78, 200000
LB_sp32:
    s_sleep 1
    v_and_b32 v224, 3, v0
    v_lshlrev_b32 v224, 3, v224
    buffer_load_dwordx2 v[224:225], v224, s[16:19], s2 offen sc1
    s_waitcnt vmcnt(0)
    s_add_u32 s62, s96, 3
    v_subrev_u32 v224, s62, v224
    v_cmp_ne_u32 s[58:59], s97, v225
    v_cmp_lt_u32 s[60:61], 12, v224
    s_lshl_b32 s62, 1, s41
    s_andn2_b32 s62, 15, s62
    s_nop 0
    s_or_b32 s60, s60, s58
    s_and_b32 s60, s60, s62
    s_cbranch_scc0 LB_ok31
    s_sub_u32 s78, s78, 1
    s_cmp_lg_u32 s78, 0
    s_cbranch_scc1 LB_sp32
LB_ok31:
    s_nop 1
LB_dw33:
    s_waitcnt vmcnt(9)
    s_barrier
    s_cmp_eq_u32 s36, 0
    s_cbranch_scc0 LB_dw34
    s_add_u32 s63, s96, 4
    v_mov_b32 v2, s63
    v_mov_b32 v3, s97
    s_mul_i32 s62, s41, 120
    s_sub_u32 s62, s2, s62
    s_lshl_b32 s63, s41, 3
    s_lshl_b32 s63, 1, s63
    s_andn2_b32 exec_lo, 0x01010101, s63
    s_mov_b32 exec_hi, 0
    buffer_store_dwordx2 v[2:3], v100, s[16:19], s62 offen sc1
    s_mov_b64 exec, -1
LB_dw34:
    s_setprio 3
    s_waitcnt lgkmcnt(4)
    v_mfma_f32_16x16x32_bf16 v[64:67], v[24:27], v[120:123], v[64:67]
    v_mul_f32 v240, v240, v12
    v_mul_f32 v241, v241, v13
    v_mul_f32 v242, v242, v14
    v_mul_f32 v243, v243, v15
    v_cvt_pk_bf16_f32 v178, v240, v241
    s_add_u32 s56, s71, s80
    ds_read_b64_tr_b16 v[40:41], v5 offset:16896
    v_mfma_f32_16x16x32_bf16 v[64:67], v[28:31], v[128:131], v[64:67]
    v_cvt_pk_bf16_f32 v179, v242, v243
    s_cbranch_vccz LB_sw35
    v_swap_b32 v176, v178
    v_swap_b32 v177, v179
LB_sw35:
    s_add_u32 s63, s65, 65536
    buffer_store_dwordx4 v[176:179], v100, s[16:19], s63 offen sc1
    v_mul_f32 v12, v236, v236
    v_mul_f32 v13, v237, v237
    v_mul_f32 v14, v238, v238
    s_add_u32 s56, s56, 147456
    ds_read_b64_tr_b16 v[42:43], v5 offset:18944
    v_mfma_f32_16x16x32_bf16 v[68:71], v[24:27], v[124:127], v[68:71]
    v_mul_f32 v15, v239, v239
    v_fma_f32 v12, v12, v20, v19
    v_fma_f32 v13, v13, v20, v19
    v_fma_f32 v14, v14, v20, v19
    v_fma_f32 v15, v15, v20, v19
    ds_read_b64_tr_b16 v[44:45], v5 offset:25088
    v_mfma_f32_16x16x32_bf16 v[68:71], v[28:31], v[132:135], v[68:71]
    v_mul_f32 v12, v236, v12
    v_mul_f32 v13, v237, v13
    v_mul_f32 v14, v238, v14
    v_mul_f32 v15, v239, v15
    ds_read_b64_tr_b16 v[46:47], v5 offset:27136
    s_waitcnt lgkmcnt(4)
    v_mfma_f32_16x16x32_bf16 v[72:75], v[32:35], v[120:123], v[72:75]
    v_exp_f32 v12, v12
    v_exp_f32 v13, v13
    v_exp_f32 v14, v14
    s_add_u32 m0, s42, 65536
    ds_read_b64_tr_b16 v[24:25], v101 offset:16896
    buffer_load_dwordx4 v6, s[12:15], s56 offen lds
    v_mfma_f32_16x16x32_bf16 v[72:75], v[36:39], v[128:131], v[72:75]
    v_exp_f32 v15, v15
    v_fma_f32 v12, v12, v21, v21
    v_fma_f32 v13, v13, v21, v21
    v_fma_f32 v14, v14, v21, v21
    s_add_u32 s56, s70, 147456
    ds_read_b64_tr_b16 v[26:27], v101 offset:18944
    s_add_u32 s63, s72, 32768
    buffer_load_dwordx4 v[184:187], v100, s[16:19], s63 offen offset:0 sc1
    v_mfma_f32_16x16x32_bf16 v[76:79], v[32:35], v[124:127], v[76:79]
    v_fma_f32 v15, v15, v21, v21
    v_rcp_f32 v12, v12
    v_rcp_f32 v13, v13
    s_add_u32 s57, s71, 147456
    ds_read_b64_tr_b16 v[28:29], v101 offset:25088
    v_mfma_f32_16x16x32_bf16 v[76:79], v[36:39], v[132:135], v[76:79]
    v_rcp_f32 v14, v14
    v_rcp_f32 v15, v15
    v_mul_f32 v236, v236, v12
    s_cmp_ge_u32 s37, 2
    s_cselect_b32 s56, s57, s56
    ds_read_b64_tr_b16 v[30:31], v101 offset:27136
    s_setprio 2
    s_waitcnt lgkmcnt(4)
    v_mfma_f32_16x16x32_bf16 v[104:107], v[40:43], v[120:123], v[104:107]
    v_mul_f32 v237, v237, v13
    v_mul_f32 v238, v238, v14
    v_mul_f32 v239, v239, v15
    v_cvt_pk_bf16_f32 v180, v236, v237
    v_cvt_pk_bf16_f32 v181, v238, v239
    s_add_u32 s56, s56, s81
    v_add_u32 v102, 0xffff2000, v102
    ds_read_b64_tr_b16 v[32:33], v102 offset:0
    v_mfma_f32_16x16x32_bf16 v[104:107], v[44:47], v[128:131], v[104:107]
    v_mul_f32 v12, v244, v244
    v_mul_f32 v13, v245, v245
    v_mul_f32 v14, v246, v246
    v_mul_f32 v15, v247, v247
    ds_read_b64_tr_b16 v[34:35], v102 offset:1024
    v_mfma_f32_16x16x32_bf16 v[108:111], v[40:43], v[124:127], v[108:111]
    v_fma_f32 v12, v12, v20, v19
    v_fma_f32 v13, v13, v20, v19
    v_fma_f32 v14, v14, v20, v19
    v_fma_f32 v15, v15, v20, v19
    v_mul_f32 v12, v244, v12
    ds_read_b64_tr_b16 v[36:37], v102 offset:2048
    s_add_u32 s63, s72, 32768
    buffer_load_dwordx4 v[188:191], v100, s[16:19], s63 offen offset:1024 sc1
    v_mfma_f32_16x16x32_bf16 v[108:111], v[44:47], v[132:135], v[108:111]
    v_mul_f32 v13, v245, v13
    v_mul_f32 v14, v246, v14
    v_mul_f32 v15, v247, v15
    v_exp_f32 v12, v12
    ds_read_b64_tr_b16 v[38:39], v102 offset:3072
    s_setprio 1
    s_waitcnt lgkmcnt(4)
    v_mfma_f32_16x16x32_bf16 v[248:251], v[24:27], v[120:123], v[248:251]
    v_exp_f32 v13, v13
    v_exp_f32 v14, v14
    v_add_u32 v103, 0xffff2000, v103
    ds_read_b64_tr_b16 v[40:41], v103 offset:0
    v_mfma_f32_16x16x32_bf16 v[248:251], v[28:31], v[128:131], v[248:251]
    v_exp_f32 v15, v15
    v_fma_f32 v12, v12, v21, v21
    v_fma_f32 v13, v13, v21, v21
    v_fma_f32 v14, v14, v21, v21
    s_add_u32 m0, s42, 73728
    ds_read_b64_tr_b16 v[42:43], v103 offset:1024
    buffer_load_dwordx4 v7, s[12:15], s56 offen lds
    v_mfma_f32_16x16x32_bf16 v[252:255], v[24:27], v[124:127], v[252:255]
    v_fma_f32 v15, v15, v21, v21
    v_rcp_f32 v12, v12
    v_rcp_f32 v13, v13
    s_add_u32 s56, s69, s80
    ds_read_b64_tr_b16 v[44:45], v103 offset:2048
    v_mfma_f32_16x16x32_bf16 v[252:255], v[28:31], v[132:135], v[252:255]
    v_rcp_f32 v14, v14
    v_rcp_f32 v15, v15
    v_mul_f32 v244, v244, v12
    s_add_u32 s56, s56, 221184
    ds_read_b64_tr_b16 v[46:47], v103 offset:3072
    s_add_u32 s63, s73, 32768
    buffer_load_dwordx4 v[192:195], v100, s[16:19], s63 offen offset:0 sc1
    s_waitcnt lgkmcnt(4)
    v_mfma_f32_16x16x32_bf16 v[88:91], v[32:35], v[120:123], v[88:91]
    v_mul_f32 v245, v245, v13
    v_mul_f32 v246, v246, v14
    v_mul_f32 v247, v247, v15
    v_cvt_pk_bf16_f32 v182, v244, v245
    v_cvt_pk_bf16_f32 v183, v246, v247
    ds_read_b64_tr_b16 v[24:25], v5 offset:40960
    v_mfma_f32_16x16x32_bf16 v[88:91], v[36:39], v[128:131], v[88:91]
    s_cbranch_vccz LB_sw36
    v_swap_b32 v180, v182
    v_swap_b32 v181, v183
LB_sw36:
    s_add_u32 s63, s65, 66560
    buffer_store_dwordx4 v[180:183], v100, s[16:19], s63 offen sc1
    ds_read_b64_tr_b16 v[26:27], v5 offset:43008
    v_mfma_f32_16x16x32_bf16 v[92:95], v[32:35], v[124:127], v[92:95]
    ds_read_b64_tr_b16 v[28:29], v5 offset:49152
    v_mfma_f32_16x16x32_bf16 v[92:95], v[36:39], v[132:135], v[92:95]
    ds_read_b64_tr_b16 v[30:31], v5 offset:51200
    s_setprio 0
    s_waitcnt lgkmcnt(4)
    v_mfma_f32_16x16x32_bf16 v[48:51], v[40:43], v[120:123], v[48:51]
    ds_read_b64_tr_b16 v[32:33], v101 offset:40960
    s_add_u32 s63, s73, 32768
    buffer_load_dwordx4 v[196:199], v100, s[16:19], s63 offen offset:1024 sc1
    v_mfma_f32_16x16x32_bf16 v[48:51], v[44:47], v[128:131], v[48:51]
    ds_read_b64_tr_b16 v[34:35], v101 offset:43008
    v_mfma_f32_16x16x32_bf16 v[52:55], v[40:43], v[124:127], v[52:55]
    s_add_u32 m0, s42, 155648
    ds_read_b64_tr_b16 v[36:37], v101 offset:49152
    buffer_load_dwordx4 v6, s[12:15], s56 offen lds
    v_mfma_f32_16x16x32_bf16 v[52:55], v[44:47], v[132:135], v[52:55]
    ds_read_b64_tr_b16 v[38:39], v101 offset:51200
    s_waitcnt vmcnt(2)
    s_barrier
    s_cmp_eq_u32 s36, 0
    s_cbranch_scc0 LB_dw37
    s_add_u32 s63, s96, 15
    v_mov_b32 v2, s63
    v_mov_b32 v3, s97
    s_mul_i32 s62, s41, 120
    s_sub_u32 s62, s2, s62
    s_lshl_b32 s63, s41, 3
    s_lshl_b32 s63, 1, s63
    s_andn2_b32 exec_lo, 0x01010101, s63
    s_mov_b32 exec_hi, 0
    buffer_store_dwordx2 v[2:3], v100, s[16:19], s62 offen sc1
    s_mov_b64 exec, -1
LB_dw37:
    s_setprio 3
    s_waitcnt lgkmcnt(4)
    v_mfma_f32_16x16x32_bf16 v[64:67], v[24:27], v[136:139], v[64:67]
    s_add_u32 s56, s70, s80
    ds_read_b64_tr_b16 v[40:41], v5 offset:41472
    v_mfma_f32_16x16x32_bf16 v[64:67], v[28:31], v[144:147], v[64:67]
    s_add_u32 s56, s56, 221184
    ds_read_b64_tr_b16 v[42:43], v5 offset:43520
    s_add_u32 s63, s74, 32768
    buffer_load_dwordx4 v[200:203], v100, s[16:19], s63 offen offset:0 sc1
    v_mfma_f32_16x16x32_bf16 v[68:71], v[24:27], v[140:143], v[68:71]
    ds_read_b64_tr_b16 v[44:45], v5 offset:49664
    v_mfma_f32_16x16x32_bf16 v[68:71], v[28:31], v[148:151], v[68:71]
    ds_read_b64_tr_b16 v[46:47], v5 offset:51712
    s_waitcnt lgkmcnt(4)
    v_mfma_f32_16x16x32_bf16 v[72:75], v[32:35], v[136:139], v[72:75]
    ds_read_b64_tr_b16 v[24:25], v101 offset:41472
    v_mfma_f32_16x16x32_bf16 v[72:75], v[36:39], v[144:147], v[72:75]
    ds_read_b64_tr_b16 v[26:27], v101 offset:43520
    v_mfma_f32_16x16x32_bf16 v[76:79], v[32:35], v[140:143], v[76:79]
    s_add_u32 m0, s42, 81920
    ds_read_b64_tr_b16 v[28:29], v101 offset:49664
    buffer_load_dwordx4 v6, s[12:15], s56 offen lds
    v_mfma_f32_16x16x32_bf16 v[76:79], v[36:39], v[148:151], v[76:79]
    s_add_u32 s56, s69, 221184
    ds_read_b64_tr_b16 v[30:31], v101 offset:51712
    s_add_u32 s63, s74, 32768
    buffer_load_dwordx4 v[204:207], v100, s[16:19], s63 offen offset:1024 sc1
    s_setprio 2
    s_waitcnt lgkmcnt(4)
    v_mfma_f32_16x16x32_bf16 v[104:107], v[40:43], v[136:139], v[104:107]
    s_add_u32 s57, s70, 221184
    ds_read_b64_tr_b16 v[32:33], v102 offset:24576
    v_mfma_f32_16x16x32_bf16 v[104:107], v[44:47], v[144:147], v[104:107]
    s_cmp_ge_u32 s37, 2
    s_cselect_b32 s56, s57, s56
    ds_read_b64_tr_b16 v[34:35], v102 offset:25600
    v_mfma_f32_16x16x32_bf16 v[108:111], v[40:43], v[140:143], v[108:111]
    s_add_u32 s56, s56, s81
    ds_read_b64_tr_b16 v[36:37], v102 offset:26624
    v_mfma_f32_16x16x32_bf16 v[108:111], v[44:47], v[148:151], v[108:111]
    ds_read_b64_tr_b16 v[38:39], v102 offset:27648
    s_setprio 1
    s_waitcnt lgkmcnt(4)
    v_mfma_f32_16x16x32_bf16 v[248:251], v[24:27], v[136:139], v[248:251]
    ds_read_b64_tr_b16 v[40:41], v103 offset:24576
    s_add_u32 s63, s75, 32768
    buffer_load_dwordx4 v[208:211], v100, s[16:19], s63 offen offset:0 sc1
    v_mfma_f32_16x16x32_bf16 v[248:251], v[28:31], v[144:147], v[248:251]
    ds_read_b64_tr_b16 v[42:43], v103 offset:25600
    v_mfma_f32_16x16x32_bf16 v[252:255], v[24:27], v[140:143], v[252:255]
    ds_read_b64_tr_b16 v[44:45], v103 offset:26624
    v_mfma_f32_16x16x32_bf16 v[252:255], v[28:31], v[148:151], v[252:255]
    s_add_u32 m0, s42, 90112
    ds_read_b64_tr_b16 v[46:47], v103 offset:27648
    buffer_load_dwordx4 v7, s[12:15], s56 offen lds
    s_waitcnt lgkmcnt(4)
    v_mfma_f32_16x16x32_bf16 v[88:91], v[32:35], v[136:139], v[88:91]
    s_add_u32 s56, s71, s80
    v_add_u32 v5, 0x10000, v5
    ds_read_b64_tr_b16 v[24:25], v5 offset:0
    v_mfma_f32_16x16x32_bf16 v[88:91], v[36:39], v[144:147], v[88:91]
    s_add_u32 s56, s56, 221184
    ds_read_b64_tr_b16 v[26:27], v5 offset:2048
    s_add_u32 s63, s75, 32768
    buffer_load_dwordx4 v[212:215], v100, s[16:19], s63 offen offset:1024 sc1
    v_mfma_f32_16x16x32_bf16 v[92:95], v[32:35], v[140:143], v[92:95]
    ds_read_b64_tr_b16 v[28:29], v5 offset:8192
    v_mfma_f32_16x16x32_bf16 v[92:95], v[36:39], v[148:151], v[92:95]
    ds_read_b64_tr_b16 v[30:31], v5 offset:10240
    s_setprio 0
    s_waitcnt lgkmcnt(4)
    v_mfma_f32_16x16x32_bf16 v[48:51], v[40:43], v[136:139], v[48:51]
    v_add_u32 v101, 0x10000, v101
    ds_read_b64_tr_b16 v[32:33], v101 offset:0
    v_mfma_f32_16x16x32_bf16 v[48:51], v[44:47], v[144:147], v[48:51]
    ds_read_b64_tr_b16 v[34:35], v101 offset:2048
    v_mfma_f32_16x16x32_bf16 v[52:55], v[40:43], v[140:143], v[52:55]
    ds_read_b64_tr_b16 v[36:37], v101 offset:8192
    v_mfma_f32_16x16x32_bf16 v[52:55], v[44:47], v[148:151], v[52:55]
    s_add_u32 m0, s42, 98304
    ds_read_b64_tr_b16 v[38:39], v101 offset:10240
    buffer_load_dwordx4 v6, s[12:15], s56 offen lds
    s_barrier
    s_setprio 3
    s_waitcnt lgkmcnt(4)
    v_mfma_f32_16x16x32_bf16 v[64:67], v[24:27], v[152:155], v[64:67]
    s_cmp_eq_u32 s36, 0
    s_cbranch_scc0 LB_dw38
    v_and_b32 v224, 3, v0
    v_lshlrev_b32 v224, 3, v224
    buffer_load_dwordx2 v[224:225], v224, s[16:19], s2 offen sc1
LB_dw38:
    s_add_u32 s56, s69, s80
    ds_read_b64_tr_b16 v[40:41], v5 offset:512
    v_mfma_f32_16x16x32_bf16 v[64:67], v[28:31], v[160:163], v[64:67]
    s_add_u32 s56, s56, 294912
    ds_read_b64_tr_b16 v[42:43], v5 offset:2560
    v_mfma_f32_16x16x32_bf16 v[68:71], v[24:27], v[156:159], v[68:71]
    ds_read_b64_tr_b16 v[44:45], v5 offset:8704
    v_mfma_f32_16x16x32_bf16 v[68:71], v[28:31], v[164:167], v[68:71]
    ds_read_b64_tr_b16 v[46:47], v5 offset:10752
    s_waitcnt lgkmcnt(4)
    v_mfma_f32_16x16x32_bf16 v[72:75], v[32:35], v[152:155], v[72:75]
    ds_read_b64_tr_b16 v[24:25], v101 offset:512
    v_mfma_f32_16x16x32_bf16 v[72:75], v[36:39], v[160:163], v[72:75]
    ds_read_b64_tr_b16 v[26:27], v101 offset:2560
    v_mfma_f32_16x16x32_bf16 v[76:79], v[32:35], v[156:159], v[76:79]
    s_add_u32 m0, s42, 106496
    ds_read_b64_tr_b16 v[28:29], v101 offset:8704
    buffer_load_dwordx4 v6, s[12:15], s56 offen lds
    v_mfma_f32_16x16x32_bf16 v[76:79], v[36:39], v[164:167], v[76:79]
    s_add_u32 s56, s71, 221184
    ds_read_b64_tr_b16 v[30:31], v101 offset:10752
    s_setprio 2
    s_waitcnt lgkmcnt(4)
    v_mfma_f32_16x16x32_bf16 v[104:107], v[40:43], v[152:155], v[104:107]
    s_add_u32 s57, s69, 294912
    ds_read_b64_tr_b16 v[32:33], v102 offset:49152
    v_mfma_f32_16x16x32_bf16 v[104:107], v[44:47], v[160:163], v[104:107]
    s_cmp_ge_u32 s37, 2
    s_cselect_b32 s56, s57, s56
    ds_read_b64_tr_b16 v[34:35], v102 offset:50176
    v_mfma_f32_16x16x32_bf16 v[108:111], v[40:43], v[156:159], v[108:111]
    s_add_u32 s56, s56, s81
    ds_read_b64_tr_b16 v[36:37], v102 offset:51200
    v_mfma_f32_16x16x32_bf16 v[108:111], v[44:47], v[164:167], v[108:111]
    ds_read_b64_tr_b16 v[38:39], v102 offset:52224
    s_setprio 1
    s_waitcnt lgkmcnt(4)
    v_mfma_f32_16x16x32_bf16 v[248:251], v[24:27], v[152:155], v[248:251]
    ds_read_b64_tr_b16 v[40:41], v103 offset:49152
    v_mfma_f32_16x16x32_bf16 v[248:251], v[28:31], v[160:163], v[248:251]
    s_add_u32 m0, s42, 114688
    ds_read_b64_tr_b16 v[42:43], v103 offset:50176
    buffer_load_dwordx4 v7, s[12:15], s56 offen lds
    v_mfma_f32_16x16x32_bf16 v[252:255], v[24:27], v[156:159], v[252:255]
    s_add_u32 s56, s68, 221184
    ds_read_b64_tr_b16 v[44:45], v103 offset:51200
    v_mfma_f32_16x16x32_bf16 v[252:255], v[28:31], v[164:167], v[252:255]
    s_add_u32 s57, s68, 0
    ds_read_b64_tr_b16 v[46:47], v103 offset:52224
    s_waitcnt lgkmcnt(4)
    v_mfma_f32_16x16x32_bf16 v[88:91], v[32:35], v[152:155], v[88:91]
    s_cmp_ge_u32 s37, 2
    s_cselect_b32 s56, s57, s56
    v_add_u32 v5, 0xfffe2000, v5
    ds_read_b64_tr_b16 v[24:25], v5 offset:0
    v_mfma_f32_16x16x32_bf16 v[88:91], v[36:39], v[160:163], v[88:91]
    s_add_u32 s56, s56, s83
    ds_read_b64_tr_b16 v[26:27], v5 offset:2048
    v_mfma_f32_16x16x32_bf16 v[92:95], v[32:35], v[156:159], v[92:95]
    ds_read_b64_tr_b16 v[28:29], v5 offset:8192
    v_mfma_f32_16x16x32_bf16 v[92:95], v[36:39], v[164:167], v[92:95]
    ds_read_b64_tr_b16 v[30:31], v5 offset:10240
    s_setprio 0
    s_waitcnt lgkmcnt(4)
    v_mfma_f32_16x16x32_bf16 v[48:51], v[40:43], v[152:155], v[48:51]
    s_add_u32 m0, s42, 122880
    v_add_u32 v101, 0xfffe2000, v101
    ds_read_b64_tr_b16 v[32:33], v101 offset:0
    buffer_load_dwordx4 v7, s[12:15], s56 offen lds
    v_mfma_f32_16x16x32_bf16 v[48:51], v[44:47], v[160:163], v[48:51]
    ds_read_b64_tr_b16 v[34:35], v101 offset:2048
    v_mfma_f32_16x16x32_bf16 v[52:55], v[40:43], v[156:159], v[52:55]
    ds_read_b64_tr_b16 v[36:37], v101 offset:8192
    v_mfma_f32_16x16x32_bf16 v[52:55], v[44:47], v[164:167], v[52:55]
    ds_read_b64_tr_b16 v[38:39], v101 offset:10240
    s_cmp_eq_u32 s36, 0
    s_cbranch_scc0 LB_dw41
    s_waitcnt vmcnt(3)
    s_add_u32 s62, s96, 4
    v_subrev_u32 v224, s62, v224
    v_cmp_ne_u32 s[58:59], s97, v225
    v_cmp_lt_u32 s[60:61], 11, v224
    s_lshl_b32 s62, 1, s41
    s_andn2_b32 s62, 15, s62
    s_nop 0
    s_or_b32 s60, s60, s58
    s_and_b32 s60, s60, s62
    s_cbranch_scc0 LB_ok39
    s_mov_b32 s78, 200000
LB_sp40:
    s_sleep 1
    v_and_b32 v224, 3, v0
    v_lshlrev_b32 v224, 3, v224
    buffer_load_dwordx2 v[224:225], v224, s[16:19], s2 offen sc1
    s_waitcnt vmcnt(0)
    s_add_u32 s62, s96, 4
    v_subrev_u32 v224, s62, v224
    v_cmp_ne_u32 s[58:59], s97, v225
    v_cmp_lt_u32 s[60:61], 11, v224
    s_lshl_b32 s62, 1, s41
    s_andn2_b32 s62, 15, s62
    s_nop 0
    s_or_b32 s60, s60, s58
    s_and_b32 s60, s60, s62
    s_cbranch_scc0 LB_ok39
    s_sub_u32 s78, s78, 1
    s_cmp_lg_u32 s78, 0
    s_cbranch_scc1 LB_sp40
LB_ok39:
    s_nop 1
LB_dw41:
    s_barrier
    s_setprio 3
    s_waitcnt lgkmcnt(4)
    v_mfma_f32_16x16x32_bf16 v[64:67], v[24:27], v[168:171], v[64:67]
    s_add_u32 s56, s69, 0
    ds_read_b64_tr_b16 v[40:41], v5 offset:512
    s_add_u32 s63, s73, 49152
    buffer_load_dwordx4 v[216:219], v100, s[16:19], s63 offen offset:0 sc1
    v_mfma_f32_16x16x32_bf16 v[64:67], v[28:31], v[176:179], v[64:67]
    s_add_u32 s57, s70, 0
    ds_read_b64_tr_b16 v[42:43], v5 offset:2560
    v_mfma_f32_16x16x32_bf16 v[68:71], v[24:27], v[172:175], v[68:71]
    s_cmp_ge_u32 s37, 2
    s_cselect_b32 s56, s57, s56
    ds_read_b64_tr_b16 v[44:45], v5 offset:8704
    v_mfma_f32_16x16x32_bf16 v[68:71], v[28:31], v[180:183], v[68:71]
    s_add_u32 s56, s56, s83
    ds_read_b64_tr_b16 v[46:47], v5 offset:10752
    s_waitcnt lgkmcnt(4)
    v_mfma_f32_16x16x32_bf16 v[72:75], v[32:35], v[168:171], v[72:75]
    s_add_u32 m0, s42, 131072
    ds_read_b64_tr_b16 v[24:25], v101 offset:512
    buffer_load_dwordx4 v7, s[12:15], s56 offen lds
    v_mfma_f32_16x16x32_bf16 v[72:75], v[36:39], v[176:179], v[72:75]
    s_add_u32 s56, s71, 0
    ds_read_b64_tr_b16 v[26:27], v101 offset:2560
    s_add_u32 s63, s73, 49152
    buffer_load_dwordx4 v[220:223], v100, s[16:19], s63 offen offset:1024 sc1
    v_mfma_f32_16x16x32_bf16 v[76:79], v[32:35], v[172:175], v[76:79]
    s_add_u32 s57, s68, 73728
    ds_read_b64_tr_b16 v[28:29], v101 offset:8704
    v_mfma_f32_16x16x32_bf16 v[76:79], v[36:39], v[180:183], v[76:79]
    s_cmp_ge_u32 s37, 2
    s_cselect_b32 s56, s57, s56
    ds_read_b64_tr_b16 v[30:31], v101 offset:10752
    s_setprio 2
    s_waitcnt lgkmcnt(4)
    v_mfma_f32_16x16x32_bf16 v[104:107], v[40:43], v[168:171], v[104:107]
    s_add_u32 s56, s56, s83
    v_add_u32 v102, 0xfffee000, v102
    ds_read_b64_tr_b16 v[32:33], v102 offset:0
    v_mfma_f32_16x16x32_bf16 v[104:107], v[44:47], v[176:179], v[104:107]
    ds_read_b64_tr_b16 v[34:35], v102 offset:1024
    v_mfma_f32_16x16x32_bf16 v[108:111], v[40:43], v[172:175], v[108:111]
    ds_read_b64_tr_b16 v[36:37], v102 offset:2048
    s_add_u32 s63, s74, 49152
    buffer_load_dwordx4 v[224:227], v100, s[16:19], s63 offen offset:0 sc1
    v_mfma_f32_16x16x32_bf16 v[108:111], v[44:47], v[180:183], v[108:111]
    ds_read_b64_tr_b16 v[38:39], v102 offset:3072
    s_setprio 1
    s_waitcnt lgkmcnt(4)
    v_mfma_f32_16x16x32_bf16 v[248:251], v[24:27], v[168:171], v[248:251]
    v_add_u32 v103, 0xfffee000, v103
    ds_read_b64_tr_b16 v[40:41], v103 offset:0
    v_mfma_f32_16x16x32_bf16 v[248:251], v[28:31], v[176:179], v[248:251]
    s_add_u32 m0, s42, 139264
    ds_read_b64_tr_b16 v[42:43], v103 offset:1024
    buffer_load_dwordx4 v7, s[12:15], s56 offen lds
    v_mfma_f32_16x16x32_bf16 v[252:255], v[24:27], v[172:175], v[252:255]
    s_add_u32 s56, s69, 73728
    ds_read_b64_tr_b16 v[44:45], v103 offset:2048
    v_mfma_f32_16x16x32_bf16 v[252:255], v[28:31], v[180:183], v[252:255]
    s_add_u32 s57, s70, 73728
    ds_read_b64_tr_b16 v[46:47], v103 offset:3072
    s_add_u32 s63, s74, 49152
    buffer_load_dwordx4 v[228:231], v100, s[16:19], s63 offen offset:1024 sc1
    s_waitcnt lgkmcnt(4)
    v_mfma_f32_16x16x32_bf16 v[88:91], v[32:35], v[168:171], v[88:91]
    s_cmp_ge_u32 s37, 2
    s_cselect_b32 s56, s57, s56
    ds_read_b64_tr_b16 v[24:25], v5 offset:24576
    v_mfma_f32_16x16x32_bf16 v[88:91], v[36:39], v[176:179], v[88:91]
    s_add_u32 s56, s56, s83
    ds_read_b64_tr_b16 v[26:27], v5 offset:26624
    v_mfma_f32_16x16x32_bf16 v[92:95], v[32:35], v[172:175], v[92:95]
    ds_read_b64_tr_b16 v[28:29], v5 offset:32768
    v_mfma_f32_16x16x32_bf16 v[92:95], v[36:39], v[180:183], v[92:95]
    ds_read_b64_tr_b16 v[30:31], v5 offset:34816
    s_setprio 0
    s_waitcnt lgkmcnt(4)
    v_mfma_f32_16x16x32_bf16 v[48:51], v[40:43], v[168:171], v[48:51]
    ds_read_b64_tr_b16 v[32:33], v101 offset:24576
    s_add_u32 s63, s75, 49152
    buffer_load_dwordx4 v[232:235], v100, s[16:19], s63 offen offset:0 sc1
    v_mfma_f32_16x16x32_bf16 v[48:51], v[44:47], v[176:179], v[48:51]
    ds_read_b64_tr_b16 v[34:35], v101 offset:26624
    v_mfma_f32_16x16x32_bf16 v[52:55], v[40:43], v[172:175], v[52:55]
    s_add_u32 m0, s42, 147456
    ds_read_b64_tr_b16 v[36:37], v101 offset:32768
    buffer_load_dwordx4 v7, s[12:15], s56 offen lds
    v_mfma_f32_16x16x32_bf16 v[52:55], v[44:47], v[180:183], v[52:55]
    ds_read_b64_tr_b16 v[38:39], v101 offset:34816
    s_barrier
    s_setprio 3
    s_waitcnt lgkmcnt(4)
    v_mfma_f32_16x16x32_bf16 v[64:67], v[24:27], v[184:187], v[64:67]
    s_add_u32 s56, s71, 73728
    ds_read_b64_tr_b16 v[40:41], v5 offset:25088
    v_mfma_f32_16x16x32_bf16 v[64:67], v[28:31], v[192:195], v[64:67]
    s_add_u32 s57, s68, 294912
    ds_read_b64_tr_b16 v[42:43], v5 offset:27136
    s_add_u32 s63, s75, 49152
    buffer_load_dwordx4 v[236:239], v100, s[16:19], s63 offen offset:1024 sc1
    v_mfma_f32_16x16x32_bf16 v[68:71], v[24:27], v[188:191], v[68:71]
    s_cmp_ge_u32 s37, 2
    s_cselect_b32 s56, s57, s56
    ds_read_b64_tr_b16 v[44:45], v5 offset:33280
    s_waitcnt vmcnt(20)
    v_mfma_f32_16x16x32_bf16 v[68:71], v[28:31], v[196:199], v[68:71]
    s_add_u32 s56, s56, s83
    ds_read_b64_tr_b16 v[46:47], v5 offset:35328
    s_waitcnt lgkmcnt(4)
    v_mfma_f32_16x16x32_bf16 v[72:75], v[32:35], v[184:187], v[72:75]
    ds_read_b64_tr_b16 v[24:25], v101 offset:25088
    v_mfma_f32_16x16x32_bf16 v[72:75], v[36:39], v[192:195], v[72:75]
    ds_read_b64_tr_b16 v[26:27], v101 offset:27136
    v_mfma_f32_16x16x32_bf16 v[76:79], v[32:35], v[188:191], v[76:79]
    s_add_u32 m0, s42, 8192
    ds_read_b64_tr_b16 v[28:29], v101 offset:33280
    buffer_load_dwordx4 v7, s[12:15], s56 offen lds
    v_mfma_f32_16x16x32_bf16 v[76:79], v[36:39], v[196:199], v[76:79]
    s_add_u32 s56, s68, 147456
    ds_read_b64_tr_b16 v[30:31], v101 offset:35328
    s_setprio 2
    s_waitcnt lgkmcnt(4)
    v_mfma_f32_16x16x32_bf16 v[104:107], v[40:43], v[184:187], v[104:107]
    s_add_u32 s57, s69, 147456
    ds_read_b64_tr_b16 v[32:33], v102 offset:24576
    v_mfma_f32_16x16x32_bf16 v[104:107], v[44:47], v[192:195], v[104:107]
    s_cmp_ge_u32 s37, 2
    s_cselect_b32 s56, s57, s56
    ds_read_b64_tr_b16 v[34:35], v102 offset:25600
    v_mfma_f32_16x16x32_bf16 v[108:111], v[40:43], v[188:191], v[108:111]
    s_add_u32 s56, s56, s83
    ds_read_b64_tr_b16 v[36:37], v102 offset:26624
    v_mfma_f32_16x16x32_bf16 v[108:111], v[44:47], v[196:199], v[108:111]
    ds_read_b64_tr_b16 v[38:39], v102 offset:27648
    s_setprio 1
    s_waitcnt lgkmcnt(4)
    v_mfma_f32_16x16x32_bf16 v[248:251], v[24:27], v[184:187], v[248:251]
    ds_read_b64_tr_b16 v[40:41], v103 offset:24576
    v_mfma_f32_16x16x32_bf16 v[248:251], v[28:31], v[192:195], v[248:251]
    s_add_u32 m0, s42, 16384
    ds_read_b64_tr_b16 v[42:43], v103 offset:25600
    buffer_load_dwordx4 v7, s[12:15], s56 offen lds
    v_mfma_f32_16x16x32_bf16 v[252:255], v[24:27], v[188:191], v[252:255]
    ds_read_b64_tr_b16 v[44:45], v103 offset:26624
    v_mfma_f32_16x16x32_bf16 v[252:255], v[28:31], v[196:199], v[252:255]
    ds_read_b64_tr_b16 v[46:47], v103 offset:27648
    s_waitcnt lgkmcnt(4)
    v_mfma_f32_16x16x32_bf16 v[88:91], v[32:35], v[184:187], v[88:91]
    ds_read_b64_tr_b16 v[24:25], v5 offset:49152
    v_mfma_f32_16x16x32_bf16 v[88:91], v[36:39], v[192:195], v[88:91]
    ds_read_b64_tr_b16 v[26:27], v5 offset:51200
    v_mfma_f32_16x16x32_bf16 v[92:95], v[32:35], v[188:191], v[92:95]
    ds_read_b64_tr_b16 v[28:29], v5 offset:57344
    v_mfma_f32_16x16x32_bf16 v[92:95], v[36:39], v[196:199], v[92:95]
    ds_read_b64_tr_b16 v[30:31], v5 offset:59392
    s_setprio 0
    s_waitcnt lgkmcnt(4)
    v_mfma_f32_16x16x32_bf16 v[48:51], v[40:43], v[184:187], v[48:51]
    ds_read_b64_tr_b16 v[32:33], v101 offset:49152
    v_mfma_f32_16x16x32_bf16 v[48:51], v[44:47], v[192:195], v[48:51]
    ds_read_b64_tr_b16 v[34:35], v101 offset:51200
    v_mfma_f32_16x16x32_bf16 v[52:55], v[40:43], v[188:191], v[52:55]
    ds_read_b64_tr_b16 v[36:37], v101 offset:57344
    v_mfma_f32_16x16x32_bf16 v[52:55], v[44:47], v[196:199], v[52:55]
    ds_read_b64_tr_b16 v[38:39], v101 offset:59392
    s_waitcnt vmcnt(16)
    s_barrier
    s_setprio 3
    s_waitcnt lgkmcnt(4)
    v_mfma_f32_16x16x32_bf16 v[64:67], v[24:27], v[200:203], v[64:67]
    s_cmp_eq_u32 s36, 0
    s_cbranch_scc0 LB_dw42
    v_and_b32 v22, 3, v0
    v_lshlrev_b32 v22, 3, v22
    buffer_load_dwordx2 v[22:23], v22, s[16:19], s2 offen sc1
LB_dw42:
    s_add_u32 s56, s70, 147456
    ds_read_b64_tr_b16 v[40:41], v5 offset:49664
    v_mfma_f32_16x16x32_bf16 v[64:67], v[28:31], v[208:211], v[64:67]
    s_add_u32 s57, s71, 147456
    ds_read_b64_tr_b16 v[42:43], v5 offset:51712
    v_mfma_f32_16x16x32_bf16 v[68:71], v[24:27], v[204:207], v[68:71]
    s_cmp_ge_u32 s37, 2
    s_cselect_b32 s56, s57, s56
    ds_read_b64_tr_b16 v[44:45], v5 offset:57856
    s_waitcnt vmcnt(15)
    v_mfma_f32_16x16x32_bf16 v[68:71], v[28:31], v[212:215], v[68:71]
    s_add_u32 s56, s56, s83
    ds_read_b64_tr_b16 v[46:47], v5 offset:59904
    s_waitcnt lgkmcnt(4)
    v_mfma_f32_16x16x32_bf16 v[72:75], v[32:35], v[200:203], v[72:75]
    s_add_u32 m0, s42, 49152
    ds_read_b64_tr_b16 v[24:25], v101 offset:49664
    buffer_load_dwordx4 v7, s[12:15], s56 offen lds
    v_mfma_f32_16x16x32_bf16 v[72:75], v[36:39], v[208:211], v[72:75]
    ds_read_b64_tr_b16 v[26:27], v101 offset:51712
    v_mfma_f32_16x16x32_bf16 v[76:79], v[32:35], v[204:207], v[76:79]
    ds_read_b64_tr_b16 v[28:29], v101 offset:57856
    v_mfma_f32_16x16x32_bf16 v[76:79], v[36:39], v[212:215], v[76:79]
    ds_read_b64_tr_b16 v[30:31], v101 offset:59904
    s_setprio 2
    s_waitcnt lgkmcnt(4)
    v_mfma_f32_16x16x32_bf16 v[104:107], v[40:43], v[200:203], v[104:107]
    ds_read_b64_tr_b16 v[32:33], v102 offset:49152
    v_mfma_f32_16x16x32_bf16 v[104:107], v[44:47], v[208:211], v[104:107]
    ds_read_b64_tr_b16 v[34:35], v102 offset:50176
    v_mfma_f32_16x16x32_bf16 v[108:111], v[40:43], v[204:207], v[108:111]
    ds_read_b64_tr_b16 v[36:37], v102 offset:51200
    v_mfma_f32_16x16x32_bf16 v[108:111], v[44:47], v[212:215], v[108:111]
    ds_read_b64_tr_b16 v[38:39], v102 offset:52224
    s_setprio 1
    s_waitcnt lgkmcnt(4)
    v_mfma_f32_16x16x32_bf16 v[248:251], v[24:27], v[200:203], v[248:251]
    ds_read_b64_tr_b16 v[40:41], v103 offset:49152
    v_mfma_f32_16x16x32_bf16 v[248:251], v[28:31], v[208:211], v[248:251]
    ds_read_b64_tr_b16 v[42:43], v103 offset:50176
    v_mfma_f32_16x16x32_bf16 v[252:255], v[24:27], v[204:207], v[252:255]
    ds_read_b64_tr_b16 v[44:45], v103 offset:51200
    v_mfma_f32_16x16x32_bf16 v[252:255], v[28:31], v[212:215], v[252:255]
    ds_read_b64_tr_b16 v[46:47], v103 offset:52224
    s_waitcnt lgkmcnt(4)
    v_mfma_f32_16x16x32_bf16 v[88:91], v[32:35], v[200:203], v[88:91]
    v_add_u32 v5, 0x24000, v5
    ds_read_b64_tr_b16 v[24:25], v5 offset:0
    v_mfma_f32_16x16x32_bf16 v[88:91], v[36:39], v[208:211], v[88:91]
    ds_read_b64_tr_b16 v[26:27], v5 offset:2048
    v_mfma_f32_16x16x32_bf16 v[92:95], v[32:35], v[204:207], v[92:95]
    v_add_u32 v5, 0xfffee000, v5
    ds_read_b64_tr_b16 v[28:29], v5 offset:0
    v_mfma_f32_16x16x32_bf16 v[92:95], v[36:39], v[212:215], v[92:95]
    ds_read_b64_tr_b16 v[30:31], v5 offset:2048
    s_setprio 0
    s_waitcnt lgkmcnt(4)
    v_mfma_f32_16x16x32_bf16 v[48:51], v[40:43], v[200:203], v[48:51]
    v_add_u32 v101, 0x24000, v101
    ds_read_b64_tr_b16 v[32:33], v101 offset:0
    v_mfma_f32_16x16x32_bf16 v[48:51], v[44:47], v[208:211], v[48:51]
    ds_read_b64_tr_b16 v[34:35], v101 offset:2048
    v_mfma_f32_16x16x32_bf16 v[52:55], v[40:43], v[204:207], v[52:55]
    v_add_u32 v101, 0xfffee000, v101
    ds_read_b64_tr_b16 v[36:37], v101 offset:0
    v_mfma_f32_16x16x32_bf16 v[52:55], v[44:47], v[212:215], v[52:55]
    ds_read_b64_tr_b16 v[38:39], v101 offset:2048
    s_cmp_eq_u32 s36, 0
    s_cbranch_scc0 LB_dw45
    s_waitcnt vmcnt(1)
    s_add_u32 s62, s96, 5
    v_subrev_u32 v22, s62, v22
    v_cmp_ne_u32 s[58:59], s97, v23
    v_cmp_lt_u32 s[60:61], 10, v22
    s_lshl_b32 s62, 1, s41
    s_andn2_b32 s62, 15, s62
    s_nop 0
    s_or_b32 s60, s60, s58
    s_and_b32 s60, s60, s62
    s_cbranch_scc0 LB_ok43
    s_mov_b32 s78, 200000
LB_sp44:
    s_sleep 1
    v_and_b32 v22, 3, v0
    v_lshlrev_b32 v22, 3, v22
    buffer_load_dwordx2 v[22:23], v22, s[16:19], s2 offen sc1
    s_waitcnt vmcnt(0)
    s_add_u32 s62, s96, 5
    v_subrev_u32 v22, s62, v22
    v_cmp_ne_u32 s[58:59], s97, v23
    v_cmp_lt_u32 s[60:61], 10, v22
    s_lshl_b32 s62, 1, s41
    s_andn2_b32 s62, 15, s62
    s_nop 0
    s_or_b32 s60, s60, s58
    s_and_b32 s60, s60, s62
    s_cbranch_scc0 LB_ok43
    s_sub_u32 s78, s78, 1
    s_cmp_lg_u32 s78, 0
    s_cbranch_scc1 LB_sp44
LB_ok43:
    s_nop 1
LB_dw45:
    s_waitcnt vmcnt(13)
    s_barrier
    s_setprio 3
    s_waitcnt lgkmcnt(4)
    s_waitcnt vmcnt(11)
    v_mfma_f32_16x16x32_bf16 v[64:67], v[24:27], v[216:219], v[64:67]
    s_add_u32 s56, s69, 221184
    v_add_u32 v5, 0x12000, v5
    ds_read_b64_tr_b16 v[40:41], v5 offset:512
    s_add_u32 s63, s73, 65536
    buffer_load_dwordx4 v[240:243], v100, s[16:19], s63 offen offset:0 sc1
    s_waitcnt vmcnt(9)
    v_mfma_f32_16x16x32_bf16 v[64:67], v[28:31], v[224:227], v[64:67]
    s_add_u32 s57, s70, 221184
    ds_read_b64_tr_b16 v[42:43], v5 offset:2560
    v_mfma_f32_16x16x32_bf16 v[68:71], v[24:27], v[220:223], v[68:71]
    s_cmp_ge_u32 s37, 2
    s_cselect_b32 s56, s57, s56
    v_add_u32 v5, 0xfffee000, v5
    ds_read_b64_tr_b16 v[44:45], v5 offset:512
    s_waitcnt vmcnt(7)
    v_mfma_f32_16x16x32_bf16 v[68:71], v[28:31], v[228:231], v[68:71]
    s_add_u32 s56, s56, s83
    ds_read_b64_tr_b16 v[46:47], v5 offset:2560
    s_waitcnt lgkmcnt(4)
    v_mfma_f32_16x16x32_bf16 v[72:75], v[32:35], v[216:219], v[72:75]
    s_add_u32 m0, s42, 57344
    v_add_u32 v101, 0x12000, v101
    ds_read_b64_tr_b16 v[24:25], v101 offset:512
    buffer_load_dwordx4 v7, s[12:15], s56 offen lds
    v_mfma_f32_16x16x32_bf16 v[72:75], v[36:39], v[224:227], v[72:75]
    s_add_u32 s56, s71, 221184
    ds_read_b64_tr_b16 v[26:27], v101 offset:2560
    s_add_u32 s63, s73, 65536
    buffer_load_dwordx4 v[244:247], v100, s[16:19], s63 offen offset:1024 sc1
    v_mfma_f32_16x16x32_bf16 v[76:79], v[32:35], v[220:223], v[76:79]
    s_add_u32 s57, s69, 294912
    v_add_u32 v101, 0xfffee000, v101
    ds_read_b64_tr_b16 v[28:29], v101 offset:512
    v_mfma_f32_16x16x32_bf16 v[76:79], v[36:39], v[228:231], v[76:79]
    s_cmp_ge_u32 s37, 2
    s_cselect_b32 s56, s57, s56
    ds_read_b64_tr_b16 v[30:31], v101 offset:2560
    s_setprio 2
    s_waitcnt lgkmcnt(4)
    v_mfma_f32_16x16x32_bf16 v[104:107], v[40:43], v[216:219], v[104:107]
    s_add_u32 s56, s56, s83
    v_add_u32 v102, 0x10000, v102
    ds_read_b64_tr_b16 v[32:33], v102 offset:0
    v_mfma_f32_16x16x32_bf16 v[104:107], v[44:47], v[224:227], v[104:107]
    ds_read_b64_tr_b16 v[34:35], v102 offset:1024
    v_mfma_f32_16x16x32_bf16 v[108:111], v[40:43], v[220:223], v[108:111]
    ds_read_b64_tr_b16 v[36:37], v102 offset:2048
    v_mfma_f32_16x16x32_bf16 v[108:111], v[44:47], v[228:231], v[108:111]
    ds_read_b64_tr_b16 v[38:39], v102 offset:3072
    s_setprio 1
    s_waitcnt lgkmcnt(4)
    v_mfma_f32_16x16x32_bf16 v[248:251], v[24:27], v[216:219], v[248:251]
    s_add_u32 m0, s42, 65536
    v_add_u32 v103, 0x10000, v103
    ds_read_b64_tr_b16 v[40:41], v103 offset:0
    buffer_load_dwordx4 v7, s[12:15], s56 offen lds
    v_mfma_f32_16x16x32_bf16 v[248:251], v[28:31], v[224:227], v[248:251]
    ds_read_b64_tr_b16 v[42:43], v103 offset:1024
    v_mfma_f32_16x16x32_bf16 v[252:255], v[24:27], v[220:223], v[252:255]
    ds_read_b64_tr_b16 v[44:45], v103 offset:2048
    v_mfma_f32_16x16x32_bf16 v[252:255], v[28:31], v[228:231], v[252:255]
    ds_read_b64_tr_b16 v[46:47], v103 offset:3072
    s_waitcnt lgkmcnt(4)
    v_mfma_f32_16x16x32_bf16 v[88:91], v[32:35], v[216:219], v[88:91]
    ds_read_b64_tr_b16 v[24:25], v101 offset:16384
    v_mfma_f32_16x16x32_bf16 v[88:91], v[36:39], v[224:227], v[88:91]
    ds_read_b64_tr_b16 v[26:27], v101 offset:18432
    v_mfma_f32_16x16x32_bf16 v[92:95], v[32:35], v[220:223], v[92:95]
    ds_read_b64_tr_b16 v[28:29], v101 offset:24576
    v_mfma_f32_16x16x32_bf16 v[92:95], v[36:39], v[228:231], v[92:95]
    ds_read_b64_tr_b16 v[30:31], v101 offset:26624
    s_setprio 0
    s_waitcnt lgkmcnt(4)
    v_mfma_f32_16x16x32_bf16 v[48:51], v[40:43], v[216:219], v[48:51]
    ds_read_b64_tr_b16 v[32:33], v101 offset:16896
    v_mfma_f32_16x16x32_bf16 v[48:51], v[44:47], v[224:227], v[48:51]
    ds_read_b64_tr_b16 v[34:35], v101 offset:18944
    v_mfma_f32_16x16x32_bf16 v[52:55], v[40:43], v[220:223], v[52:55]
    ds_read_b64_tr_b16 v[36:37], v101 offset:25088
    v_mfma_f32_16x16x32_bf16 v[52:55], v[44:47], v[228:231], v[52:55]
    ds_read_b64_tr_b16 v[38:39], v101 offset:27136
    s_barrier
    s_setprio 3
    s_waitcnt lgkmcnt(4)
    s_waitcnt vmcnt(9)
    v_mfma_f32_16x16x32_bf16 v[72:75], v[24:27], v[232:235], v[72:75]
    ds_read_b64_tr_b16 v[40:41], v103 offset:24576
    s_waitcnt vmcnt(3)
    v_mfma_f32_16x16x32_bf16 v[72:75], v[28:31], v[240:243], v[72:75]
    ds_read_b64_tr_b16 v[42:43], v103 offset:25600
    v_mfma_f32_16x16x32_bf16 v[76:79], v[24:27], v[236:239], v[76:79]
    ds_read_b64_tr_b16 v[44:45], v103 offset:26624
    s_waitcnt vmcnt(1)
    v_mfma_f32_16x16x32_bf16 v[76:79], v[28:31], v[244:247], v[76:79]
    ds_read_b64_tr_b16 v[46:47], v103 offset:27648
    v_add_u32 v1, s42, v100
    v_xor_b32 v4, 0x1000, v1
    s_waitcnt lgkmcnt(4)
    v_mfma_f32_16x16x32_bf16 v[248:251], v[32:35], v[232:235], v[248:251]
    ds_read_b64_tr_b16 v[24:25], v5 offset:16384
    v_mfma_f32_16x16x32_bf16 v[248:251], v[36:39], v[240:243], v[248:251]
    ds_read_b64_tr_b16 v[26:27], v5 offset:18432
    v_mfma_f32_16x16x32_bf16 v[252:255], v[32:35], v[236:239], v[252:255]
    ds_read_b64_tr_b16 v[28:29], v5 offset:24576
    v_mfma_f32_16x16x32_bf16 v[252:255], v[36:39], v[244:247], v[252:255]
    v_cvt_pk_bf16_f32 v72, v72, v73
    v_cvt_pk_bf16_f32 v73, v74, v75
    v_cvt_pk_bf16_f32 v74, v76, v77
    v_cvt_pk_bf16_f32 v75, v78, v79
    ds_write_b128 v1, v[72:75] offset:24576
    ds_read_b64_tr_b16 v[30:31], v5 offset:26624
    s_setprio 2
    s_waitcnt lgkmcnt(5)
    v_mfma_f32_16x16x32_bf16 v[48:51], v[40:43], v[232:235], v[48:51]
    ds_read_b64_tr_b16 v[32:33], v5 offset:16896
    v_mfma_f32_16x16x32_bf16 v[48:51], v[44:47], v[240:243], v[48:51]
    ds_read_b64_tr_b16 v[34:35], v5 offset:18944
    v_mfma_f32_16x16x32_bf16 v[52:55], v[40:43], v[236:239], v[52:55]
    ds_read_b64_tr_b16 v[36:37], v5 offset:25088
    v_mfma_f32_16x16x32_bf16 v[52:55], v[44:47], v[244:247], v[52:55]
    v_cvt_pk_bf16_f32 v248, v248, v249
    v_cvt_pk_bf16_f32 v249, v250, v251
    v_cvt_pk_bf16_f32 v250, v252, v253
    v_cvt_pk_bf16_f32 v251, v254, v255
    ds_write_b128 v1, v[248:251] offset:32768
    ds_read_b64_tr_b16 v[38:39], v5 offset:27136
    s_setprio 1
    s_waitcnt lgkmcnt(5)
    v_mfma_f32_16x16x32_bf16 v[64:67], v[24:27], v[232:235], v[64:67]
    ds_read_b64_tr_b16 v[40:41], v102 offset:24576
    v_mfma_f32_16x16x32_bf16 v[64:67], v[28:31], v[240:243], v[64:67]
    ds_read_b64_tr_b16 v[42:43], v102 offset:25600
    v_mfma_f32_16x16x32_bf16 v[68:71], v[24:27], v[236:239], v[68:71]
    ds_read_b64_tr_b16 v[44:45], v102 offset:26624
    v_mfma_f32_16x16x32_bf16 v[68:71], v[28:31], v[244:247], v[68:71]
    v_cvt_pk_bf16_f32 v48, v48, v49
    v_cvt_pk_bf16_f32 v49, v50, v51
    v_cvt_pk_bf16_f32 v50, v52, v53
    v_cvt_pk_bf16_f32 v51, v54, v55
    ds_write_b128 v1, v[48:51] offset:40960
    ds_read_b64_tr_b16 v[46:47], v102 offset:27648
    s_waitcnt lgkmcnt(5)
    v_mfma_f32_16x16x32_bf16 v[104:107], v[32:35], v[232:235], v[104:107]
    ds_read_b64_tr_b16 v[24:25], v102 offset:32768
    v_mfma_f32_16x16x32_bf16 v[104:107], v[36:39], v[240:243], v[104:107]
    ds_read_b64_tr_b16 v[26:27], v102 offset:33792
    v_mfma_f32_16x16x32_bf16 v[108:111], v[32:35], v[236:239], v[108:111]
    ds_read_b64_tr_b16 v[28:29], v102 offset:34816
    v_mfma_f32_16x16x32_bf16 v[108:111], v[36:39], v[244:247], v[108:111]
    ds_read_b64_tr_b16 v[30:31], v102 offset:35840
    s_setprio 0
    s_waitcnt lgkmcnt(4)
    v_mfma_f32_16x16x32_bf16 v[88:91], v[40:43], v[232:235], v[88:91]
    ds_read_b64_tr_b16 v[32:33], v103 offset:32768
    v_mfma_f32_16x16x32_bf16 v[88:91], v[44:47], v[240:243], v[88:91]
    ds_read_b64_tr_b16 v[34:35], v103 offset:33792
    v_mfma_f32_16x16x32_bf16 v[92:95], v[40:43], v[236:239], v[92:95]
    ds_read_b64_tr_b16 v[36:37], v103 offset:34816
    v_mfma_f32_16x16x32_bf16 v[92:95], v[44:47], v[244:247], v[92:95]
    ds_read_b64_tr_b16 v[38:39], v103 offset:35840
    s_barrier
    s_setprio 3
    s_waitcnt lgkmcnt(4)
    v_mfma_f32_16x16x32_bf16 v[72:75], v[24:27], v[80:83], 0
    ds_read_b128 v[12:15], v4 offset:24576
    ds_read_b128 v[16:19], v4 offset:32768
    ds_read_b64_tr_b16 v[40:41], v102 offset:40960
    v_mfma_f32_16x16x32_bf16 v[72:75], v[28:31], v[112:115], v[72:75]
    ds_read_b128 v[48:51], v4 offset:40960
    v_lshlrev_b32 v23, 2, v0
    ds_read_b64_tr_b16 v[42:43], v102 offset:41984
    v_mfma_f32_16x16x32_bf16 v[76:79], v[24:27], v[84:87], 0
    ds_read_b64_tr_b16 v[44:45], v102 offset:43008
    v_mfma_f32_16x16x32_bf16 v[76:79], v[28:31], v[116:119], v[76:79]
    s_waitcnt lgkmcnt(5)
    v_lshlrev_b32 v20, 16, v12
    v_and_b32 v21, 0xffff0000, v12
    v_add_f32 v64, v64, v20
    v_add_f32 v65, v65, v21
    v_lshlrev_b32 v20, 16, v13
    v_and_b32 v21, 0xffff0000, v13
    ds_read_b64_tr_b16 v[46:47], v102 offset:44032
    v_mfma_f32_16x16x32_bf16 v[248:251], v[32:35], v[80:83], 0
    v_add_f32 v66, v66, v20
    v_add_f32 v67, v67, v21
    v_cvt_pk_bf16_f32 v64, v64, v65
    v_cvt_pk_bf16_f32 v65, v66, v67
    v_lshlrev_b32 v20, 16, v14
    ds_read_b64_tr_b16 v[24:25], v103 offset:40960
    v_mfma_f32_16x16x32_bf16 v[248:251], v[36:39], v[112:115], v[248:251]
    v_and_b32 v21, 0xffff0000, v14
    v_add_f32 v68, v68, v20
    v_add_f32 v69, v69, v21
    v_lshlrev_b32 v20, 16, v15
    v_and_b32 v21, 0xffff0000, v15
    ds_read_b64_tr_b16 v[26:27], v103 offset:41984
    v_mfma_f32_16x16x32_bf16 v[252:255], v[32:35], v[84:87], 0
    v_add_f32 v70, v70, v20
    v_add_f32 v71, v71, v21
    v_cvt_pk_bf16_f32 v66, v68, v69
    v_cvt_pk_bf16_f32 v67, v70, v71
    v_bitop3_b32 v68, v64, v65, v66 bitop3:0x96
    ds_read_b64_tr_b16 v[28:29], v103 offset:43008
    v_mfma_f32_16x16x32_bf16 v[252:255], v[36:39], v[116:119], v[252:255]
    v_bitop3_b32 v68, v68, v67, s96 bitop3:0x96
    s_and_b32 s62, s40, 2
    s_xor_b32 s62, s62, 2
    s_lshl4_add_u32 s62, s62, s40
    s_lshl_b32 s62, s62, 12
    s_add_u32 s62, s62, s76
    buffer_store_dwordx4 v[64:67], v100, s[16:19], s62 offen sc1
    buffer_store_dword v68, v23, s[16:19], s62 offen offset:1024 sc1
    s_waitcnt lgkmcnt(8)
    v_lshlrev_b32 v20, 16, v16
    v_and_b32 v21, 0xffff0000, v16
    v_add_f32 v104, v104, v20
    v_add_f32 v105, v105, v21
    ds_read_b64_tr_b16 v[30:31], v103 offset:44032
    s_setprio 2
    s_waitcnt lgkmcnt(4)
    v_mfma_f32_16x16x32_bf16 v[72:75], v[40:43], v[120:123], v[72:75]
    v_lshlrev_b32 v20, 16, v17
    v_and_b32 v21, 0xffff0000, v17
    v_add_f32 v106, v106, v20
    v_add_f32 v107, v107, v21
    v_cvt_pk_bf16_f32 v104, v104, v105
    ds_read_b64_tr_b16 v[32:33], v102 offset:49152
    v_mfma_f32_16x16x32_bf16 v[72:75], v[44:47], v[128:131], v[72:75]
    v_cvt_pk_bf16_f32 v105, v106, v107
    v_lshlrev_b32 v20, 16, v18
    v_and_b32 v21, 0xffff0000, v18
    v_add_f32 v108, v108, v20
    v_add_f32 v109, v109, v21
    ds_read_b64_tr_b16 v[34:35], v102 offset:50176
    v_mfma_f32_16x16x32_bf16 v[76:79], v[40:43], v[124:127], v[76:79]
    v_lshlrev_b32 v20, 16, v19
    v_and_b32 v21, 0xffff0000, v19
    v_add_f32 v110, v110, v20
    v_add_f32 v111, v111, v21
    v_cvt_pk_bf16_f32 v106, v108, v109
    ds_read_b64_tr_b16 v[36:37], v102 offset:51200
    v_mfma_f32_16x16x32_bf16 v[76:79], v[44:47], v[132:135], v[76:79]
    v_cvt_pk_bf16_f32 v107, v110, v111
    v_bitop3_b32 v108, v104, v105, v106 bitop3:0x96
    v_bitop3_b32 v108, v108, v107, s96 bitop3:0x96
    s_and_b32 s62, s40, 2
    s_xor_b32 s62, s62, 3
    s_lshl4_add_u32 s62, s62, s40
    s_lshl_b32 s62, s62, 12
    s_add_u32 s62, s62, s76
    buffer_store_dwordx4 v[104:107], v100, s[16:19], s62 offen sc1
    buffer_store_dword v108, v23, s[16:19], s62 offen offset:1024 sc1
    v_lshlrev_b32 v20, 16, v48
    v_and_b32 v21, 0xffff0000, v48
    ds_read_b64_tr_b16 v[38:39], v102 offset:52224
    s_setprio 1
    s_waitcnt lgkmcnt(4)
    v_mfma_f32_16x16x32_bf16 v[248:251], v[24:27], v[120:123], v[248:251]
    v_add_f32 v88, v88, v20
    v_add_f32 v89, v89, v21
    v_lshlrev_b32 v20, 16, v49
    v_and_b32 v21, 0xffff0000, v49
    v_add_f32 v90, v90, v20
    ds_read_b64_tr_b16 v[40:41], v103 offset:49152
    v_mfma_f32_16x16x32_bf16 v[248:251], v[28:31], v[128:131], v[248:251]
    v_add_f32 v91, v91, v21
    v_cvt_pk_bf16_f32 v88, v88, v89
    v_cvt_pk_bf16_f32 v89, v90, v91
    v_lshlrev_b32 v20, 16, v50
    v_and_b32 v21, 0xffff0000, v50
    ds_read_b64_tr_b16 v[42:43], v103 offset:50176
    v_mfma_f32_16x16x32_bf16 v[252:255], v[24:27], v[124:127], v[252:255]
    v_add_f32 v92, v92, v20
    v_add_f32 v93, v93, v21
    v_lshlrev_b32 v20, 16, v51
    v_and_b32 v21, 0xffff0000, v51
    v_add_f32 v94, v94, v20
    ds_read_b64_tr_b16 v[44:45], v103 offset:51200
    v_mfma_f32_16x16x32_bf16 v[252:255], v[28:31], v[132:135], v[252:255]
    v_add_f32 v95, v95, v21
    v_cvt_pk_bf16_f32 v90, v92, v93
    v_cvt_pk_bf16_f32 v91, v94, v95
    v_bitop3_b32 v92, v88, v89, v90 bitop3:0x96
    v_bitop3_b32 v92, v92, v91, s96 bitop3:0x96
    s_xor_b32 s62, s40, 1
    s_lshl4_add_u32 s62, s62, s40
    s_lshl_b32 s62, s62, 12
    s_add_u32 s62, s62, s76
    buffer_store_dwordx4 v[88:91], v100, s[16:19], s62 offen sc1
    buffer_store_dword v92, v23, s[16:19], s62 offen offset:1024 sc1
    ds_read_b64_tr_b16 v[46:47], v103 offset:52224
    s_waitcnt lgkmcnt(4)
    v_mfma_f32_16x16x32_bf16 v[72:75], v[32:35], v[136:139], v[72:75]
    ds_read_b64_tr_b16 v[24:25], v102 offset:57344
    v_mfma_f32_16x16x32_bf16 v[72:75], v[36:39], v[144:147], v[72:75]
    ds_read_b64_tr_b16 v[26:27], v102 offset:58368
    v_mfma_f32_16x16x32_bf16 v[76:79], v[32:35], v[140:143], v[76:79]
    ds_read_b64_tr_b16 v[28:29], v102 offset:59392
    v_mfma_f32_16x16x32_bf16 v[76:79], v[36:39], v[148:151], v[76:79]
    ds_read_b64_tr_b16 v[30:31], v102 offset:60416
    s_setprio 0
    s_waitcnt lgkmcnt(4)
    v_mfma_f32_16x16x32_bf16 v[248:251], v[40:43], v[136:139], v[248:251]
    ds_read_b64_tr_b16 v[32:33], v103 offset:57344
    v_mfma_f32_16x16x32_bf16 v[248:251], v[44:47], v[144:147], v[248:251]
    ds_read_b64_tr_b16 v[34:35], v103 offset:58368
    v_mfma_f32_16x16x32_bf16 v[252:255], v[40:43], v[140:143], v[252:255]
    ds_read_b64_tr_b16 v[36:37], v103 offset:59392
    v_mfma_f32_16x16x32_bf16 v[252:255], v[44:47], v[148:151], v[252:255]
    ds_read_b64_tr_b16 v[38:39], v103 offset:60416
    s_waitcnt vmcnt(6)
    s_barrier
    s_setprio 3
    s_waitcnt lgkmcnt(4)
    v_mfma_f32_16x16x32_bf16 v[72:75], v[24:27], v[152:155], v[72:75]
    v_add_u32 v102, 0xfffec000, v102
    ds_read_b64_tr_b16 v[40:41], v102 offset:0
    v_mfma_f32_16x16x32_bf16 v[72:75], v[28:31], v[160:163], v[72:75]
    ds_read_b64_tr_b16 v[42:43], v102 offset:1024
    v_mfma_f32_16x16x32_bf16 v[76:79], v[24:27], v[156:159], v[76:79]
    ds_read_b64_tr_b16 v[44:45], v102 offset:2048
    v_mfma_f32_16x16x32_bf16 v[76:79], v[28:31], v[164:167], v[76:79]
    ds_read_b64_tr_b16 v[46:47], v102 offset:3072
    s_waitcnt lgkmcnt(4)
    v_mfma_f32_16x16x32_bf16 v[248:251], v[32:35], v[152:155], v[248:251]
    v_add_u32 v103, 0xfffec000, v103
    ds_read_b64_tr_b16 v[24:25], v103 offset:0
    v_mfma_f32_16x16x32_bf16 v[248:251], v[36:39], v[160:163], v[248:251]
    ds_read_b64_tr_b16 v[26:27], v103 offset:1024
    v_mfma_f32_16x16x32_bf16 v[252:255], v[32:35], v[156:159], v[252:255]
    ds_read_b64_tr_b16 v[28:29], v103 offset:2048
    v_mfma_f32_16x16x32_bf16 v[252:255], v[36:39], v[164:167], v[252:255]
    ds_read_b64_tr_b16 v[30:31], v103 offset:3072
    s_setprio 2
    s_waitcnt lgkmcnt(4)
    v_mfma_f32_16x16x32_bf16 v[72:75], v[40:43], v[168:171], v[72:75]
    ds_read_b64_tr_b16 v[32:33], v102 offset:8192
    v_mfma_f32_16x16x32_bf16 v[72:75], v[44:47], v[176:179], v[72:75]
    ds_read_b64_tr_b16 v[34:35], v102 offset:9216
    v_mfma_f32_16x16x32_bf16 v[76:79], v[40:43], v[172:175], v[76:79]
    ds_read_b64_tr_b16 v[36:37], v102 offset:10240
    v_mfma_f32_16x16x32_bf16 v[76:79], v[44:47], v[180:183], v[76:79]
    ds_read_b64_tr_b16 v[38:39], v102 offset:11264
    s_setprio 1
    s_waitcnt lgkmcnt(4)
    v_mfma_f32_16x16x32_bf16 v[248:251], v[24:27], v[168:171], v[248:251]
    ds_read_b64_tr_b16 v[40:41], v103 offset:8192
    v_mfma_f32_16x16x32_bf16 v[248:251], v[28:31], v[176:179], v[248:251]
    ds_read_b64_tr_b16 v[42:43], v103 offset:9216
    v_mfma_f32_16x16x32_bf16 v[252:255], v[24:27], v[172:175], v[252:255]
    ds_read_b64_tr_b16 v[44:45], v103 offset:10240
    v_mfma_f32_16x16x32_bf16 v[252:255], v[28:31], v[180:183], v[252:255]
    ds_read_b64_tr_b16 v[46:47], v103 offset:11264
    s_waitcnt lgkmcnt(4)
    v_mfma_f32_16x16x32_bf16 v[72:75], v[32:35], v[184:187], v[72:75]
    ds_read_b64_tr_b16 v[24:25], v102 offset:40960
    v_mfma_f32_16x16x32_bf16 v[72:75], v[36:39], v[192:195], v[72:75]
    ds_read_b64_tr_b16 v[26:27], v102 offset:41984
    v_mfma_f32_16x16x32_bf16 v[76:79], v[32:35], v[188:191], v[76:79]
    ds_read_b64_tr_b16 v[28:29], v102 offset:43008
    v_mfma_f32_16x16x32_bf16 v[76:79], v[36:39], v[196:199], v[76:79]
    ds_read_b64_tr_b16 v[30:31], v102 offset:44032
    s_setprio 0
    s_waitcnt lgkmcnt(4)
    v_mfma_f32_16x16x32_bf16 v[248:251], v[40:43], v[184:187], v[248:251]
    ds_read_b64_tr_b16 v[32:33], v103 offset:40960
    v_mfma_f32_16x16x32_bf16 v[248:251], v[44:47], v[192:195], v[248:251]
    ds_read_b64_tr_b16 v[34:35], v103 offset:41984
    v_mfma_f32_16x16x32_bf16 v[252:255], v[40:43], v[188:191], v[252:255]
    ds_read_b64_tr_b16 v[36:37], v103 offset:43008
    v_mfma_f32_16x16x32_bf16 v[252:255], v[44:47], v[196:199], v[252:255]
    ds_read_b64_tr_b16 v[38:39], v103 offset:44032
    s_barrier
    s_setprio 3
    s_waitcnt lgkmcnt(4)
    v_mfma_f32_16x16x32_bf16 v[72:75], v[24:27], v[200:203], v[72:75]
    ds_read_b64_tr_b16 v[40:41], v102 offset:49152
    v_mfma_f32_16x16x32_bf16 v[72:75], v[28:31], v[208:211], v[72:75]
    ds_read_b64_tr_b16 v[42:43], v102 offset:50176
    v_mfma_f32_16x16x32_bf16 v[76:79], v[24:27], v[204:207], v[76:79]
    ds_read_b64_tr_b16 v[44:45], v102 offset:51200
    v_mfma_f32_16x16x32_bf16 v[76:79], v[28:31], v[212:215], v[76:79]
    ds_read_b64_tr_b16 v[46:47], v102 offset:52224
    s_waitcnt lgkmcnt(4)
    v_mfma_f32_16x16x32_bf16 v[248:251], v[32:35], v[200:203], v[248:251]
    ds_read_b64_tr_b16 v[24:25], v103 offset:49152
    v_mfma_f32_16x16x32_bf16 v[248:251], v[36:39], v[208:211], v[248:251]
    ds_read_b64_tr_b16 v[26:27], v103 offset:50176
    v_mfma_f32_16x16x32_bf16 v[252:255], v[32:35], v[204:207], v[252:255]
    ds_read_b64_tr_b16 v[28:29], v103 offset:51200
    v_mfma_f32_16x16x32_bf16 v[252:255], v[36:39], v[212:215], v[252:255]
    ds_read_b64_tr_b16 v[30:31], v103 offset:52224
    s_setprio 2
    s_waitcnt lgkmcnt(4)
    v_mfma_f32_16x16x32_bf16 v[72:75], v[40:43], v[216:219], v[72:75]
    ds_read_b64_tr_b16 v[32:33], v102 offset:57344
    v_mfma_f32_16x16x32_bf16 v[72:75], v[44:47], v[224:227], v[72:75]
    ds_read_b64_tr_b16 v[34:35], v102 offset:58368
    v_mfma_f32_16x16x32_bf16 v[76:79], v[40:43], v[220:223], v[76:79]
    ds_read_b64_tr_b16 v[36:37], v102 offset:59392
    v_mfma_f32_16x16x32_bf16 v[76:79], v[44:47], v[228:231], v[76:79]
    ds_read_b64_tr_b16 v[38:39], v102 offset:60416
    s_setprio 1
    s_waitcnt lgkmcnt(4)
    v_mfma_f32_16x16x32_bf16 v[248:251], v[24:27], v[216:219], v[248:251]
    ds_read_b64_tr_b16 v[40:41], v103 offset:57344
    v_mfma_f32_16x16x32_bf16 v[248:251], v[28:31], v[224:227], v[248:251]
    ds_read_b64_tr_b16 v[42:43], v103 offset:58368
    v_mfma_f32_16x16x32_bf16 v[252:255], v[24:27], v[220:223], v[252:255]
    ds_read_b64_tr_b16 v[44:45], v103 offset:59392
    v_mfma_f32_16x16x32_bf16 v[252:255], v[28:31], v[228:231], v[252:255]
    ds_read_b64_tr_b16 v[46:47], v103 offset:60416
    s_waitcnt lgkmcnt(4)
    v_mfma_f32_16x16x32_bf16 v[72:75], v[32:35], v[232:235], v[72:75]
    v_mfma_f32_16x16x32_bf16 v[72:75], v[36:39], v[240:243], v[72:75]
    v_mfma_f32_16x16x32_bf16 v[76:79], v[32:35], v[236:239], v[76:79]
    v_mfma_f32_16x16x32_bf16 v[76:79], v[36:39], v[244:247], v[76:79]
    s_setprio 0
    s_waitcnt lgkmcnt(0)
    v_mfma_f32_16x16x32_bf16 v[248:251], v[40:43], v[232:235], v[248:251]
    v_mfma_f32_16x16x32_bf16 v[248:251], v[44:47], v[240:243], v[248:251]
    v_mfma_f32_16x16x32_bf16 v[252:255], v[40:43], v[236:239], v[252:255]
    v_mfma_f32_16x16x32_bf16 v[252:255], v[44:47], v[244:247], v[252:255]
    s_lshl_b32 s54, s40, 16
    s_add_u32 s54, s54, s76
    s_add_u32 s62, s40, 1
    s_and_b32 s62, s62, 3
    s_lshl_b32 s62, s62, 12
    s_add_u32 s44, s62, s54
    s_add_u32 s62, s40, 2
    s_and_b32 s62, s62, 3
    s_lshl_b32 s62, s62, 12
    s_add_u32 s45, s62, s54
    s_add_u32 s62, s40, 3
    s_and_b32 s62, s62, 3
    s_lshl_b32 s62, s62, 12
    s_add_u32 s46, s62, s54
    buffer_load_dwordx4 v[112:115], v100, s[16:19], s44 offen sc1
    buffer_load_dword v116, v23, s[16:19], s44 offen offset:1024 sc1
    buffer_load_dwordx4 v[120:123], v100, s[16:19], s45 offen sc1
    buffer_load_dword v124, v23, s[16:19], s45 offen offset:1024 sc1
    buffer_load_dwordx4 v[128:131], v100, s[16:19], s46 offen sc1
    buffer_load_dword v132, v23, s[16:19], s46 offen offset:1024 sc1
    v_add_u32 v1, 0x12000, v1
    ds_write_b128 v1, v[248:251] offset:0
    v_add_u32 v1, 0x14000, v1
    ds_write_b128 v1, v[252:255] offset:0
    v_lshrrev_b32 v14, 4, v0
    s_lshl_b32 s62, s38, 5
    s_sub_u32 s63, s62, s43
    s_add_u32 s63, s63, 5120
    v_lshl_add_u32 v12, v14, 3, s63
    v_and_b32 v13, 15, v0
    v_mul_u32_u24 v13, 1152, v13
    v_lshl_add_u32 v13, v14, 3, v13
    s_lshl2_add_u32 s55, s39, s37
    s_mul_i32 s55, s55, 36864
    s_add_u32 s55, s55, s62
    s_waitcnt lgkmcnt(0)
    s_barrier
    v_add_u32 v4, 0x12000, v4
    ds_read_b128 v[24:27], v4 offset:0
    v_add_u32 v4, 0x14000, v4
    ds_read_b128 v[28:31], v4 offset:0
    v_add_u32 v32, s83, v12
    ds_read_b64 v[32:33], v32
    s_waitcnt lgkmcnt(0)
    v_lshlrev_b32 v36, 16, v32
    v_and_b32 v37, 0xffff0000, v32
    v_lshlrev_b32 v38, 16, v33
    v_and_b32 v39, 0xffff0000, v33
    v_add_f32 v72, v72, v24
    v_add_f32 v72, v72, v36
    v_add_f32 v73, v73, v25
    v_add_f32 v73, v73, v37
    v_add_f32 v74, v74, v26
    v_add_f32 v74, v74, v38
    v_add_f32 v75, v75, v27
    v_add_f32 v75, v75, v39
    v_add_f32 v76, v76, v28
    v_add_f32 v76, v76, v36
    v_add_f32 v77, v77, v29
    v_add_f32 v77, v77, v37
    v_add_f32 v78, v78, v30
    v_add_f32 v78, v78, v38
    v_add_f32 v79, v79, v31
    v_add_f32 v79, v79, v39
    s_waitcnt vmcnt(0)
    v_bitop3_b32 v117, v112, v113, v114 bitop3:0x96
    v_bitop3_b32 v117, v117, v115, v116 bitop3:0x96
    v_xor_b32 v117, s96, v117
    v_bitop3_b32 v125, v120, v121, v122 bitop3:0x96
    v_bitop3_b32 v125, v125, v123, v124 bitop3:0x96
    v_xor_b32 v125, s96, v125
    v_or_b32 v117, v117, v125
    v_bitop3_b32 v133, v128, v129, v130 bitop3:0x96
    v_bitop3_b32 v133, v133, v131, v132 bitop3:0x96
    v_xor_b32 v133, s96, v133
    v_or_b32 v117, v117, v133
    v_cmp_ne_u32 vcc, 0, v117
    s_nop 3
    s_cmp_lg_u64 vcc, 0
    s_cbranch_scc0 LB_fo46
    s_mov_b32 s78, 200000
LB_fs47:
    s_sleep 1
    buffer_load_dwordx4 v[112:115], v100, s[16:19], s44 offen sc1
    buffer_load_dword v116, v23, s[16:19], s44 offen offset:1024 sc1
    buffer_load_dwordx4 v[120:123], v100, s[16:19], s45 offen sc1
    buffer_load_dword v124, v23, s[16:19], s45 offen offset:1024 sc1
    buffer_load_dwordx4 v[128:131], v100, s[16:19], s46 offen sc1
    buffer_load_dword v132, v23, s[16:19], s46 offen offset:1024 sc1
    s_waitcnt vmcnt(0)
    v_bitop3_b32 v117, v112, v113, v114 bitop3:0x96
    v_bitop3_b32 v117, v117, v115, v116 bitop3:0x96
    v_xor_b32 v117, s96, v117
    v_bitop3_b32 v125, v120, v121, v122 bitop3:0x96
    v_bitop3_b32 v125, v125, v123, v124 bitop3:0x96
    v_xor_b32 v125, s96, v125
    v_or_b32 v117, v117, v125
    v_bitop3_b32 v133, v128, v129, v130 bitop3:0x96
    v_bitop3_b32 v133, v133, v131, v132 bitop3:0x96
    v_xor_b32 v133, s96, v133
    v_or_b32 v117, v117, v133
    v_cmp_ne_u32 vcc, 0, v117
    s_nop 3
    s_cmp_lg_u64 vcc, 0
    s_cbranch_scc0 LB_fo46
    s_sub_u32 s78, s78, 1
    s_cmp_lg_u32 s78, 0
    s_cbranch_scc1 LB_fs47
LB_fo46:
    v_lshlrev_b32 v118, 16, v112
    v_and_b32 v119, 0xffff0000, v112
    v_add_f32 v72, v72, v118
    v_add_f32 v73, v73, v119
    v_lshlrev_b32 v118, 16, v113
    v_and_b32 v119, 0xffff0000, v113
    v_add_f32 v74, v74, v118
    v_add_f32 v75, v75, v119
    v_lshlrev_b32 v118, 16, v114
    v_and_b32 v119, 0xffff0000, v114
    v_add_f32 v76, v76, v118
    v_add_f32 v77, v77, v119
    v_lshlrev_b32 v118, 16, v115
    v_and_b32 v119, 0xffff0000, v115
    v_add_f32 v78, v78, v118
    v_add_f32 v79, v79, v119
    v_lshlrev_b32 v126, 16, v120
    v_and_b32 v127, 0xffff0000, v120
    v_add_f32 v72, v72, v126
    v_add_f32 v73, v73, v127
    v_lshlrev_b32 v126, 16, v121
    v_and_b32 v127, 0xffff0000, v121
    v_add_f32 v74, v74, v126
    v_add_f32 v75, v75, v127
    v_lshlrev_b32 v126, 16, v122
    v_and_b32 v127, 0xffff0000, v122
    v_add_f32 v76, v76, v126
    v_add_f32 v77, v77, v127
    v_lshlrev_b32 v126, 16, v123
    v_and_b32 v127, 0xffff0000, v123
    v_add_f32 v78, v78, v126
    v_add_f32 v79, v79, v127
    v_lshlrev_b32 v134, 16, v128
    v_and_b32 v135, 0xffff0000, v128
    v_add_f32 v72, v72, v134
    v_add_f32 v73, v73, v135
    v_lshlrev_b32 v134, 16, v129
    v_and_b32 v135, 0xffff0000, v129
    v_add_f32 v74, v74, v134
    v_add_f32 v75, v75, v135
    v_lshlrev_b32 v134, 16, v130
    v_and_b32 v135, 0xffff0000, v130
    v_add_f32 v76, v76, v134
    v_add_f32 v77, v77, v135
    v_lshlrev_b32 v134, 16, v131
    v_and_b32 v135, 0xffff0000, v131
    v_add_f32 v78, v78, v134
    v_add_f32 v79, v79, v135
    s_add_u32 s63, s55, s83
    v_cvt_pk_bf16_f32 v72, v72, v73
    v_cvt_pk_bf16_f32 v73, v74, v75
    buffer_store_dwordx2 v[72:73], v13, s[20:23], s63 offen
    v_cvt_pk_bf16_f32 v76, v76, v77
    v_cvt_pk_bf16_f32 v77, v78, v79
    s_add_u32 s63, s63, 18432
    buffer_store_dwordx2 v[76:77], v13, s[20:23], s63 offen
    s_endpgm
L_end:
    s_endpgm
.section .rodata,"a"
.p2align 6
.amdhsa_kernel standalone__mixer_channel_mlp__prompt_kernel
  .amdhsa_next_free_vgpr 256
  .amdhsa_next_free_sgpr 102
  .amdhsa_accum_offset 256
  .amdhsa_group_segment_fixed_size 0
  .amdhsa_kernarg_size 64
  .amdhsa_user_sgpr_count 2
  .amdhsa_user_sgpr_kernarg_segment_ptr 1
  .amdhsa_system_sgpr_workgroup_id_x 1
.end_amdhsa_kernel
```
